```python
import torch

def _softmax(x, axis=-1):
    return torch.softmax(x, dim=axis)
def _gelu(x):
    return torch.nn.functional.gelu(x, approximate="tanh")
def _silu(x):
    return torch.nn.functional.silu(x)
def _sigmoid(x):
    return torch.sigmoid(x)
def _layernorm(x, axis=-1, eps=1e-5):
    m = x.mean(dim=axis, keepdim=True)
    v = x.var(dim=axis, keepdim=True, unbiased=False)
    return (x - m) / torch.sqrt(v + eps)
def _scatter_add(tgt, idx, src, axis=0):
    return tgt.clone().index_add_(axis, idx, src)
def _segment_sum(src, seg, n):
    out = torch.zeros((n,) + src.shape[1:], dtype=src.dtype)
    return out.index_add_(0, seg, src)
def _pad(x, pw):
    flat = tuple(v for pair in reversed(pw) for v in pair)
    return torch.nn.functional.pad(x, flat)

kernel_name = 'gated_mix__grouped_kv_mqa__mixer_token_mlp__prompt'

def setup_inputs():

    _w = (lambda a: (lambda t: t.to(torch.bfloat16) if t.is_floating_point() else t)(torch.as_tensor(a)))
    def _A_setup():
        B, S, D, H = 1, 2048, 512, 32
        Dh = D // H
        return {
            "x": _w((lambda *s: torch.randn(*s, dtype=torch.bfloat16) * 0.05)(B, S, D)),
            "wq": _w((lambda *s: torch.randn(*s, dtype=torch.bfloat16) * 0.8)(D, H * Dh)),
            "wk": _w((lambda *s: torch.randn(*s, dtype=torch.bfloat16) * 0.8)(D, Dh)),
            "wv": _w((lambda *s: torch.randn(*s, dtype=torch.bfloat16) * 0.05)(D, Dh)),
            "wo": _w((lambda *s: torch.randn(*s, dtype=torch.bfloat16) * 0.05)(H * Dh, D)),
        }
    _A_in = _A_setup()

    def _B_setup():
        B, S, D, F = 1, 2048, 512, 1792
        return {
            "x": _w((lambda *s: torch.randn(*s, dtype=torch.bfloat16) * 0.05)(B, S, D)),
            "w1": _w((lambda *s: torch.randn(*s, dtype=torch.bfloat16) * 0.2)(S, F) * (S ** -0.5)),
            "b1": _w((lambda *s: torch.randn(*s, dtype=torch.bfloat16) * 1.6)(F) * 0.02),
            "w2": _w((lambda *s: torch.randn(*s, dtype=torch.bfloat16) * 0.05)(F, S) * (F ** -0.5)),
            "b2": _w((lambda *s: torch.randn(*s, dtype=torch.bfloat16) * 0.1)(S) * 0.02),
        }
    _B_in = _B_setup()

    return {
        "A_x": _A_in["x"],
        "A_wq": _A_in["wq"],
        "A_wk": _A_in["wk"],
        "A_wv": _A_in["wv"],
        "A_wo": _A_in["wo"],
        "B_x": _B_in["x"],
        "B_w1": _B_in["w1"],
        "B_b1": _B_in["b1"],
        "B_w2": _B_in["w2"],
        "B_b2": _B_in["b2"],
        "gate_w": _w((lambda *s: torch.randn(*s, dtype=torch.bfloat16) * 0.05)(512) * 16.0),
    }

def reference(A_x, A_wq, A_wk, A_wv, A_wo, B_x, B_w1, B_b1, B_w2, B_b2, gate_w):
    def _A_ref(x, wq, wk, wv, wo):
        B, S, D = x.shape
        H = 32
        Dh = D // H
        q = (lambda x, *d: x.permute(*d))((x @ wq).reshape(B, S, H, Dh), 0, 2, 1, 3)
        k = x @ wk
        v = x @ wv
        scores = torch.einsum("bhqd,bkd->bhqk", q, k) * (Dh ** -0.5)
        p = _softmax(scores, axis=-1)
        o = torch.einsum("bhqk,bkd->bhqd", p, v)
        return (lambda x, *d: x.permute(*d))(o, 0, 2, 1, 3).reshape(B, S, H * Dh) @ wo

    def _B_ref(x, w1, b1, w2, b2):
        B, S, D = x.shape
        h = _layernorm(x, axis=-1)
        u = torch.einsum("bsd,sf->bdf", h, w1) + b1
        u = _gelu(u)
        y = torch.einsum("bdf,fs->bds", u, w2) + b2
        return (lambda x, *d: x.permute(*d))(y, 0, 2, 1)

    x = A_x
    g = _sigmoid((x * gate_w).sum(-1, keepdims=True))
    a = _A_ref(x, A_wq, A_wk, A_wv, A_wo)
    b = _B_ref(x, B_w1, B_b1, B_w2, B_b2)
    return g * a + (1 - g) * b
```

```asm
; @launch grid=(256,1,1) block=(512,1,1) lds=163840
.amdgcn_target "amdgcn-amd-amdhsa--gfx950"
.text
.globl gated_mix__grouped_kv_mqa__mixer_token_mlp__prompt_kernel
.p2align 8
.type gated_mix__grouped_kv_mqa__mixer_token_mlp__prompt_kernel,@function
gated_mix__grouped_kv_mqa__mixer_token_mlp__prompt_kernel:
    s_cmp_ge_u32 s2, 256
    s_cbranch_scc1 L_end
    s_load_dwordx2 s[4:5], s[0:1], 0
    s_load_dwordx2 s[48:49], s[0:1], 104
    s_load_dwordx2 s[12:13], s[0:1], 16
    s_load_dwordx2 s[16:17], s[0:1], 24
    s_load_dwordx2 s[8:9], s[0:1], 8
    s_load_dwordx16 s[64:79], s[0:1], 32
    s_getpc_b64 s[62:63]
L_pc:
    v_lshrrev_b32 v3, 6, v0
    v_and_b32 v0, 63, v0
    v_readfirstlane_b32 s3, v3
    s_and_b32 s57, s2, 7
    s_lshr_b32 s58, s2, 3
    s_lshl_b32 s53, s57, 2
    s_and_b32 s54, s58, 3
    s_add_u32 s53, s53, s54
    s_lshr_b32 s54, s58, 2
    s_lshl_b32 s55, s53, 3
    s_add_u32 s55, s55, s54
    s_cmp_ge_u32 s3, 4
    s_cbranch_scc1 L_gemm
    s_setprio 3
    s_cmp_lg_u32 s3, 0
    s_cbranch_scc1 L_noinit
    s_and_b32 s80, s58, 7
    s_lshl_b32 s80, s80, 13
    v_lshl_add_u32 v1, v0, 7, s80
    v_min_u32 v1, L_codeend-L_pc-4, v1
    global_load_dword v127, v1, s[62:63]
L_noinit:
    s_mov_b32 s6, 2097152
    s_mov_b32 s7, 0x00020000
    v_and_b32 v22, 31, v0
    v_lshrrev_b32 v8, 5, v0
    v_lshlrev_b32 v21, 4, v22
    v_lshl_add_u32 v21, v8, 10, v21
    s_lshl_b32 s80, s55, 13
    s_lshl_b32 s81, s3, 11
    s_add_u32 s83, s80, s81
    s_waitcnt lgkmcnt(0)
    buffer_load_dwordx4 v[112:115], v21, s[4:7], s83 offen
    buffer_load_dwordx4 v[116:119], v21, s[4:7], s83 offen offset:512
    s_load_dword s52, s[48:49], 0
    s_mov_b32 s56, s58
    s_mul_i32 s57, s57, 28
    s_add_u32 s57, s57, s56
    s_lshr_b32 s56, s57, 3
    s_and_b32 s57, s57, 7
    s_and_b32 s59, s3, 3
    s_mov_b32 s60, 0x40000
    s_mov_b32 s14, 16384
    s_mov_b32 s15, 0x00020000
    s_mov_b32 s18, 16384
    s_mov_b32 s19, 0x00020000
    s_mul_i32 s61, s59, 10240
    s_add_u32 s61, s61, 114688
    v_lshlrev_b32 v2, 4, v0
    s_and_b32 s62, s58, 3
    s_lshl_b32 s62, s62, 11
    s_lshl_b32 s82, s59, 12
    s_and_b32 s63, s62, 2048
    s_add_u32 s82, s82, s63
    s_bitcmp1_b32 s58, 1
    s_cbranch_scc0 L_noswap
    s_mov_b64 s[64:65], s[12:13]
    s_mov_b64 s[12:13], s[16:17]
    s_mov_b64 s[16:17], s[64:65]
L_noswap:
    s_xor_b32 s64, s62, 0
    s_add_u32 s64, s64, s61
    s_add_u32 m0, s64, 2048
    s_xor_b32 s65, s82, 0
    buffer_load_dwordx4 v2, s[12:15], s65 offen lds
    buffer_load_dwordx4 v2, s[12:15], s65 offen offset:1024 lds
    s_mov_b32 s10, 524288
    s_mov_b32 s11, 0x00020000
    s_mov_b32 s42, 1024
    s_mov_b32 s43, 0x00020000
    s_mov_b32 s30, 3584
    s_mov_b32 s31, 0x00020000
    s_mov_b32 s38, 4096
    s_mov_b32 s39, 0x00020000
    s_mov_b32 s26, 7340032
    s_mov_b32 s27, 0x00020000
    s_mov_b32 s50, 268435456
    s_mov_b32 s51, 0x00020000
    v_lshlrev_b32 v13, 7, v0
    s_cmp_lg_u32 s59, 0
    s_cbranch_scc1 L_t1
    s_lshl_b32 s64, s58, 3
    s_and_b32 s65, s2, 7
    s_add_u32 s64, s64, s65
    s_lshl_b32 s64, s64, 11
    s_bfm_b64 exec, 16, 0
    buffer_load_dword v126, v13, s[8:11], s64 offen
    s_mov_b64 exec, -1
L_t1:
    s_cmp_lg_u32 s59, 1
    s_cbranch_scc1 L_t2
    s_mov_b64 s[28:29], s[70:71]
    s_mov_b64 s[36:37], s[74:75]
    s_mov_b64 s[40:41], s[76:77]
    s_lshl_b32 s64, s56, 7
    s_lshl_b32 s65, s53, 7
    s_mov_b64 exec, 0xff
    buffer_load_dword v126, v13, s[40:43], 0 offen
    s_mov_b64 exec, 1
    buffer_load_dword v126, v13, s[28:31], s64 offen
    buffer_load_dword v126, v13, s[36:39], s65 offen
    s_mov_b64 exec, -1
L_t2:
    v_lshrrev_b32 v10, 4, v0
    v_and_b32 v11, 15, v0
    v_lshlrev_b32 v12, 2, v10
    v_xor_b32 v12, v12, v11
    v_lshlrev_b32 v12, 4, v12
    v_lshl_add_u32 v12, v10, 10, v12
    s_lshl_b32 s81, s59, 8
    s_add_u32 s80, s80, s81
    s_add_u32 s81, s80, 4096
    v_and_b32 v24, 7, v0
    v_lshlrev_b32 v13, 8, v24
    v_lshl_add_u32 v13, v10, 4, v13
    v_and_b32 v14, 3, v0
    v_lshl_add_u32 v13, v14, 6, v13
    v_add_u32 v13, 114688, v13
    v_xor_b32 v14, 64, v13
    v_xor_b32 v15, 128, v13
    v_xor_b32 v16, 192, v13
    v_lshlrev_b32 v17, 8, v10
    v_lshl_add_u32 v17, v11, 3, v17
    v_add_u32 v17, 116736, v17
    v_and_b32 v20, 3, v0
    v_lshlrev_b32 v20, 2, v20
    v_add_u32 v20, 155648, v20
    s_mul_i32 s68, s59, 28672
    s_add_u32 s68, s68, 24576
    v_add_u32 v21, s68, v21
    v_lshlrev_b32 v28, 4, v24
    v_lshl_add_u32 v28, v10, 9, v28
    s_lshr_b32 s71, s55, 2
    s_lshl_b32 s71, s71, 10
    s_and_b32 s69, s55, 3
    s_lshl_b32 s69, s69, 7
    s_add_u32 s71, s71, s69
    s_add_u32 s71, s71, 196608
    s_lshl_b32 s67, s55, 8
    s_add_u32 s67, s67, 262144
    v_bfe_u32 v8, v0, 3, 1
    v_mul_u32_u24 v9, 28672, v8
    v_bfe_u32 v8, v0, 2, 1
    v_lshl_add_u32 v9, v8, 10, v9
    v_lshl_add_u32 v9, v10, 5, v9
    v_and_b32 v8, 3, v0
    v_lshl_add_u32 v9, v8, 3, v9
    s_and_b32 s69, s59, 1
    s_lshl_b32 s68, s69, 9
    s_add_u32 s68, s68, 24576
    v_add_u32 v9, s68, v9
    s_lshl_b32 s70, s55, 13
    s_lshl_b32 s69, s69, 12
    s_add_u32 s70, s70, s69
    s_add_u32 s70, s70, 1048576
    s_lshl_b32 s69, s55, 5
    s_add_u32 s68, s69, 32768
    s_mov_b32 s74, 0xbb000000
    s_mov_b32 s75, 0x3b000000
    v_bfe_u32 v29, v0, 2, 2
    v_lshrrev_b32 v31, 1, v29
    v_lshlrev_b32 v31, 6, v31
    v_lshl_add_u32 v31, v29, 7, v31
    v_bfe_u32 v29, v0, 4, 1
    v_lshl_add_u32 v31, v29, 5, v31
    v_lshl_add_u32 v31, v8, 3, v31
    v_lshrrev_b32 v30, 5, v0
    v_lshl_add_u32 v31, v30, 10, v31
    s_and_b32 s69, s59, 1
    s_lshl_b32 s69, s69, 6
    v_xor_b32 v31, s69, v31
    v_add_u32 v232, 16384, v31
    v_add_u32 v233, 73728, v31
    v_add_u32 v234, 122880, v31
    v_bfe_u32 v29, v0, 1, 3
    v_xor_b32 v29, v29, v30
    s_and_b32 s69, s53, 1
    s_lshl_b32 s69, s69, 2
    v_xor_b32 v29, s69, v29
    v_lshlrev_b32 v29, 4, v29
    v_lshl_add_u32 v240, v22, 7, v29
    s_lshr_b32 s69, s59, 1
    s_lshl_b32 s69, s69, 12
    v_add_u32 v240, s69, v240
    v_xor_b32 v241, 32, v240
    v_xor_b32 v242, 64, v240
    v_xor_b32 v243, 96, v240
    v_add_u32 v248, 57344, v240
    v_add_u32 v249, 57344, v241
    v_add_u32 v250, 57344, v242
    v_add_u32 v251, 57344, v243
    v_mov_b32 v58, 0
    v_mov_b32 v60, v2
    v_mov_b32 v61, v2
    s_mov_b32 m0, s61
    s_cmp_eq_u32 s59, 1
    s_cbranch_scc1 L_w1
    s_cmp_lt_u32 s59, 1
    s_cbranch_scc1 L_w0
    s_waitcnt vmcnt(2)
L_w0:
    s_waitcnt vmcnt(3)
L_w1:
    s_waitcnt vmcnt(5)
    buffer_load_dwordx4 v12, s[4:7], s80 offen lds
    s_add_u32 m0, s61, 1024
    s_nop 0
    buffer_load_dwordx4 v12, s[4:7], s81 offen lds
    v_lshlrev_b32 v32, 16, v112
    v_and_b32 v33, 0xffff0000, v112
    v_lshlrev_b32 v34, 16, v113
    v_and_b32 v35, 0xffff0000, v113
    v_lshlrev_b32 v36, 16, v114
    v_and_b32 v37, 0xffff0000, v114
    v_lshlrev_b32 v38, 16, v115
    v_and_b32 v39, 0xffff0000, v115
    v_lshlrev_b32 v40, 16, v116
    v_and_b32 v41, 0xffff0000, v116
    v_lshlrev_b32 v42, 16, v117
    v_and_b32 v43, 0xffff0000, v117
    v_lshlrev_b32 v44, 16, v118
    v_and_b32 v45, 0xffff0000, v118
    v_lshlrev_b32 v46, 16, v119
    v_and_b32 v47, 0xffff0000, v119
    s_xor_b32 s64, s62, 2048
    s_add_u32 s64, s64, s61
    s_add_u32 m0, s64, 2048
    s_xor_b32 s65, s82, 2048
    buffer_load_dwordx4 v2, s[12:15], s65 offen lds
    buffer_load_dwordx4 v2, s[12:15], s65 offen offset:1024 lds
    v_pk_add_f32 v[48:49], v[32:33], v[34:35]
    v_pk_add_f32 v[50:51], v[36:37], v[38:39]
    v_pk_add_f32 v[52:53], v[40:41], v[42:43]
    v_pk_add_f32 v[54:55], v[44:45], v[46:47]
    v_pk_add_f32 v[48:49], v[48:49], v[50:51]
    v_pk_add_f32 v[52:53], v[52:53], v[54:55]
    v_pk_add_f32 v[48:49], v[48:49], v[52:53]
    v_add_f32 v48, v48, v49
    s_xor_b32 s64, s62, 4096
    s_add_u32 s64, s64, s61
    s_add_u32 m0, s64, 2048
    s_xor_b32 s65, s82, 0
    buffer_load_dwordx4 v2, s[16:19], s65 offen lds
    buffer_load_dwordx4 v2, s[16:19], s65 offen offset:1024 lds
    s_nop 1
    v_add_f32_dpp v48, v48, v48 row_ror:8 row_mask:0xf bank_mask:0xf
    s_nop 1
    v_add_f32_dpp v48, v48, v48 row_ror:4 row_mask:0xf bank_mask:0xf
    s_nop 1
    v_add_f32_dpp v48, v48, v48 row_ror:2 row_mask:0xf bank_mask:0xf
    s_nop 1
    v_add_f32_dpp v48, v48, v48 row_ror:1 row_mask:0xf bank_mask:0xf
    v_mov_b32 v49, v48
    s_nop 1
    v_permlane16_swap_b32 v48, v49
    v_add_f32 v48, v48, v49
    s_xor_b32 s64, s62, 6144
    s_add_u32 s64, s64, s61
    s_add_u32 m0, s64, 2048
    s_xor_b32 s65, s82, 2048
    buffer_load_dwordx4 v2, s[16:19], s65 offen lds
    buffer_load_dwordx4 v2, s[16:19], s65 offen offset:1024 lds
    s_barrier
    v_mul_f32 v48, s74, v48
    v_pk_add_f32 v[32:33], v[32:33], v[48:49] op_sel_hi:[1,0]
    v_pk_add_f32 v[34:35], v[34:35], v[48:49] op_sel_hi:[1,0]
    v_pk_add_f32 v[36:37], v[36:37], v[48:49] op_sel_hi:[1,0]
    v_pk_add_f32 v[38:39], v[38:39], v[48:49] op_sel_hi:[1,0]
    v_pk_add_f32 v[40:41], v[40:41], v[48:49] op_sel_hi:[1,0]
    v_pk_add_f32 v[42:43], v[42:43], v[48:49] op_sel_hi:[1,0]
    v_pk_add_f32 v[44:45], v[44:45], v[48:49] op_sel_hi:[1,0]
    v_pk_add_f32 v[46:47], v[46:47], v[48:49] op_sel_hi:[1,0]
    v_pk_mul_f32 v[50:51], v[32:33], v[32:33]
    v_pk_mul_f32 v[52:53], v[34:35], v[34:35]
    v_pk_fma_f32 v[50:51], v[36:37], v[36:37], v[50:51]
    v_pk_fma_f32 v[52:53], v[38:39], v[38:39], v[52:53]
    v_pk_fma_f32 v[50:51], v[40:41], v[40:41], v[50:51]
    v_pk_fma_f32 v[52:53], v[42:43], v[42:43], v[52:53]
    v_pk_fma_f32 v[50:51], v[44:45], v[44:45], v[50:51]
    v_pk_fma_f32 v[52:53], v[46:47], v[46:47], v[52:53]
    v_pk_add_f32 v[50:51], v[50:51], v[52:53]
    v_add_f32 v50, v50, v51
    s_nop 1
    v_add_f32_dpp v50, v50, v50 row_ror:8 row_mask:0xf bank_mask:0xf
    s_nop 1
    v_add_f32_dpp v50, v50, v50 row_ror:4 row_mask:0xf bank_mask:0xf
    s_nop 1
    v_add_f32_dpp v50, v50, v50 row_ror:2 row_mask:0xf bank_mask:0xf
    s_nop 1
    v_add_f32_dpp v50, v50, v50 row_ror:1 row_mask:0xf bank_mask:0xf
    v_mov_b32 v51, v50
    s_nop 1
    v_permlane16_swap_b32 v50, v51
    v_add_f32 v50, v50, v51
    v_mov_b32 v51, 0x3727c5ac
    v_fmac_f32 v51, s75, v50
    v_rsq_f32 v50, v51
    s_nop 0
    v_pk_mul_f32 v[32:33], v[32:33], v[50:51] op_sel_hi:[1,0]
    v_pk_mul_f32 v[34:35], v[34:35], v[50:51] op_sel_hi:[1,0]
    v_pk_mul_f32 v[36:37], v[36:37], v[50:51] op_sel_hi:[1,0]
    v_pk_mul_f32 v[38:39], v[38:39], v[50:51] op_sel_hi:[1,0]
    v_pk_mul_f32 v[40:41], v[40:41], v[50:51] op_sel_hi:[1,0]
    v_pk_mul_f32 v[42:43], v[42:43], v[50:51] op_sel_hi:[1,0]
    v_pk_mul_f32 v[44:45], v[44:45], v[50:51] op_sel_hi:[1,0]
    v_pk_mul_f32 v[46:47], v[46:47], v[50:51] op_sel_hi:[1,0]
    v_cvt_pk_bf16_f32 v112, v32, v33
    v_cvt_pk_bf16_f32 v113, v34, v35
    v_cvt_pk_bf16_f32 v114, v36, v37
    v_cvt_pk_bf16_f32 v115, v38, v39
    v_cvt_pk_bf16_f32 v116, v40, v41
    v_cvt_pk_bf16_f32 v117, v42, v43
    v_cvt_pk_bf16_f32 v118, v44, v45
    v_cvt_pk_bf16_f32 v119, v46, v47
    ds_write_b128 v21, v[112:115]
    ds_write_b128 v21, v[116:119] offset:512
    s_waitcnt vmcnt(0) lgkmcnt(0)
    s_barrier
    s_mul_i32 s52, s52, 0x9E3779B1
    s_add_u32 s52, s52, 0x7F4A7C15
    v_mov_b32 v56, s52
    s_cmp_ge_u32 s59, 2
    s_cbranch_scc1 L_h_part
    s_cmp_eq_u32 s59, 1
    s_cbranch_scc1 L_v_part
    ds_read_b128 v[64:67], v13 offset:0
    ds_read_b64_tr_b16 v[96:97], v17 offset:0
    ds_read_b64_tr_b16 v[98:99], v17 offset:128
    ds_read_b128 v[68:71], v14 offset:0
    ds_read_b64_tr_b16 v[100:101], v17 offset:1024
    ds_read_b64_tr_b16 v[102:103], v17 offset:1152
    ds_read_b128 v[72:75], v15 offset:0
    ds_read_b64_tr_b16 v[104:105], v17 offset:2048
    ds_read_b64_tr_b16 v[106:107], v17 offset:2176
    ds_read_b128 v[76:79], v16 offset:0
    ds_read_b64_tr_b16 v[108:109], v17 offset:3072
    ds_read_b64_tr_b16 v[110:111], v17 offset:3200
    s_waitcnt lgkmcnt(6)
    v_mfma_f32_16x16x32_bf16 v[32:35], v[96:99], v[64:67], 0
    ds_read_b128 v[80:83], v13 offset:10240
    ds_read_b64_tr_b16 v[112:113], v17 offset:10240
    ds_read_b64_tr_b16 v[114:115], v17 offset:10368
    v_mfma_f32_16x16x32_bf16 v[32:35], v[100:103], v[68:71], v[32:35]
    ds_read_b128 v[84:87], v14 offset:10240
    ds_read_b64_tr_b16 v[116:117], v17 offset:11264
    ds_read_b64_tr_b16 v[118:119], v17 offset:11392
    s_waitcnt lgkmcnt(6)
    v_mfma_f32_16x16x32_bf16 v[32:35], v[104:107], v[72:75], v[32:35]
    ds_read_b128 v[88:91], v15 offset:10240
    ds_read_b64_tr_b16 v[120:121], v17 offset:12288
    ds_read_b64_tr_b16 v[122:123], v17 offset:12416
    v_mfma_f32_16x16x32_bf16 v[32:35], v[108:111], v[76:79], v[32:35]
    ds_read_b128 v[92:95], v16 offset:10240
    ds_read_b64_tr_b16 v[124:125], v17 offset:13312
    ds_read_b64_tr_b16 v[126:127], v17 offset:13440
    s_waitcnt lgkmcnt(6)
    v_mfma_f32_16x16x32_bf16 v[32:35], v[112:115], v[80:83], v[32:35]
    ds_read_b128 v[64:67], v13 offset:20480
    ds_read_b64_tr_b16 v[96:97], v17 offset:20480
    ds_read_b64_tr_b16 v[98:99], v17 offset:20608
    v_mfma_f32_16x16x32_bf16 v[32:35], v[116:119], v[84:87], v[32:35]
    ds_read_b128 v[68:71], v14 offset:20480
    ds_read_b64_tr_b16 v[100:101], v17 offset:21504
    ds_read_b64_tr_b16 v[102:103], v17 offset:21632
    s_waitcnt lgkmcnt(6)
    v_mfma_f32_16x16x32_bf16 v[32:35], v[120:123], v[88:91], v[32:35]
    ds_read_b128 v[72:75], v15 offset:20480
    ds_read_b64_tr_b16 v[104:105], v17 offset:22528
    ds_read_b64_tr_b16 v[106:107], v17 offset:22656
    v_mfma_f32_16x16x32_bf16 v[32:35], v[124:127], v[92:95], v[32:35]
    ds_read_b128 v[76:79], v16 offset:20480
    ds_read_b64_tr_b16 v[108:109], v17 offset:23552
    ds_read_b64_tr_b16 v[110:111], v17 offset:23680
    s_waitcnt lgkmcnt(6)
    v_mfma_f32_16x16x32_bf16 v[32:35], v[96:99], v[64:67], v[32:35]
    ds_read_b128 v[80:83], v13 offset:30720
    ds_read_b64_tr_b16 v[112:113], v17 offset:30720
    ds_read_b64_tr_b16 v[114:115], v17 offset:30848
    v_mfma_f32_16x16x32_bf16 v[32:35], v[100:103], v[68:71], v[32:35]
    ds_read_b128 v[84:87], v14 offset:30720
    ds_read_b64_tr_b16 v[116:117], v17 offset:31744
    ds_read_b64_tr_b16 v[118:119], v17 offset:31872
    s_waitcnt lgkmcnt(6)
    v_mfma_f32_16x16x32_bf16 v[32:35], v[104:107], v[72:75], v[32:35]
    ds_read_b128 v[88:91], v15 offset:30720
    ds_read_b64_tr_b16 v[120:121], v17 offset:32768
    ds_read_b64_tr_b16 v[122:123], v17 offset:32896
    v_mfma_f32_16x16x32_bf16 v[32:35], v[108:111], v[76:79], v[32:35]
    ds_read_b128 v[92:95], v16 offset:30720
    ds_read_b64_tr_b16 v[124:125], v17 offset:33792
    ds_read_b64_tr_b16 v[126:127], v17 offset:33920
    s_waitcnt lgkmcnt(6)
    v_mfma_f32_16x16x32_bf16 v[32:35], v[112:115], v[80:83], v[32:35]
    v_mfma_f32_16x16x32_bf16 v[32:35], v[116:119], v[84:87], v[32:35]
    s_waitcnt lgkmcnt(0)
    v_mfma_f32_16x16x32_bf16 v[32:35], v[120:123], v[88:91], v[32:35]
    v_mfma_f32_16x16x32_bf16 v[32:35], v[124:127], v[92:95], v[32:35]
    s_nop 7
    v_cvt_pk_bf16_f32 v40, v32, v33
    v_cvt_pk_bf16_f32 v41, v34, v35
    v_cvt_pk_bf16_f32 v42, v32, v33
    v_cvt_pk_bf16_f32 v43, v34, v35
    s_nop 1
    v_permlane32_swap_b32 v40, v42
    v_permlane32_swap_b32 v41, v43
    s_barrier
    s_mov_b64 exec, 0x00ff00ff
    buffer_store_dwordx4 v[40:43], v28, s[48:51], s71 offen sc1
    s_mov_b64 exec, -1
    s_branch L_st_done
L_v_part:
    ds_read_b128 v[64:67], v13 offset:0
    ds_read_b64_tr_b16 v[96:97], v17 offset:4096
    ds_read_b64_tr_b16 v[98:99], v17 offset:4224
    ds_read_b128 v[68:71], v14 offset:0
    ds_read_b64_tr_b16 v[100:101], v17 offset:5120
    ds_read_b64_tr_b16 v[102:103], v17 offset:5248
    ds_read_b128 v[72:75], v15 offset:0
    ds_read_b64_tr_b16 v[104:105], v17 offset:6144
    ds_read_b64_tr_b16 v[106:107], v17 offset:6272
    ds_read_b128 v[76:79], v16 offset:0
    ds_read_b64_tr_b16 v[108:109], v17 offset:7168
    ds_read_b64_tr_b16 v[110:111], v17 offset:7296
    s_waitcnt lgkmcnt(6)
    v_mfma_f32_16x16x32_bf16 v[32:35], v[64:67], v[96:99], 0
    ds_read_b128 v[80:83], v13 offset:10240
    ds_read_b64_tr_b16 v[112:113], v17 offset:14336
    ds_read_b64_tr_b16 v[114:115], v17 offset:14464
    v_mfma_f32_16x16x32_bf16 v[32:35], v[68:71], v[100:103], v[32:35]
    ds_read_b128 v[84:87], v14 offset:10240
    ds_read_b64_tr_b16 v[116:117], v17 offset:15360
    ds_read_b64_tr_b16 v[118:119], v17 offset:15488
    s_waitcnt lgkmcnt(6)
    v_mfma_f32_16x16x32_bf16 v[32:35], v[72:75], v[104:107], v[32:35]
    ds_read_b128 v[88:91], v15 offset:10240
    ds_read_b64_tr_b16 v[120:121], v17 offset:16384
    ds_read_b64_tr_b16 v[122:123], v17 offset:16512
    v_mfma_f32_16x16x32_bf16 v[32:35], v[76:79], v[108:111], v[32:35]
    ds_read_b128 v[92:95], v16 offset:10240
    ds_read_b64_tr_b16 v[124:125], v17 offset:17408
    ds_read_b64_tr_b16 v[126:127], v17 offset:17536
    s_waitcnt lgkmcnt(6)
    v_mfma_f32_16x16x32_bf16 v[32:35], v[80:83], v[112:115], v[32:35]
    ds_read_b128 v[64:67], v13 offset:20480
    ds_read_b64_tr_b16 v[96:97], v17 offset:24576
    ds_read_b64_tr_b16 v[98:99], v17 offset:24704
    v_mfma_f32_16x16x32_bf16 v[32:35], v[84:87], v[116:119], v[32:35]
    ds_read_b128 v[68:71], v14 offset:20480
    ds_read_b64_tr_b16 v[100:101], v17 offset:25600
    ds_read_b64_tr_b16 v[102:103], v17 offset:25728
    s_waitcnt lgkmcnt(6)
    v_mfma_f32_16x16x32_bf16 v[32:35], v[88:91], v[120:123], v[32:35]
    ds_read_b128 v[72:75], v15 offset:20480
    ds_read_b64_tr_b16 v[104:105], v17 offset:26624
    ds_read_b64_tr_b16 v[106:107], v17 offset:26752
    v_mfma_f32_16x16x32_bf16 v[32:35], v[92:95], v[124:127], v[32:35]
    ds_read_b128 v[76:79], v16 offset:20480
    ds_read_b64_tr_b16 v[108:109], v17 offset:27648
    ds_read_b64_tr_b16 v[110:111], v17 offset:27776
    s_waitcnt lgkmcnt(6)
    v_mfma_f32_16x16x32_bf16 v[32:35], v[64:67], v[96:99], v[32:35]
    ds_read_b128 v[80:83], v13 offset:30720
    ds_read_b64_tr_b16 v[112:113], v17 offset:34816
    ds_read_b64_tr_b16 v[114:115], v17 offset:34944
    v_mfma_f32_16x16x32_bf16 v[32:35], v[68:71], v[100:103], v[32:35]
    ds_read_b128 v[84:87], v14 offset:30720
    ds_read_b64_tr_b16 v[116:117], v17 offset:35840
    ds_read_b64_tr_b16 v[118:119], v17 offset:35968
    s_waitcnt lgkmcnt(6)
    v_mfma_f32_16x16x32_bf16 v[32:35], v[72:75], v[104:107], v[32:35]
    ds_read_b128 v[88:91], v15 offset:30720
    ds_read_b64_tr_b16 v[120:121], v17 offset:36864
    ds_read_b64_tr_b16 v[122:123], v17 offset:36992
    v_mfma_f32_16x16x32_bf16 v[32:35], v[76:79], v[108:111], v[32:35]
    ds_read_b128 v[92:95], v16 offset:30720
    ds_read_b64_tr_b16 v[124:125], v17 offset:37888
    ds_read_b64_tr_b16 v[126:127], v17 offset:38016
    s_waitcnt lgkmcnt(6)
    v_mfma_f32_16x16x32_bf16 v[32:35], v[80:83], v[112:115], v[32:35]
    v_mfma_f32_16x16x32_bf16 v[32:35], v[84:87], v[116:119], v[32:35]
    s_waitcnt lgkmcnt(0)
    v_mfma_f32_16x16x32_bf16 v[32:35], v[88:91], v[120:123], v[32:35]
    v_mfma_f32_16x16x32_bf16 v[32:35], v[92:95], v[124:127], v[32:35]
    s_nop 7
    v_cvt_pk_bf16_f32 v40, v32, v33
    v_cvt_pk_bf16_f32 v41, v34, v35
    v_cvt_pk_bf16_f32 v42, v32, v33
    v_cvt_pk_bf16_f32 v43, v34, v35
    s_nop 1
    v_permlane16_swap_b32 v40, v42
    v_permlane16_swap_b32 v41, v43
    s_barrier
    s_mov_b64 exec, 0xffff
    buffer_store_dwordx4 v[40:43], v61, s[48:51], s67 offen sc1
    s_mov_b64 exec, -1
    s_branch L_st_done
L_h_part:
    ds_read_b64_tr_b16 v[64:65], v9 offset:0
    ds_read_b64_tr_b16 v[66:67], v9 offset:57344
    ds_read_b64_tr_b16 v[68:69], v9 offset:128
    ds_read_b64_tr_b16 v[70:71], v9 offset:57472
    ds_read_b64_tr_b16 v[72:73], v9 offset:256
    ds_read_b64_tr_b16 v[74:75], v9 offset:57600
    ds_read_b64_tr_b16 v[76:77], v9 offset:384
    ds_read_b64_tr_b16 v[78:79], v9 offset:57728
    s_waitcnt lgkmcnt(0)
    s_barrier
    buffer_store_dwordx4 v[64:67], v60, s[48:51], s70 offen offset:0 sc1
    buffer_store_dwordx4 v[68:71], v60, s[48:51], s70 offen offset:1024 sc1
    buffer_store_dwordx4 v[72:75], v60, s[48:51], s70 offen offset:2048 sc1
    buffer_store_dwordx4 v[76:79], v60, s[48:51], s70 offen offset:3072 sc1
L_st_done:
    s_mul_i32 s69, s59, 2560
    s_add_u32 s69, s69, 122880
    v_add_u32 v3, s69, v2
    v_lshlrev_b32 v4, 3, v0
    v_add_u32 v4, s69, v4
    v_mov_b32 v5, 155648
    v_and_b32 v10, 15, v0
    v_lshlrev_b32 v10, 4, v10
    v_bfe_u32 v11, v0, 4, 1
    v_lshl_add_u32 v10, v11, 9, v10
    v_lshrrev_b32 v11, 5, v0
    v_lshl_add_u32 v10, v11, 8, v10
    v_add_u32 v7, 65536, v10
    v_lshlrev_b32 v12, 5, v0
    v_mov_b32 v13, v20
    v_add_u32 v14, 114688, v2
    s_lshl_b32 s70, s59, 11
    s_add_u32 s70, s70, 32768
    s_lshl_b32 s80, s59, 14
    s_add_u32 s80, s80, 196608
    s_and_b32 s81, s58, 15
    s_lshl_b32 s81, s81, 10
    s_add_u32 s80, s80, s81
    s_mov_b32 s74, 0x3eb8aa3b
    s_and_b32 s69, s59, 1
    s_lshl_b32 s69, s69, 2
    s_lshr_b32 s71, s59, 1
    s_add_u32 s69, s69, s71
    s_lshl_b32 s69, s69, 10
    v_add_u32 v235, s69, v14
    v_and_b32 v21, 11, v0
    v_cmp_eq_u32 vcc, 0, v21
    v_mov_b32 v21, 0x3f803f80
    v_mov_b32 v1, 0xdddddddd
    v_cndmask_b32 v22, 0, v21, vcc
    v_cndmask_b32 v23, 0, v21, vcc
    v_mov_b32 v2, v60
    v_mov_b64 v[132:133], v[22:23]
    v_mov_b64 v[134:135], v[22:23]
    v_mov_b64 v[140:141], v[22:23]
    v_mov_b64 v[142:143], v[22:23]
    v_mov_b64 v[148:149], v[22:23]
    v_mov_b64 v[150:151], v[22:23]
    v_mov_b64 v[156:157], v[22:23]
    v_mov_b64 v[158:159], v[22:23]
    v_mov_b64 v[164:165], v[22:23]
    v_mov_b64 v[166:167], v[22:23]
    v_mov_b64 v[172:173], v[22:23]
    v_mov_b64 v[174:175], v[22:23]
    v_mov_b64 v[180:181], v[22:23]
    v_mov_b64 v[182:183], v[22:23]
    v_mov_b64 v[188:189], v[22:23]
    v_mov_b64 v[190:191], v[22:23]
    v_mov_b64 v[196:197], v[22:23]
    v_mov_b64 v[198:199], v[22:23]
    v_mov_b64 v[204:205], v[22:23]
    v_mov_b64 v[206:207], v[22:23]
    v_mov_b64 v[212:213], v[22:23]
    v_mov_b64 v[214:215], v[22:23]
    v_mov_b64 v[220:221], v[22:23]
    v_mov_b64 v[222:223], v[22:23]
    v_mov_b64 v[228:229], v[22:23]
    v_mov_b64 v[230:231], v[22:23]
    v_mov_b64 v[236:237], v[22:23]
    v_mov_b64 v[238:239], v[22:23]
    v_mov_b64 v[244:245], v[22:23]
    v_mov_b64 v[246:247], v[22:23]
    v_mov_b64 v[252:253], v[22:23]
    v_mov_b64 v[254:255], v[22:23]
    v_mov_b64 v[16:17], 0
    v_mov_b64 v[18:19], 0
    v_mov_b64 v[20:21], 0
    v_mov_b64 v[22:23], 0
    v_mov_b64 v[24:25], 0
    v_mov_b64 v[26:27], 0
    v_mov_b64 v[28:29], 0
    v_mov_b64 v[30:31], 0
    v_and_b32 v15, 31, v0
    v_lshlrev_b32 v15, 2, v15
    v_add_u32 v15, 156032, v15
    s_mov_b32 s62, 7
    s_add_u32 s77, s52, 8
    s_lshl_b32 s77, s77, 2
    s_and_b32 s76, s62, 1
    s_lshl_b32 s69, s53, 1
    s_add_u32 s76, s76, s69
    s_lshl_b32 s76, s76, 3
    s_add_u32 s76, s76, s54
    s_lshl_b32 s76, s76, 2
    s_lshr_b32 s69, s62, 1
    s_add_u32 s76, s76, s69
    s_lshl_b32 s76, s76, 11
    s_add_u32 s76, s76, 5242880
    s_waitcnt vmcnt(0)
    s_barrier
    s_cmp_lg_u32 s59, 0
    s_cbranch_scc1 L_nofl
    s_mov_b64 exec, 1
    buffer_store_dword v56, v58, s[48:51], s68 offen sc1
    s_mov_b64 exec, -1
L_nofl:
    s_barrier
    ds_read_b64_tr_b16 v[96:97], v232 offset:0
    ds_read_b64_tr_b16 v[98:99], v232 offset:512
    ds_read_b128 v[100:103], v240 offset:0
    ds_read_b64_tr_b16 v[104:105], v232 offset:2048
    ds_read_b64_tr_b16 v[106:107], v232 offset:2560
    ds_read_b128 v[108:111], v241 offset:0
    ds_read_b64_tr_b16 v[112:113], v232 offset:4096
    ds_read_b64_tr_b16 v[114:115], v232 offset:4608
    ds_read_b128 v[116:119], v242 offset:0
    ds_read_b64_tr_b16 v[120:121], v232 offset:6144
    ds_read_b64_tr_b16 v[122:123], v232 offset:6656
    ds_read_b128 v[124:127], v243 offset:0
    s_waitcnt lgkmcnt(6)
    v_mfma_f32_32x32x16_bf16 v[32:47], v[96:99], v[100:103], 0
    ds_read_b64_tr_b16 v[80:81], v232 offset:28672
    ds_read_b64_tr_b16 v[82:83], v232 offset:29184
    ds_read_b128 v[84:87], v240 offset:28672
    v_mfma_f32_32x32x16_bf16 v[32:47], v[104:107], v[108:111], v[32:47]
    ds_read_b64_tr_b16 v[88:89], v232 offset:30720
    ds_read_b64_tr_b16 v[90:91], v232 offset:31232
    ds_read_b128 v[92:95], v241 offset:28672
    s_waitcnt lgkmcnt(6)
    v_mfma_f32_32x32x16_bf16 v[32:47], v[112:115], v[116:119], v[32:47]
    ds_read_b64_tr_b16 v[96:97], v232 offset:32768
    ds_read_b64_tr_b16 v[98:99], v232 offset:33280
    ds_read_b128 v[100:103], v242 offset:28672
    v_mfma_f32_32x32x16_bf16 v[32:47], v[120:123], v[124:127], v[32:47]
    ds_read_b64_tr_b16 v[104:105], v232 offset:34816
    ds_read_b64_tr_b16 v[106:107], v232 offset:35328
    ds_read_b128 v[108:111], v243 offset:28672
    s_waitcnt lgkmcnt(6)
    v_mfma_f32_32x32x16_bf16 v[32:47], v[80:83], v[84:87], v[32:47]
    ds_read_b64_tr_b16 v[112:113], v233 offset:0
    ds_read_b64_tr_b16 v[114:115], v233 offset:512
    ds_read_b128 v[116:119], v248 offset:0
    v_mfma_f32_32x32x16_bf16 v[32:47], v[88:91], v[92:95], v[32:47]
    ds_read_b64_tr_b16 v[120:121], v233 offset:2048
    ds_read_b64_tr_b16 v[122:123], v233 offset:2560
    ds_read_b128 v[124:127], v249 offset:0
    s_waitcnt lgkmcnt(6)
    v_mfma_f32_32x32x16_bf16 v[32:47], v[96:99], v[100:103], v[32:47]
    ds_read_b64_tr_b16 v[80:81], v233 offset:4096
    ds_read_b64_tr_b16 v[82:83], v233 offset:4608
    ds_read_b128 v[84:87], v250 offset:0
    v_mfma_f32_32x32x16_bf16 v[32:47], v[104:107], v[108:111], v[32:47]
    ds_read_b64_tr_b16 v[88:89], v233 offset:6144
    ds_read_b64_tr_b16 v[90:91], v233 offset:6656
    ds_read_b128 v[92:95], v251 offset:0
    s_waitcnt lgkmcnt(6)
    v_mfma_f32_32x32x16_bf16 v[32:47], v[112:115], v[116:119], v[32:47]
    ds_read_b64_tr_b16 v[96:97], v233 offset:28672
    ds_read_b64_tr_b16 v[98:99], v233 offset:29184
    ds_read_b128 v[100:103], v248 offset:28672
    v_mfma_f32_32x32x16_bf16 v[32:47], v[120:123], v[124:127], v[32:47]
    ds_read_b64_tr_b16 v[104:105], v233 offset:30720
    ds_read_b64_tr_b16 v[106:107], v233 offset:31232
    ds_read_b128 v[108:111], v249 offset:28672
    s_waitcnt lgkmcnt(6)
    v_mfma_f32_32x32x16_bf16 v[32:47], v[80:83], v[84:87], v[32:47]
    ds_read_b64_tr_b16 v[112:113], v233 offset:32768
    ds_read_b64_tr_b16 v[114:115], v233 offset:33280
    ds_read_b128 v[116:119], v250 offset:28672
    v_mfma_f32_32x32x16_bf16 v[32:47], v[88:91], v[92:95], v[32:47]
    ds_read_b64_tr_b16 v[120:121], v233 offset:34816
    ds_read_b64_tr_b16 v[122:123], v233 offset:35328
    ds_read_b128 v[124:127], v251 offset:28672
    s_waitcnt lgkmcnt(6)
    v_mfma_f32_32x32x16_bf16 v[32:47], v[96:99], v[100:103], v[32:47]
    v_mfma_f32_32x32x16_bf16 v[32:47], v[104:107], v[108:111], v[32:47]
    s_waitcnt lgkmcnt(0)
    v_mfma_f32_32x32x16_bf16 v[32:47], v[112:115], v[116:119], v[32:47]
    v_mfma_f32_32x32x16_bf16 v[32:47], v[120:123], v[124:127], v[32:47]
    s_barrier
    ds_read_b64_tr_b16 v[96:97], v234 offset:0
    ds_read_b64_tr_b16 v[98:99], v234 offset:512
    ds_read_b128 v[100:103], v240 offset:8192
    ds_read_b64_tr_b16 v[104:105], v234 offset:2048
    ds_read_b64_tr_b16 v[106:107], v234 offset:2560
    ds_read_b128 v[108:111], v241 offset:8192
    ds_read_b64_tr_b16 v[112:113], v234 offset:8192
    ds_read_b64_tr_b16 v[114:115], v234 offset:8704
    ds_read_b128 v[116:119], v240 offset:36864
    ds_read_b64_tr_b16 v[120:121], v234 offset:10240
    ds_read_b64_tr_b16 v[122:123], v234 offset:10752
    ds_read_b128 v[124:127], v241 offset:36864
    s_waitcnt lgkmcnt(6)
    v_mfma_f32_32x32x16_bf16 v[32:47], v[96:99], v[100:103], v[32:47]
    ds_read_b64_tr_b16 v[80:81], v234 offset:16384
    ds_read_b64_tr_b16 v[82:83], v234 offset:16896
    ds_read_b128 v[84:87], v248 offset:8192
    v_mfma_f32_32x32x16_bf16 v[32:47], v[104:107], v[108:111], v[32:47]
    ds_read_b64_tr_b16 v[88:89], v234 offset:18432
    ds_read_b64_tr_b16 v[90:91], v234 offset:18944
    ds_read_b128 v[92:95], v249 offset:8192
    s_waitcnt lgkmcnt(6)
    v_mfma_f32_32x32x16_bf16 v[32:47], v[112:115], v[116:119], v[32:47]
    ds_read_b64_tr_b16 v[96:97], v234 offset:24576
    ds_read_b64_tr_b16 v[98:99], v234 offset:25088
    ds_read_b128 v[100:103], v248 offset:36864
    v_mfma_f32_32x32x16_bf16 v[32:47], v[120:123], v[124:127], v[32:47]
    ds_read_b64_tr_b16 v[104:105], v234 offset:26624
    ds_read_b64_tr_b16 v[106:107], v234 offset:27136
    ds_read_b128 v[108:111], v249 offset:36864
    s_waitcnt lgkmcnt(6)
    v_mfma_f32_32x32x16_bf16 v[32:47], v[80:83], v[84:87], v[32:47]
    v_mfma_f32_32x32x16_bf16 v[32:47], v[88:91], v[92:95], v[32:47]
    s_waitcnt lgkmcnt(0)
    v_mfma_f32_32x32x16_bf16 v[32:47], v[96:99], v[100:103], v[32:47]
    v_mfma_f32_32x32x16_bf16 v[32:47], v[104:107], v[108:111], v[32:47]
    s_barrier
    buffer_load_dword v6, v12, s[48:51], s70 offen sc1
    ds_read_b64_tr_b16 v[96:97], v234 offset:4096
    ds_read_b64_tr_b16 v[98:99], v234 offset:4608
    ds_read_b128 v[100:103], v242 offset:8192
    ds_read_b64_tr_b16 v[104:105], v234 offset:6144
    ds_read_b64_tr_b16 v[106:107], v234 offset:6656
    ds_read_b128 v[108:111], v243 offset:8192
    ds_read_b64_tr_b16 v[112:113], v234 offset:12288
    ds_read_b64_tr_b16 v[114:115], v234 offset:12800
    ds_read_b128 v[116:119], v242 offset:36864
    ds_read_b64_tr_b16 v[120:121], v234 offset:14336
    ds_read_b64_tr_b16 v[122:123], v234 offset:14848
    ds_read_b128 v[124:127], v243 offset:36864
    s_waitcnt lgkmcnt(6)
    v_mfma_f32_32x32x16_bf16 v[32:47], v[96:99], v[100:103], v[32:47]
    ds_read_b64_tr_b16 v[80:81], v234 offset:20480
    ds_read_b64_tr_b16 v[82:83], v234 offset:20992
    ds_read_b128 v[84:87], v250 offset:8192
    v_mfma_f32_32x32x16_bf16 v[32:47], v[104:107], v[108:111], v[32:47]
    ds_read_b64_tr_b16 v[88:89], v234 offset:22528
    ds_read_b64_tr_b16 v[90:91], v234 offset:23040
    ds_read_b128 v[92:95], v251 offset:8192
    s_waitcnt lgkmcnt(6)
    v_mfma_f32_32x32x16_bf16 v[32:47], v[112:115], v[116:119], v[32:47]
    ds_read_b64_tr_b16 v[96:97], v234 offset:28672
    ds_read_b64_tr_b16 v[98:99], v234 offset:29184
    ds_read_b128 v[100:103], v250 offset:36864
    v_mfma_f32_32x32x16_bf16 v[32:47], v[120:123], v[124:127], v[32:47]
    ds_read_b64_tr_b16 v[104:105], v234 offset:30720
    ds_read_b64_tr_b16 v[106:107], v234 offset:31232
    ds_read_b128 v[108:111], v251 offset:36864
    s_waitcnt lgkmcnt(6)
    v_mfma_f32_32x32x16_bf16 v[32:47], v[80:83], v[84:87], v[32:47]
    v_mfma_f32_32x32x16_bf16 v[32:47], v[88:91], v[92:95], v[32:47]
    s_waitcnt lgkmcnt(0)
    v_mfma_f32_32x32x16_bf16 v[32:47], v[96:99], v[100:103], v[32:47]
    v_mfma_f32_32x32x16_bf16 v[32:47], v[104:107], v[108:111], v[32:47]
    s_nop 11
    v_pk_mul_f32 v[32:33], v[32:33], s[74:75] op_sel_hi:[1,0]
    v_pk_mul_f32 v[34:35], v[34:35], s[74:75] op_sel_hi:[1,0]
    v_pk_mul_f32 v[36:37], v[36:37], s[74:75] op_sel_hi:[1,0]
    v_pk_mul_f32 v[38:39], v[38:39], s[74:75] op_sel_hi:[1,0]
    v_pk_mul_f32 v[40:41], v[40:41], s[74:75] op_sel_hi:[1,0]
    v_pk_mul_f32 v[42:43], v[42:43], s[74:75] op_sel_hi:[1,0]
    v_pk_mul_f32 v[44:45], v[44:45], s[74:75] op_sel_hi:[1,0]
    v_pk_mul_f32 v[46:47], v[46:47], s[74:75] op_sel_hi:[1,0]
    v_cvt_pk_bf16_f32 v32, v32, v33
    v_cvt_pk_bf16_f32 v33, v34, v35
    v_cvt_pk_bf16_f32 v34, v36, v37
    v_cvt_pk_bf16_f32 v35, v38, v39
    v_cvt_pk_bf16_f32 v36, v40, v41
    v_cvt_pk_bf16_f32 v37, v42, v43
    v_cvt_pk_bf16_f32 v38, v44, v45
    v_cvt_pk_bf16_f32 v39, v46, v47
    ds_write_b128 v235, v[32:35]
    ds_write_b128 v235, v[36:39] offset:2048
    s_waitcnt vmcnt(0)
    s_branch L_gwc_3
L_gw_1:
    s_mov_b64 exec, s[82:83]
    buffer_load_dword v6, v12, s[48:51], s70 offen sc1
    s_waitcnt vmcnt(0)
L_gwc_3:
    v_cmp_ne_u32 s[82:83], s52, v6
    s_mov_b64 exec, -1
    s_cmp_eq_u64 s[82:83], 0
    s_cbranch_scc1 L_gwe_2
    s_sub_u32 s60, s60, 1
    s_cbranch_scc1 L_bail
    s_sleep 4
    s_branch L_gw_1
L_gwe_2:
    s_xor_b32 s81, s80, 0
    buffer_load_dwordx4 v[64:67], v2, s[48:51], s81 offen sc1
    buffer_load_dwordx4 v[128:131], v7, s[48:51], s81 offen sc1
    s_xor_b32 s81, s80, 1024
    buffer_load_dwordx4 v[68:71], v2, s[48:51], s81 offen sc1
    buffer_load_dwordx4 v[136:139], v7, s[48:51], s81 offen sc1
    s_waitcnt lgkmcnt(0)
    s_barrier
    ds_read_b128 v[8:11], v14
    s_xor_b32 s81, s80, 2048
    buffer_load_dwordx4 v[72:75], v2, s[48:51], s81 offen sc1
    buffer_load_dwordx4 v[144:147], v7, s[48:51], s81 offen sc1
    s_xor_b32 s81, s80, 3072
    buffer_load_dwordx4 v[76:79], v2, s[48:51], s81 offen sc1
    buffer_load_dwordx4 v[152:155], v7, s[48:51], s81 offen sc1
    s_xor_b32 s81, s80, 4096
    buffer_load_dwordx4 v[80:83], v2, s[48:51], s81 offen sc1
    buffer_load_dwordx4 v[160:163], v7, s[48:51], s81 offen sc1
    s_waitcnt vmcnt(8)
    v_permlane16_swap_b32 v128, v132
    v_permlane16_swap_b32 v129, v133
    v_permlane16_swap_b32 v130, v134
    v_permlane16_swap_b32 v131, v135
    s_xor_b32 s81, s80, 5120
    buffer_load_dwordx4 v[84:87], v2, s[48:51], s81 offen sc1
    buffer_load_dwordx4 v[168:171], v7, s[48:51], s81 offen sc1
    s_waitcnt vmcnt(8)
    v_permlane16_swap_b32 v136, v140
    v_permlane16_swap_b32 v137, v141
    v_permlane16_swap_b32 v138, v142
    v_permlane16_swap_b32 v139, v143
    s_waitcnt lgkmcnt(0)
    v_mfma_f32_32x32x16_bf16 v[32:47], v[64:67], v[8:11], 0
    v_add_u32 v12, 8192, v14
    s_nop 10
L_main:
    s_setprio 2
    v_exp_f32 v32, v32
    v_exp_f32 v33, v33
    v_exp_f32 v34, v34
    v_exp_f32 v35, v35
    v_exp_f32 v36, v36
    v_mfma_f32_32x32x16_bf16 v[48:63], v[68:71], v[8:11], 0
    s_xor_b32 s81, s80, 6144
    buffer_load_dwordx4 v[88:91], v2, s[48:51], s81 offen sc1
    buffer_load_dwordx4 v[176:179], v7, s[48:51], s81 offen sc1
    v_exp_f32 v37, v37
    v_exp_f32 v38, v38
    v_exp_f32 v39, v39
    v_exp_f32 v40, v40
    v_exp_f32 v41, v41
    v_exp_f32 v42, v42
    v_exp_f32 v43, v43
    v_exp_f32 v44, v44
    v_exp_f32 v45, v45
    v_exp_f32 v46, v46
    v_smfmac_f32_32x32x32_bf16 v[16:31], v[128:131], v[32:39], v1
    v_exp_f32 v47, v47
    v_exp_f32 v48, v48
    v_exp_f32 v49, v49
    v_smfmac_f32_32x32x32_bf16 v[16:31], v[132:135], v[40:47], v1
    v_exp_f32 v50, v50
    v_exp_f32 v51, v51
    v_exp_f32 v52, v52
    s_waitcnt vmcnt(9)
    v_mfma_f32_32x32x16_bf16 v[32:47], v[72:75], v[8:11], 0
    s_xor_b32 s81, s80, 7168
    buffer_load_dwordx4 v[92:95], v2, s[48:51], s81 offen sc1
    buffer_load_dwordx4 v[184:187], v7, s[48:51], s81 offen sc1
    v_exp_f32 v53, v53
    v_exp_f32 v54, v54
    v_exp_f32 v55, v55
    v_exp_f32 v56, v56
    v_exp_f32 v57, v57
    v_smfmac_f32_32x32x32_bf16 v[16:31], v[136:139], v[48:55], v1
    v_exp_f32 v58, v58
    v_exp_f32 v59, v59
    v_exp_f32 v60, v60
    v_exp_f32 v61, v61
    v_exp_f32 v62, v62
    v_exp_f32 v63, v63
    v_exp_f32 v32, v32
    v_exp_f32 v33, v33
    v_smfmac_f32_32x32x32_bf16 v[16:31], v[140:143], v[56:63], v1
    v_exp_f32 v34, v34
    v_exp_f32 v35, v35
    v_exp_f32 v36, v36
    s_waitcnt vmcnt(9)
    v_mfma_f32_32x32x16_bf16 v[48:63], v[76:79], v[8:11], 0
    v_permlane16_swap_b32 v144, v148
    v_permlane16_swap_b32 v145, v149
    v_permlane16_swap_b32 v146, v150
    v_permlane16_swap_b32 v147, v151
    s_xor_b32 s81, s80, 8192
    buffer_load_dwordx4 v[96:99], v2, s[48:51], s81 offen sc1
    buffer_load_dwordx4 v[192:195], v7, s[48:51], s81 offen sc1
    v_exp_f32 v37, v37
    v_exp_f32 v38, v38
    v_exp_f32 v39, v39
    v_exp_f32 v40, v40
    v_exp_f32 v41, v41
    v_smfmac_f32_32x32x32_bf16 v[16:31], v[144:147], v[32:39], v1
    v_exp_f32 v42, v42
    v_exp_f32 v43, v43
    v_exp_f32 v44, v44
    v_exp_f32 v45, v45
    v_exp_f32 v46, v46
    v_exp_f32 v47, v47
    v_exp_f32 v48, v48
    v_exp_f32 v49, v49
    v_smfmac_f32_32x32x32_bf16 v[16:31], v[148:151], v[40:47], v1
    v_exp_f32 v50, v50
    v_exp_f32 v51, v51
    v_exp_f32 v52, v52
    s_waitcnt vmcnt(9)
    v_mfma_f32_32x32x16_bf16 v[32:47], v[80:83], v[8:11], 0
    v_permlane16_swap_b32 v152, v156
    v_permlane16_swap_b32 v153, v157
    v_permlane16_swap_b32 v154, v158
    v_permlane16_swap_b32 v155, v159
    s_xor_b32 s81, s80, 9216
    buffer_load_dwordx4 v[100:103], v2, s[48:51], s81 offen sc1
    buffer_load_dwordx4 v[200:203], v7, s[48:51], s81 offen sc1
    v_exp_f32 v53, v53
    v_exp_f32 v54, v54
    v_exp_f32 v55, v55
    v_exp_f32 v56, v56
    v_exp_f32 v57, v57
    v_smfmac_f32_32x32x32_bf16 v[16:31], v[152:155], v[48:55], v1
    v_exp_f32 v58, v58
    v_exp_f32 v59, v59
    v_exp_f32 v60, v60
    v_exp_f32 v61, v61
    v_exp_f32 v62, v62
    v_exp_f32 v63, v63
    v_exp_f32 v32, v32
    v_exp_f32 v33, v33
    v_smfmac_f32_32x32x32_bf16 v[16:31], v[156:159], v[56:63], v1
    v_exp_f32 v34, v34
    v_exp_f32 v35, v35
    v_exp_f32 v36, v36
    s_waitcnt vmcnt(9)
    v_mfma_f32_32x32x16_bf16 v[48:63], v[84:87], v[8:11], 0
    v_permlane16_swap_b32 v160, v164
    v_permlane16_swap_b32 v161, v165
    v_permlane16_swap_b32 v162, v166
    v_permlane16_swap_b32 v163, v167
    s_xor_b32 s81, s80, 10240
    buffer_load_dwordx4 v[104:107], v2, s[48:51], s81 offen sc1
    buffer_load_dwordx4 v[208:211], v7, s[48:51], s81 offen sc1
    v_exp_f32 v37, v37
    v_exp_f32 v38, v38
    v_exp_f32 v39, v39
    v_exp_f32 v40, v40
    v_exp_f32 v41, v41
    v_smfmac_f32_32x32x32_bf16 v[16:31], v[160:163], v[32:39], v1
    v_exp_f32 v42, v42
    v_exp_f32 v43, v43
    v_exp_f32 v44, v44
    v_exp_f32 v45, v45
    v_exp_f32 v46, v46
    v_exp_f32 v47, v47
    v_exp_f32 v48, v48
    v_exp_f32 v49, v49
    v_smfmac_f32_32x32x32_bf16 v[16:31], v[164:167], v[40:47], v1
    v_exp_f32 v50, v50
    v_exp_f32 v51, v51
    v_exp_f32 v52, v52
    s_waitcnt vmcnt(9)
    v_mfma_f32_32x32x16_bf16 v[32:47], v[88:91], v[8:11], 0
    v_permlane16_swap_b32 v168, v172
    v_permlane16_swap_b32 v169, v173
    v_permlane16_swap_b32 v170, v174
    v_permlane16_swap_b32 v171, v175
    s_xor_b32 s81, s80, 11264
    buffer_load_dwordx4 v[108:111], v2, s[48:51], s81 offen sc1
    buffer_load_dwordx4 v[216:219], v7, s[48:51], s81 offen sc1
    v_exp_f32 v53, v53
    v_exp_f32 v54, v54
    v_exp_f32 v55, v55
    v_exp_f32 v56, v56
    v_exp_f32 v57, v57
    v_smfmac_f32_32x32x32_bf16 v[16:31], v[168:171], v[48:55], v1
    v_exp_f32 v58, v58
    v_exp_f32 v59, v59
    v_exp_f32 v60, v60
    v_exp_f32 v61, v61
    v_exp_f32 v62, v62
    v_exp_f32 v63, v63
    v_exp_f32 v32, v32
    v_exp_f32 v33, v33
    v_smfmac_f32_32x32x32_bf16 v[16:31], v[172:175], v[56:63], v1
    v_exp_f32 v34, v34
    v_exp_f32 v35, v35
    v_exp_f32 v36, v36
    s_waitcnt vmcnt(9)
    v_mfma_f32_32x32x16_bf16 v[48:63], v[92:95], v[8:11], 0
    v_permlane16_swap_b32 v176, v180
    v_permlane16_swap_b32 v177, v181
    v_permlane16_swap_b32 v178, v182
    v_permlane16_swap_b32 v179, v183
    s_xor_b32 s81, s80, 12288
    buffer_load_dwordx4 v[112:115], v2, s[48:51], s81 offen sc1
    buffer_load_dwordx4 v[224:227], v7, s[48:51], s81 offen sc1
    v_exp_f32 v37, v37
    v_exp_f32 v38, v38
    v_exp_f32 v39, v39
    v_exp_f32 v40, v40
    v_exp_f32 v41, v41
    v_smfmac_f32_32x32x32_bf16 v[16:31], v[176:179], v[32:39], v1
    v_exp_f32 v42, v42
    v_exp_f32 v43, v43
    v_exp_f32 v44, v44
    v_exp_f32 v45, v45
    v_exp_f32 v46, v46
    v_exp_f32 v47, v47
    v_exp_f32 v48, v48
    v_exp_f32 v49, v49
    v_smfmac_f32_32x32x32_bf16 v[16:31], v[180:183], v[40:47], v1
    v_exp_f32 v50, v50
    v_exp_f32 v51, v51
    v_exp_f32 v52, v52
    s_waitcnt vmcnt(9)
    v_mfma_f32_32x32x16_bf16 v[32:47], v[96:99], v[8:11], 0
    v_permlane16_swap_b32 v184, v188
    v_permlane16_swap_b32 v185, v189
    v_permlane16_swap_b32 v186, v190
    v_permlane16_swap_b32 v187, v191
    s_xor_b32 s81, s80, 13312
    buffer_load_dwordx4 v[116:119], v2, s[48:51], s81 offen sc1
    buffer_load_dwordx4 v[232:235], v7, s[48:51], s81 offen sc1
    v_exp_f32 v53, v53
    v_exp_f32 v54, v54
    v_exp_f32 v55, v55
    v_exp_f32 v56, v56
    v_exp_f32 v57, v57
    v_smfmac_f32_32x32x32_bf16 v[16:31], v[184:187], v[48:55], v1
    v_exp_f32 v58, v58
    v_exp_f32 v59, v59
    v_exp_f32 v60, v60
    v_exp_f32 v61, v61
    v_exp_f32 v62, v62
    v_exp_f32 v63, v63
    v_exp_f32 v32, v32
    v_exp_f32 v33, v33
    v_smfmac_f32_32x32x32_bf16 v[16:31], v[188:191], v[56:63], v1
    v_exp_f32 v34, v34
    v_exp_f32 v35, v35
    v_exp_f32 v36, v36
    s_waitcnt vmcnt(9)
    v_mfma_f32_32x32x16_bf16 v[48:63], v[100:103], v[8:11], 0
    v_permlane16_swap_b32 v192, v196
    v_permlane16_swap_b32 v193, v197
    v_permlane16_swap_b32 v194, v198
    v_permlane16_swap_b32 v195, v199
    s_xor_b32 s81, s80, 14336
    buffer_load_dwordx4 v[120:123], v2, s[48:51], s81 offen sc1
    buffer_load_dwordx4 v[240:243], v7, s[48:51], s81 offen sc1
    v_exp_f32 v37, v37
    v_exp_f32 v38, v38
    v_exp_f32 v39, v39
    v_exp_f32 v40, v40
    v_exp_f32 v41, v41
    v_smfmac_f32_32x32x32_bf16 v[16:31], v[192:195], v[32:39], v1
    v_exp_f32 v42, v42
    v_exp_f32 v43, v43
    v_exp_f32 v44, v44
    v_exp_f32 v45, v45
    v_exp_f32 v46, v46
    v_exp_f32 v47, v47
    v_exp_f32 v48, v48
    v_exp_f32 v49, v49
    v_smfmac_f32_32x32x32_bf16 v[16:31], v[196:199], v[40:47], v1
    v_exp_f32 v50, v50
    v_exp_f32 v51, v51
    v_exp_f32 v52, v52
    s_waitcnt vmcnt(9)
    v_mfma_f32_32x32x16_bf16 v[32:47], v[104:107], v[8:11], 0
    v_permlane16_swap_b32 v200, v204
    v_permlane16_swap_b32 v201, v205
    v_permlane16_swap_b32 v202, v206
    v_permlane16_swap_b32 v203, v207
    s_xor_b32 s81, s80, 15360
    buffer_load_dwordx4 v[124:127], v2, s[48:51], s81 offen sc1
    buffer_load_dwordx4 v[248:251], v7, s[48:51], s81 offen sc1
    v_exp_f32 v53, v53
    v_exp_f32 v54, v54
    v_exp_f32 v55, v55
    v_exp_f32 v56, v56
    v_exp_f32 v57, v57
    v_smfmac_f32_32x32x32_bf16 v[16:31], v[200:203], v[48:55], v1
    v_exp_f32 v58, v58
    v_exp_f32 v59, v59
    v_exp_f32 v60, v60
    v_exp_f32 v61, v61
    v_exp_f32 v62, v62
    v_exp_f32 v63, v63
    v_exp_f32 v32, v32
    v_exp_f32 v33, v33
    v_smfmac_f32_32x32x32_bf16 v[16:31], v[204:207], v[56:63], v1
    v_exp_f32 v34, v34
    v_exp_f32 v35, v35
    v_exp_f32 v36, v36
    s_waitcnt vmcnt(9)
    v_mfma_f32_32x32x16_bf16 v[48:63], v[108:111], v[8:11], 0
    v_permlane16_swap_b32 v208, v212
    v_permlane16_swap_b32 v209, v213
    v_permlane16_swap_b32 v210, v214
    v_permlane16_swap_b32 v211, v215
    v_exp_f32 v37, v37
    v_exp_f32 v38, v38
    v_exp_f32 v39, v39
    v_exp_f32 v40, v40
    v_exp_f32 v41, v41
    v_smfmac_f32_32x32x32_bf16 v[16:31], v[208:211], v[32:39], v1
    v_exp_f32 v42, v42
    v_exp_f32 v43, v43
    v_exp_f32 v44, v44
    v_exp_f32 v45, v45
    v_exp_f32 v46, v46
    v_exp_f32 v47, v47
    v_exp_f32 v48, v48
    v_exp_f32 v49, v49
    v_smfmac_f32_32x32x32_bf16 v[16:31], v[212:215], v[40:47], v1
    v_exp_f32 v50, v50
    v_exp_f32 v51, v51
    v_exp_f32 v52, v52
    s_waitcnt vmcnt(7)
    v_mfma_f32_32x32x16_bf16 v[32:47], v[112:115], v[8:11], 0
    v_permlane16_swap_b32 v216, v220
    v_permlane16_swap_b32 v217, v221
    v_permlane16_swap_b32 v218, v222
    v_permlane16_swap_b32 v219, v223
    v_exp_f32 v53, v53
    v_exp_f32 v54, v54
    v_exp_f32 v55, v55
    v_exp_f32 v56, v56
    v_exp_f32 v57, v57
    v_smfmac_f32_32x32x32_bf16 v[16:31], v[216:219], v[48:55], v1
    v_exp_f32 v58, v58
    v_exp_f32 v59, v59
    v_exp_f32 v60, v60
    v_exp_f32 v61, v61
    v_exp_f32 v62, v62
    v_exp_f32 v63, v63
    v_exp_f32 v32, v32
    v_exp_f32 v33, v33
    v_smfmac_f32_32x32x32_bf16 v[16:31], v[220:223], v[56:63], v1
    v_exp_f32 v34, v34
    v_exp_f32 v35, v35
    v_exp_f32 v36, v36
    s_waitcnt vmcnt(5)
    v_mfma_f32_32x32x16_bf16 v[48:63], v[116:119], v[8:11], 0
    v_permlane16_swap_b32 v224, v228
    v_permlane16_swap_b32 v225, v229
    v_permlane16_swap_b32 v226, v230
    v_permlane16_swap_b32 v227, v231
    v_exp_f32 v37, v37
    v_exp_f32 v38, v38
    v_exp_f32 v39, v39
    v_exp_f32 v40, v40
    v_exp_f32 v41, v41
    v_smfmac_f32_32x32x32_bf16 v[16:31], v[224:227], v[32:39], v1
    v_exp_f32 v42, v42
    v_exp_f32 v43, v43
    v_exp_f32 v44, v44
    v_exp_f32 v45, v45
    v_exp_f32 v46, v46
    v_exp_f32 v47, v47
    v_exp_f32 v48, v48
    v_exp_f32 v49, v49
    v_smfmac_f32_32x32x32_bf16 v[16:31], v[228:231], v[40:47], v1
    v_exp_f32 v50, v50
    v_exp_f32 v51, v51
    v_exp_f32 v52, v52
    s_waitcnt vmcnt(3)
    v_mfma_f32_32x32x16_bf16 v[32:47], v[120:123], v[8:11], 0
    v_permlane16_swap_b32 v232, v236
    v_permlane16_swap_b32 v233, v237
    v_permlane16_swap_b32 v234, v238
    v_permlane16_swap_b32 v235, v239
    v_exp_f32 v53, v53
    v_exp_f32 v54, v54
    v_exp_f32 v55, v55
    v_exp_f32 v56, v56
    v_exp_f32 v57, v57
    v_smfmac_f32_32x32x32_bf16 v[16:31], v[232:235], v[48:55], v1
    v_exp_f32 v58, v58
    v_exp_f32 v59, v59
    v_exp_f32 v60, v60
    v_exp_f32 v61, v61
    v_exp_f32 v62, v62
    v_exp_f32 v63, v63
    v_exp_f32 v32, v32
    v_exp_f32 v33, v33
    v_smfmac_f32_32x32x32_bf16 v[16:31], v[236:239], v[56:63], v1
    v_exp_f32 v34, v34
    v_exp_f32 v35, v35
    v_exp_f32 v36, v36
    s_waitcnt vmcnt(1)
    v_mfma_f32_32x32x16_bf16 v[48:63], v[124:127], v[8:11], 0
    ds_read_b128 v[8:11], v14 offset:1024
    v_permlane16_swap_b32 v240, v244
    v_permlane16_swap_b32 v241, v245
    v_permlane16_swap_b32 v242, v246
    v_permlane16_swap_b32 v243, v247
    v_exp_f32 v37, v37
    v_exp_f32 v38, v38
    v_exp_f32 v39, v39
    v_exp_f32 v40, v40
    v_exp_f32 v41, v41
    v_smfmac_f32_32x32x32_bf16 v[16:31], v[240:243], v[32:39], v1
    v_exp_f32 v42, v42
    v_exp_f32 v43, v43
    v_exp_f32 v44, v44
    v_exp_f32 v45, v45
    v_exp_f32 v46, v46
    v_exp_f32 v47, v47
    v_exp_f32 v48, v48
    v_exp_f32 v49, v49
    v_smfmac_f32_32x32x32_bf16 v[16:31], v[244:247], v[40:47], v1
    v_exp_f32 v50, v50
    v_exp_f32 v51, v51
    v_exp_f32 v52, v52
    s_waitcnt vmcnt(0)
    s_waitcnt lgkmcnt(0)
    v_mfma_f32_32x32x16_bf16 v[32:47], v[64:67], v[8:11], 0
    v_permlane16_swap_b32 v248, v252
    v_permlane16_swap_b32 v249, v253
    v_permlane16_swap_b32 v250, v254
    v_permlane16_swap_b32 v251, v255
    v_exp_f32 v53, v53
    v_exp_f32 v54, v54
    v_exp_f32 v55, v55
    v_exp_f32 v56, v56
    v_exp_f32 v57, v57
    v_smfmac_f32_32x32x32_bf16 v[16:31], v[248:251], v[48:55], v1
    v_exp_f32 v58, v58
    v_exp_f32 v59, v59
    v_exp_f32 v60, v60
    v_exp_f32 v61, v61
    v_exp_f32 v62, v62
    v_exp_f32 v63, v63
    v_exp_f32 v32, v32
    v_exp_f32 v33, v33
    v_smfmac_f32_32x32x32_bf16 v[16:31], v[252:255], v[56:63], v1
    v_exp_f32 v34, v34
    v_exp_f32 v35, v35
    v_exp_f32 v36, v36
    v_mfma_f32_32x32x16_bf16 v[48:63], v[68:71], v[8:11], 0
    v_exp_f32 v37, v37
    v_exp_f32 v38, v38
    v_exp_f32 v39, v39
    v_exp_f32 v40, v40
    v_exp_f32 v41, v41
    v_exp_f32 v42, v42
    v_exp_f32 v43, v43
    v_exp_f32 v44, v44
    v_add_u32_e64 v25, s52, 1
    ds_write_b128 v3, v[16:19] offset:0
    ds_write_b128 v3, v[20:23] offset:1024
    ds_write_b64 v4, v[24:25] offset:2048
    v_mov_b64 v[16:17], 0
    v_mov_b64 v[18:19], 0
    v_mov_b64 v[20:21], 0
    v_mov_b64 v[22:23], 0
    v_mov_b32 v24, 0
    v_exp_f32 v45, v45
    v_exp_f32 v46, v46
    v_smfmac_f32_32x32x32_bf16 v[16:31], v[128:131], v[32:39], v1
    v_exp_f32 v47, v47
    v_exp_f32 v48, v48
    v_exp_f32 v49, v49
    v_smfmac_f32_32x32x32_bf16 v[16:31], v[132:135], v[40:47], v1
    v_exp_f32 v50, v50
    v_exp_f32 v51, v51
    v_exp_f32 v52, v52
    v_mfma_f32_32x32x16_bf16 v[32:47], v[72:75], v[8:11], 0
    v_exp_f32 v53, v53
    v_exp_f32 v54, v54
    v_exp_f32 v55, v55
    v_exp_f32 v56, v56
    v_exp_f32 v57, v57
    v_smfmac_f32_32x32x32_bf16 v[16:31], v[136:139], v[48:55], v1
    v_exp_f32 v58, v58
    v_exp_f32 v59, v59
    v_exp_f32 v60, v60
    v_exp_f32 v61, v61
    v_exp_f32 v62, v62
    v_exp_f32 v63, v63
    v_exp_f32 v32, v32
    v_exp_f32 v33, v33
    v_smfmac_f32_32x32x32_bf16 v[16:31], v[140:143], v[56:63], v1
    v_exp_f32 v34, v34
    v_exp_f32 v35, v35
    v_exp_f32 v36, v36
    v_mfma_f32_32x32x16_bf16 v[48:63], v[76:79], v[8:11], 0
    v_exp_f32 v37, v37
    v_exp_f32 v38, v38
    v_exp_f32 v39, v39
    v_exp_f32 v40, v40
    v_exp_f32 v41, v41
    v_smfmac_f32_32x32x32_bf16 v[16:31], v[144:147], v[32:39], v1
    v_exp_f32 v42, v42
    v_exp_f32 v43, v43
    v_exp_f32 v44, v44
    v_exp_f32 v45, v45
    v_exp_f32 v46, v46
    v_exp_f32 v47, v47
    v_exp_f32 v48, v48
    v_exp_f32 v49, v49
    v_smfmac_f32_32x32x32_bf16 v[16:31], v[148:151], v[40:47], v1
    v_exp_f32 v50, v50
    v_exp_f32 v51, v51
    v_exp_f32 v52, v52
    v_mfma_f32_32x32x16_bf16 v[32:47], v[80:83], v[8:11], 0
    v_exp_f32 v53, v53
    v_exp_f32 v54, v54
    v_exp_f32 v55, v55
    v_exp_f32 v56, v56
    v_exp_f32 v57, v57
    v_smfmac_f32_32x32x32_bf16 v[16:31], v[152:155], v[48:55], v1
    v_exp_f32 v58, v58
    v_exp_f32 v59, v59
    v_exp_f32 v60, v60
    v_exp_f32 v61, v61
    v_exp_f32 v62, v62
    v_exp_f32 v63, v63
    v_exp_f32 v32, v32
    v_exp_f32 v33, v33
    v_smfmac_f32_32x32x32_bf16 v[16:31], v[156:159], v[56:63], v1
    v_exp_f32 v34, v34
    v_exp_f32 v35, v35
    v_exp_f32 v36, v36
    v_mfma_f32_32x32x16_bf16 v[48:63], v[84:87], v[8:11], 0
    v_exp_f32 v37, v37
    v_exp_f32 v38, v38
    v_exp_f32 v39, v39
    v_exp_f32 v40, v40
    v_exp_f32 v41, v41
    v_smfmac_f32_32x32x32_bf16 v[16:31], v[160:163], v[32:39], v1
    v_exp_f32 v42, v42
    v_exp_f32 v43, v43
    v_exp_f32 v44, v44
    v_exp_f32 v45, v45
    v_exp_f32 v46, v46
    v_exp_f32 v47, v47
    v_exp_f32 v48, v48
    v_exp_f32 v49, v49
    v_smfmac_f32_32x32x32_bf16 v[16:31], v[164:167], v[40:47], v1
    v_exp_f32 v50, v50
    v_exp_f32 v51, v51
    v_exp_f32 v52, v52
    v_mfma_f32_32x32x16_bf16 v[32:47], v[88:91], v[8:11], 0
    v_exp_f32 v53, v53
    v_exp_f32 v54, v54
    v_exp_f32 v55, v55
    v_exp_f32 v56, v56
    v_exp_f32 v57, v57
    v_smfmac_f32_32x32x32_bf16 v[16:31], v[168:171], v[48:55], v1
    v_exp_f32 v58, v58
    v_exp_f32 v59, v59
    v_exp_f32 v60, v60
    v_exp_f32 v61, v61
    v_exp_f32 v62, v62
    v_exp_f32 v63, v63
    v_exp_f32 v32, v32
    v_exp_f32 v33, v33
    v_smfmac_f32_32x32x32_bf16 v[16:31], v[172:175], v[56:63], v1
    v_exp_f32 v34, v34
    v_exp_f32 v35, v35
    v_exp_f32 v36, v36
    v_mfma_f32_32x32x16_bf16 v[48:63], v[92:95], v[8:11], 0
    v_exp_f32 v37, v37
    v_exp_f32 v38, v38
    v_exp_f32 v39, v39
    v_exp_f32 v40, v40
    v_exp_f32 v41, v41
    v_smfmac_f32_32x32x32_bf16 v[16:31], v[176:179], v[32:39], v1
    v_exp_f32 v42, v42
    v_exp_f32 v43, v43
    v_exp_f32 v44, v44
    v_exp_f32 v45, v45
    v_exp_f32 v46, v46
    v_exp_f32 v47, v47
    v_exp_f32 v48, v48
    v_exp_f32 v49, v49
    v_smfmac_f32_32x32x32_bf16 v[16:31], v[180:183], v[40:47], v1
    v_exp_f32 v50, v50
    v_exp_f32 v51, v51
    v_exp_f32 v52, v52
    v_mfma_f32_32x32x16_bf16 v[32:47], v[96:99], v[8:11], 0
    v_exp_f32 v53, v53
    v_exp_f32 v54, v54
    v_exp_f32 v55, v55
    v_exp_f32 v56, v56
    v_exp_f32 v57, v57
    v_smfmac_f32_32x32x32_bf16 v[16:31], v[184:187], v[48:55], v1
    v_exp_f32 v58, v58
    v_exp_f32 v59, v59
    v_exp_f32 v60, v60
    v_exp_f32 v61, v61
    v_exp_f32 v62, v62
    v_exp_f32 v63, v63
    v_exp_f32 v32, v32
    v_exp_f32 v33, v33
    v_smfmac_f32_32x32x32_bf16 v[16:31], v[188:191], v[56:63], v1
    v_exp_f32 v34, v34
    v_exp_f32 v35, v35
    v_exp_f32 v36, v36
    v_mfma_f32_32x32x16_bf16 v[48:63], v[100:103], v[8:11], 0
    v_exp_f32 v37, v37
    v_exp_f32 v38, v38
    v_exp_f32 v39, v39
    v_exp_f32 v40, v40
    v_exp_f32 v41, v41
    v_smfmac_f32_32x32x32_bf16 v[16:31], v[192:195], v[32:39], v1
    v_exp_f32 v42, v42
    v_exp_f32 v43, v43
    v_exp_f32 v44, v44
    v_exp_f32 v45, v45
    v_exp_f32 v46, v46
    v_exp_f32 v47, v47
    v_exp_f32 v48, v48
    v_exp_f32 v49, v49
    v_smfmac_f32_32x32x32_bf16 v[16:31], v[196:199], v[40:47], v1
    v_exp_f32 v50, v50
    v_exp_f32 v51, v51
    v_exp_f32 v52, v52
    v_mfma_f32_32x32x16_bf16 v[32:47], v[104:107], v[8:11], 0
    v_exp_f32 v53, v53
    v_exp_f32 v54, v54
    v_exp_f32 v55, v55
    v_exp_f32 v56, v56
    v_exp_f32 v57, v57
    v_smfmac_f32_32x32x32_bf16 v[16:31], v[200:203], v[48:55], v1
    v_exp_f32 v58, v58
    v_exp_f32 v59, v59
    v_exp_f32 v60, v60
    v_exp_f32 v61, v61
    v_exp_f32 v62, v62
    v_exp_f32 v63, v63
    v_exp_f32 v32, v32
    v_exp_f32 v33, v33
    v_smfmac_f32_32x32x32_bf16 v[16:31], v[204:207], v[56:63], v1
    v_exp_f32 v34, v34
    v_exp_f32 v35, v35
    v_exp_f32 v36, v36
    v_mfma_f32_32x32x16_bf16 v[48:63], v[108:111], v[8:11], 0
    v_exp_f32 v37, v37
    v_exp_f32 v38, v38
    v_exp_f32 v39, v39
    v_exp_f32 v40, v40
    v_exp_f32 v41, v41
    v_smfmac_f32_32x32x32_bf16 v[16:31], v[208:211], v[32:39], v1
    v_exp_f32 v42, v42
    v_exp_f32 v43, v43
    v_exp_f32 v44, v44
    v_exp_f32 v45, v45
    v_exp_f32 v46, v46
    v_exp_f32 v47, v47
    v_exp_f32 v48, v48
    v_exp_f32 v49, v49
    v_smfmac_f32_32x32x32_bf16 v[16:31], v[212:215], v[40:47], v1
    v_exp_f32 v50, v50
    v_exp_f32 v51, v51
    v_exp_f32 v52, v52
    v_mfma_f32_32x32x16_bf16 v[32:47], v[112:115], v[8:11], 0
    v_exp_f32 v53, v53
    v_exp_f32 v54, v54
    v_exp_f32 v55, v55
    v_exp_f32 v56, v56
    v_exp_f32 v57, v57
    v_smfmac_f32_32x32x32_bf16 v[16:31], v[216:219], v[48:55], v1
    v_exp_f32 v58, v58
    v_exp_f32 v59, v59
    v_exp_f32 v60, v60
    v_exp_f32 v61, v61
    v_exp_f32 v62, v62
    v_exp_f32 v63, v63
    v_exp_f32 v32, v32
    v_exp_f32 v33, v33
    v_smfmac_f32_32x32x32_bf16 v[16:31], v[220:223], v[56:63], v1
    v_exp_f32 v34, v34
    v_exp_f32 v35, v35
    v_exp_f32 v36, v36
    v_mfma_f32_32x32x16_bf16 v[48:63], v[116:119], v[8:11], 0
    v_exp_f32 v37, v37
    v_exp_f32 v38, v38
    v_exp_f32 v39, v39
    v_exp_f32 v40, v40
    v_exp_f32 v41, v41
    v_smfmac_f32_32x32x32_bf16 v[16:31], v[224:227], v[32:39], v1
    v_exp_f32 v42, v42
    v_exp_f32 v43, v43
    v_exp_f32 v44, v44
    v_exp_f32 v45, v45
    v_exp_f32 v46, v46
    v_exp_f32 v47, v47
    v_exp_f32 v48, v48
    v_exp_f32 v49, v49
    v_smfmac_f32_32x32x32_bf16 v[16:31], v[228:231], v[40:47], v1
    v_exp_f32 v50, v50
    v_exp_f32 v51, v51
    v_exp_f32 v52, v52
    v_mfma_f32_32x32x16_bf16 v[32:47], v[120:123], v[8:11], 0
    v_exp_f32 v53, v53
    v_exp_f32 v54, v54
    v_exp_f32 v55, v55
    v_exp_f32 v56, v56
    v_exp_f32 v57, v57
    v_smfmac_f32_32x32x32_bf16 v[16:31], v[232:235], v[48:55], v1
    v_exp_f32 v58, v58
    v_exp_f32 v59, v59
    v_exp_f32 v60, v60
    v_exp_f32 v61, v61
    v_exp_f32 v62, v62
    v_exp_f32 v63, v63
    v_exp_f32 v32, v32
    v_exp_f32 v33, v33
    v_smfmac_f32_32x32x32_bf16 v[16:31], v[236:239], v[56:63], v1
    v_exp_f32 v34, v34
    v_exp_f32 v35, v35
    v_exp_f32 v36, v36
    v_mfma_f32_32x32x16_bf16 v[48:63], v[124:127], v[8:11], 0
    ds_read_b128 v[8:11], v14 offset:2048
    v_exp_f32 v37, v37
    v_exp_f32 v38, v38
    v_exp_f32 v39, v39
    v_exp_f32 v40, v40
    v_exp_f32 v41, v41
    v_smfmac_f32_32x32x32_bf16 v[16:31], v[240:243], v[32:39], v1
    v_exp_f32 v42, v42
    v_exp_f32 v43, v43
    v_exp_f32 v44, v44
    v_exp_f32 v45, v45
    v_exp_f32 v46, v46
    v_exp_f32 v47, v47
    v_exp_f32 v48, v48
    v_exp_f32 v49, v49
    v_smfmac_f32_32x32x32_bf16 v[16:31], v[244:247], v[40:47], v1
    v_exp_f32 v50, v50
    v_exp_f32 v51, v51
    v_exp_f32 v52, v52
    s_waitcnt lgkmcnt(0)
    v_mfma_f32_32x32x16_bf16 v[32:47], v[64:67], v[8:11], 0
    v_exp_f32 v53, v53
    v_exp_f32 v54, v54
    v_exp_f32 v55, v55
    v_exp_f32 v56, v56
    v_exp_f32 v57, v57
    v_smfmac_f32_32x32x32_bf16 v[16:31], v[248:251], v[48:55], v1
    v_exp_f32 v58, v58
    v_exp_f32 v59, v59
    v_exp_f32 v60, v60
    v_exp_f32 v61, v61
    v_exp_f32 v62, v62
    v_exp_f32 v63, v63
    v_exp_f32 v32, v32
    v_exp_f32 v33, v33
    v_smfmac_f32_32x32x32_bf16 v[16:31], v[252:255], v[56:63], v1
    v_exp_f32 v34, v34
    v_exp_f32 v35, v35
    v_exp_f32 v36, v36
    v_mfma_f32_32x32x16_bf16 v[48:63], v[68:71], v[8:11], 0
    v_exp_f32 v37, v37
    v_exp_f32 v38, v38
    v_exp_f32 v39, v39
    v_exp_f32 v40, v40
    v_exp_f32 v41, v41
    v_exp_f32 v42, v42
    v_exp_f32 v43, v43
    v_exp_f32 v44, v44
    v_add_u32_e64 v25, s52, 2
    ds_write_b128 v3, v[16:19] offset:10240
    ds_write_b128 v3, v[20:23] offset:11264
    ds_write_b64 v4, v[24:25] offset:12288
    v_mov_b64 v[16:17], 0
    v_mov_b64 v[18:19], 0
    v_mov_b64 v[20:21], 0
    v_mov_b64 v[22:23], 0
    v_mov_b32 v24, 0
    v_exp_f32 v45, v45
    v_exp_f32 v46, v46
    v_smfmac_f32_32x32x32_bf16 v[16:31], v[128:131], v[32:39], v1
    v_exp_f32 v47, v47
    v_exp_f32 v48, v48
    v_exp_f32 v49, v49
    v_smfmac_f32_32x32x32_bf16 v[16:31], v[132:135], v[40:47], v1
    v_exp_f32 v50, v50
    v_exp_f32 v51, v51
    v_exp_f32 v52, v52
    v_mfma_f32_32x32x16_bf16 v[32:47], v[72:75], v[8:11], 0
    v_exp_f32 v53, v53
    v_exp_f32 v54, v54
    v_exp_f32 v55, v55
    v_exp_f32 v56, v56
    v_exp_f32 v57, v57
    v_smfmac_f32_32x32x32_bf16 v[16:31], v[136:139], v[48:55], v1
    v_exp_f32 v58, v58
    v_exp_f32 v59, v59
    v_exp_f32 v60, v60
    v_exp_f32 v61, v61
    v_exp_f32 v62, v62
    v_exp_f32 v63, v63
    v_exp_f32 v32, v32
    v_exp_f32 v33, v33
    v_smfmac_f32_32x32x32_bf16 v[16:31], v[140:143], v[56:63], v1
    v_exp_f32 v34, v34
    v_exp_f32 v35, v35
    v_exp_f32 v36, v36
    v_mfma_f32_32x32x16_bf16 v[48:63], v[76:79], v[8:11], 0
    v_exp_f32 v37, v37
    v_exp_f32 v38, v38
    v_exp_f32 v39, v39
    v_exp_f32 v40, v40
    v_exp_f32 v41, v41
    v_smfmac_f32_32x32x32_bf16 v[16:31], v[144:147], v[32:39], v1
    v_exp_f32 v42, v42
    v_exp_f32 v43, v43
    v_exp_f32 v44, v44
    v_exp_f32 v45, v45
    v_exp_f32 v46, v46
    v_exp_f32 v47, v47
    v_exp_f32 v48, v48
    v_exp_f32 v49, v49
    v_smfmac_f32_32x32x32_bf16 v[16:31], v[148:151], v[40:47], v1
    v_exp_f32 v50, v50
    v_exp_f32 v51, v51
    v_exp_f32 v52, v52
    v_mfma_f32_32x32x16_bf16 v[32:47], v[80:83], v[8:11], 0
    v_exp_f32 v53, v53
    v_exp_f32 v54, v54
    v_exp_f32 v55, v55
    v_exp_f32 v56, v56
    v_exp_f32 v57, v57
    v_smfmac_f32_32x32x32_bf16 v[16:31], v[152:155], v[48:55], v1
    v_exp_f32 v58, v58
    v_exp_f32 v59, v59
    v_exp_f32 v60, v60
    v_exp_f32 v61, v61
    v_exp_f32 v62, v62
    v_exp_f32 v63, v63
    v_exp_f32 v32, v32
    v_exp_f32 v33, v33
    v_smfmac_f32_32x32x32_bf16 v[16:31], v[156:159], v[56:63], v1
    v_exp_f32 v34, v34
    v_exp_f32 v35, v35
    v_exp_f32 v36, v36
    v_mfma_f32_32x32x16_bf16 v[48:63], v[84:87], v[8:11], 0
    v_exp_f32 v37, v37
    v_exp_f32 v38, v38
    v_exp_f32 v39, v39
    v_exp_f32 v40, v40
    v_exp_f32 v41, v41
    v_smfmac_f32_32x32x32_bf16 v[16:31], v[160:163], v[32:39], v1
    v_exp_f32 v42, v42
    v_exp_f32 v43, v43
    v_exp_f32 v44, v44
    v_exp_f32 v45, v45
    v_exp_f32 v46, v46
    v_exp_f32 v47, v47
    v_exp_f32 v48, v48
    v_exp_f32 v49, v49
    v_smfmac_f32_32x32x32_bf16 v[16:31], v[164:167], v[40:47], v1
    v_exp_f32 v50, v50
    v_exp_f32 v51, v51
    v_exp_f32 v52, v52
    v_mfma_f32_32x32x16_bf16 v[32:47], v[88:91], v[8:11], 0
    v_exp_f32 v53, v53
    v_exp_f32 v54, v54
    v_exp_f32 v55, v55
    v_exp_f32 v56, v56
    v_exp_f32 v57, v57
    v_smfmac_f32_32x32x32_bf16 v[16:31], v[168:171], v[48:55], v1
    v_exp_f32 v58, v58
    v_exp_f32 v59, v59
    v_exp_f32 v60, v60
    v_exp_f32 v61, v61
    v_exp_f32 v62, v62
    v_exp_f32 v63, v63
    v_exp_f32 v32, v32
    v_exp_f32 v33, v33
    v_smfmac_f32_32x32x32_bf16 v[16:31], v[172:175], v[56:63], v1
    v_exp_f32 v34, v34
    v_exp_f32 v35, v35
    v_exp_f32 v36, v36
    v_mfma_f32_32x32x16_bf16 v[48:63], v[92:95], v[8:11], 0
    v_exp_f32 v37, v37
    v_exp_f32 v38, v38
    v_exp_f32 v39, v39
    v_exp_f32 v40, v40
    v_exp_f32 v41, v41
    v_smfmac_f32_32x32x32_bf16 v[16:31], v[176:179], v[32:39], v1
    v_exp_f32 v42, v42
    v_exp_f32 v43, v43
    v_exp_f32 v44, v44
    v_exp_f32 v45, v45
    v_exp_f32 v46, v46
    v_exp_f32 v47, v47
    v_exp_f32 v48, v48
    v_exp_f32 v49, v49
    v_smfmac_f32_32x32x32_bf16 v[16:31], v[180:183], v[40:47], v1
    v_exp_f32 v50, v50
    v_exp_f32 v51, v51
    v_exp_f32 v52, v52
    v_mfma_f32_32x32x16_bf16 v[32:47], v[96:99], v[8:11], 0
    v_exp_f32 v53, v53
    v_exp_f32 v54, v54
    v_exp_f32 v55, v55
    v_exp_f32 v56, v56
    v_exp_f32 v57, v57
    v_smfmac_f32_32x32x32_bf16 v[16:31], v[184:187], v[48:55], v1
    v_exp_f32 v58, v58
    v_exp_f32 v59, v59
    v_exp_f32 v60, v60
    v_exp_f32 v61, v61
    v_exp_f32 v62, v62
    v_exp_f32 v63, v63
    v_exp_f32 v32, v32
    v_exp_f32 v33, v33
    v_smfmac_f32_32x32x32_bf16 v[16:31], v[188:191], v[56:63], v1
    v_exp_f32 v34, v34
    v_exp_f32 v35, v35
    v_exp_f32 v36, v36
    v_mfma_f32_32x32x16_bf16 v[48:63], v[100:103], v[8:11], 0
    v_exp_f32 v37, v37
    v_exp_f32 v38, v38
    v_exp_f32 v39, v39
    v_exp_f32 v40, v40
    v_exp_f32 v41, v41
    v_smfmac_f32_32x32x32_bf16 v[16:31], v[192:195], v[32:39], v1
    v_exp_f32 v42, v42
    v_exp_f32 v43, v43
    v_exp_f32 v44, v44
    v_exp_f32 v45, v45
    v_exp_f32 v46, v46
    v_exp_f32 v47, v47
    v_exp_f32 v48, v48
    v_exp_f32 v49, v49
    v_smfmac_f32_32x32x32_bf16 v[16:31], v[196:199], v[40:47], v1
    v_exp_f32 v50, v50
    v_exp_f32 v51, v51
    v_exp_f32 v52, v52
    v_mfma_f32_32x32x16_bf16 v[32:47], v[104:107], v[8:11], 0
    v_exp_f32 v53, v53
    v_exp_f32 v54, v54
    v_exp_f32 v55, v55
    v_exp_f32 v56, v56
    v_exp_f32 v57, v57
    v_smfmac_f32_32x32x32_bf16 v[16:31], v[200:203], v[48:55], v1
    v_exp_f32 v58, v58
    v_exp_f32 v59, v59
    v_exp_f32 v60, v60
    v_exp_f32 v61, v61
    v_exp_f32 v62, v62
    v_exp_f32 v63, v63
    v_exp_f32 v32, v32
    v_exp_f32 v33, v33
    v_smfmac_f32_32x32x32_bf16 v[16:31], v[204:207], v[56:63], v1
    v_exp_f32 v34, v34
    v_exp_f32 v35, v35
    v_exp_f32 v36, v36
    v_mfma_f32_32x32x16_bf16 v[48:63], v[108:111], v[8:11], 0
    v_exp_f32 v37, v37
    v_exp_f32 v38, v38
    v_exp_f32 v39, v39
    v_exp_f32 v40, v40
    v_exp_f32 v41, v41
    v_smfmac_f32_32x32x32_bf16 v[16:31], v[208:211], v[32:39], v1
    v_exp_f32 v42, v42
    v_exp_f32 v43, v43
    v_exp_f32 v44, v44
    v_exp_f32 v45, v45
    v_exp_f32 v46, v46
    v_exp_f32 v47, v47
    v_exp_f32 v48, v48
    v_exp_f32 v49, v49
    v_smfmac_f32_32x32x32_bf16 v[16:31], v[212:215], v[40:47], v1
    v_exp_f32 v50, v50
    v_exp_f32 v51, v51
    v_exp_f32 v52, v52
    v_mfma_f32_32x32x16_bf16 v[32:47], v[112:115], v[8:11], 0
    v_exp_f32 v53, v53
    v_exp_f32 v54, v54
    v_exp_f32 v55, v55
    v_exp_f32 v56, v56
    v_exp_f32 v57, v57
    v_smfmac_f32_32x32x32_bf16 v[16:31], v[216:219], v[48:55], v1
    v_exp_f32 v58, v58
    v_exp_f32 v59, v59
    v_exp_f32 v60, v60
    v_exp_f32 v61, v61
    v_exp_f32 v62, v62
    v_exp_f32 v63, v63
    v_exp_f32 v32, v32
    v_exp_f32 v33, v33
    v_smfmac_f32_32x32x32_bf16 v[16:31], v[220:223], v[56:63], v1
    v_exp_f32 v34, v34
    v_exp_f32 v35, v35
    v_exp_f32 v36, v36
    v_mfma_f32_32x32x16_bf16 v[48:63], v[116:119], v[8:11], 0
    v_exp_f32 v37, v37
    v_exp_f32 v38, v38
    v_exp_f32 v39, v39
    v_exp_f32 v40, v40
    v_exp_f32 v41, v41
    v_smfmac_f32_32x32x32_bf16 v[16:31], v[224:227], v[32:39], v1
    v_exp_f32 v42, v42
    v_exp_f32 v43, v43
    v_exp_f32 v44, v44
    v_exp_f32 v45, v45
    v_exp_f32 v46, v46
    v_exp_f32 v47, v47
    v_exp_f32 v48, v48
    v_exp_f32 v49, v49
    v_smfmac_f32_32x32x32_bf16 v[16:31], v[228:231], v[40:47], v1
    v_exp_f32 v50, v50
    v_exp_f32 v51, v51
    v_exp_f32 v52, v52
    v_mfma_f32_32x32x16_bf16 v[32:47], v[120:123], v[8:11], 0
    v_exp_f32 v53, v53
    v_exp_f32 v54, v54
    v_exp_f32 v55, v55
    v_exp_f32 v56, v56
    v_exp_f32 v57, v57
    v_smfmac_f32_32x32x32_bf16 v[16:31], v[232:235], v[48:55], v1
    v_exp_f32 v58, v58
    v_exp_f32 v59, v59
    v_exp_f32 v60, v60
    v_exp_f32 v61, v61
    v_exp_f32 v62, v62
    v_exp_f32 v63, v63
    v_exp_f32 v32, v32
    v_exp_f32 v33, v33
    v_smfmac_f32_32x32x32_bf16 v[16:31], v[236:239], v[56:63], v1
    v_exp_f32 v34, v34
    v_exp_f32 v35, v35
    v_exp_f32 v36, v36
    v_mfma_f32_32x32x16_bf16 v[48:63], v[124:127], v[8:11], 0
    ds_read_b128 v[8:11], v14 offset:3072
    v_exp_f32 v37, v37
    v_exp_f32 v38, v38
    v_exp_f32 v39, v39
    v_exp_f32 v40, v40
    v_exp_f32 v41, v41
    v_smfmac_f32_32x32x32_bf16 v[16:31], v[240:243], v[32:39], v1
    v_exp_f32 v42, v42
    v_exp_f32 v43, v43
    v_exp_f32 v44, v44
    v_exp_f32 v45, v45
    v_exp_f32 v46, v46
    v_exp_f32 v47, v47
    v_exp_f32 v48, v48
    v_exp_f32 v49, v49
    v_smfmac_f32_32x32x32_bf16 v[16:31], v[244:247], v[40:47], v1
    v_exp_f32 v50, v50
    v_exp_f32 v51, v51
    v_exp_f32 v52, v52
    s_waitcnt lgkmcnt(0)
    v_mfma_f32_32x32x16_bf16 v[32:47], v[64:67], v[8:11], 0
    v_exp_f32 v53, v53
    v_exp_f32 v54, v54
    v_exp_f32 v55, v55
    v_exp_f32 v56, v56
    v_exp_f32 v57, v57
    v_smfmac_f32_32x32x32_bf16 v[16:31], v[248:251], v[48:55], v1
    v_exp_f32 v58, v58
    v_exp_f32 v59, v59
    v_exp_f32 v60, v60
    v_exp_f32 v61, v61
    v_exp_f32 v62, v62
    v_exp_f32 v63, v63
    v_exp_f32 v32, v32
    v_exp_f32 v33, v33
    v_smfmac_f32_32x32x32_bf16 v[16:31], v[252:255], v[56:63], v1
    v_exp_f32 v34, v34
    v_exp_f32 v35, v35
    v_exp_f32 v36, v36
    v_mfma_f32_32x32x16_bf16 v[48:63], v[68:71], v[8:11], 0
    v_exp_f32 v37, v37
    v_exp_f32 v38, v38
    v_exp_f32 v39, v39
    v_exp_f32 v40, v40
    v_exp_f32 v41, v41
    v_exp_f32 v42, v42
    v_exp_f32 v43, v43
    v_exp_f32 v44, v44
    v_add_u32_e64 v25, s52, 3
    ds_write_b128 v3, v[16:19] offset:20480
    ds_write_b128 v3, v[20:23] offset:21504
    ds_write_b64 v4, v[24:25] offset:22528
    v_mov_b64 v[16:17], 0
    v_mov_b64 v[18:19], 0
    v_mov_b64 v[20:21], 0
    v_mov_b64 v[22:23], 0
    v_mov_b32 v24, 0
    v_exp_f32 v45, v45
    v_exp_f32 v46, v46
    v_smfmac_f32_32x32x32_bf16 v[16:31], v[128:131], v[32:39], v1
    v_exp_f32 v47, v47
    v_exp_f32 v48, v48
    v_exp_f32 v49, v49
    v_smfmac_f32_32x32x32_bf16 v[16:31], v[132:135], v[40:47], v1
    v_exp_f32 v50, v50
    v_exp_f32 v51, v51
    v_exp_f32 v52, v52
    v_mfma_f32_32x32x16_bf16 v[32:47], v[72:75], v[8:11], 0
    v_exp_f32 v53, v53
    v_exp_f32 v54, v54
    v_exp_f32 v55, v55
    v_exp_f32 v56, v56
    v_exp_f32 v57, v57
    v_smfmac_f32_32x32x32_bf16 v[16:31], v[136:139], v[48:55], v1
    v_exp_f32 v58, v58
    v_exp_f32 v59, v59
    v_exp_f32 v60, v60
    v_exp_f32 v61, v61
    v_exp_f32 v62, v62
    v_exp_f32 v63, v63
    v_exp_f32 v32, v32
    v_exp_f32 v33, v33
    v_smfmac_f32_32x32x32_bf16 v[16:31], v[140:143], v[56:63], v1
    v_exp_f32 v34, v34
    v_exp_f32 v35, v35
    v_exp_f32 v36, v36
    v_mfma_f32_32x32x16_bf16 v[48:63], v[76:79], v[8:11], 0
    v_exp_f32 v37, v37
    v_exp_f32 v38, v38
    v_exp_f32 v39, v39
    v_exp_f32 v40, v40
    v_exp_f32 v41, v41
    v_smfmac_f32_32x32x32_bf16 v[16:31], v[144:147], v[32:39], v1
    v_exp_f32 v42, v42
    v_exp_f32 v43, v43
    v_exp_f32 v44, v44
    v_exp_f32 v45, v45
    v_exp_f32 v46, v46
    v_exp_f32 v47, v47
    v_exp_f32 v48, v48
    v_exp_f32 v49, v49
    v_smfmac_f32_32x32x32_bf16 v[16:31], v[148:151], v[40:47], v1
    v_exp_f32 v50, v50
    v_exp_f32 v51, v51
    v_exp_f32 v52, v52
    v_mfma_f32_32x32x16_bf16 v[32:47], v[80:83], v[8:11], 0
    v_exp_f32 v53, v53
    v_exp_f32 v54, v54
    v_exp_f32 v55, v55
    v_exp_f32 v56, v56
    v_exp_f32 v57, v57
    v_smfmac_f32_32x32x32_bf16 v[16:31], v[152:155], v[48:55], v1
    v_exp_f32 v58, v58
    v_exp_f32 v59, v59
    v_exp_f32 v60, v60
    v_exp_f32 v61, v61
    v_exp_f32 v62, v62
    v_exp_f32 v63, v63
    v_exp_f32 v32, v32
    v_exp_f32 v33, v33
    v_smfmac_f32_32x32x32_bf16 v[16:31], v[156:159], v[56:63], v1
    v_exp_f32 v34, v34
    v_exp_f32 v35, v35
    v_exp_f32 v36, v36
    v_mfma_f32_32x32x16_bf16 v[48:63], v[84:87], v[8:11], 0
    v_exp_f32 v37, v37
    v_exp_f32 v38, v38
    v_exp_f32 v39, v39
    v_exp_f32 v40, v40
    v_exp_f32 v41, v41
    v_smfmac_f32_32x32x32_bf16 v[16:31], v[160:163], v[32:39], v1
    v_exp_f32 v42, v42
    v_exp_f32 v43, v43
    v_exp_f32 v44, v44
    v_exp_f32 v45, v45
    v_exp_f32 v46, v46
    v_exp_f32 v47, v47
    v_exp_f32 v48, v48
    v_exp_f32 v49, v49
    v_smfmac_f32_32x32x32_bf16 v[16:31], v[164:167], v[40:47], v1
    v_exp_f32 v50, v50
    v_exp_f32 v51, v51
    v_exp_f32 v52, v52
    v_mfma_f32_32x32x16_bf16 v[32:47], v[88:91], v[8:11], 0
    v_exp_f32 v53, v53
    v_exp_f32 v54, v54
    v_exp_f32 v55, v55
    v_exp_f32 v56, v56
    v_exp_f32 v57, v57
    v_smfmac_f32_32x32x32_bf16 v[16:31], v[168:171], v[48:55], v1
    v_exp_f32 v58, v58
    v_exp_f32 v59, v59
    v_exp_f32 v60, v60
    v_exp_f32 v61, v61
    v_exp_f32 v62, v62
    v_exp_f32 v63, v63
    v_exp_f32 v32, v32
    v_exp_f32 v33, v33
    v_smfmac_f32_32x32x32_bf16 v[16:31], v[172:175], v[56:63], v1
    v_exp_f32 v34, v34
    v_exp_f32 v35, v35
    v_exp_f32 v36, v36
    v_mfma_f32_32x32x16_bf16 v[48:63], v[92:95], v[8:11], 0
    v_exp_f32 v37, v37
    v_exp_f32 v38, v38
    v_exp_f32 v39, v39
    v_exp_f32 v40, v40
    v_exp_f32 v41, v41
    v_smfmac_f32_32x32x32_bf16 v[16:31], v[176:179], v[32:39], v1
    v_exp_f32 v42, v42
    v_exp_f32 v43, v43
    v_exp_f32 v44, v44
    v_exp_f32 v45, v45
    v_exp_f32 v46, v46
    v_exp_f32 v47, v47
    v_exp_f32 v48, v48
    v_exp_f32 v49, v49
    v_smfmac_f32_32x32x32_bf16 v[16:31], v[180:183], v[40:47], v1
    v_exp_f32 v50, v50
    v_exp_f32 v51, v51
    v_exp_f32 v52, v52
    v_mfma_f32_32x32x16_bf16 v[32:47], v[96:99], v[8:11], 0
    v_exp_f32 v53, v53
    v_exp_f32 v54, v54
    v_exp_f32 v55, v55
    v_exp_f32 v56, v56
    v_exp_f32 v57, v57
    v_smfmac_f32_32x32x32_bf16 v[16:31], v[184:187], v[48:55], v1
    v_exp_f32 v58, v58
    v_exp_f32 v59, v59
    v_exp_f32 v60, v60
    v_exp_f32 v61, v61
    v_exp_f32 v62, v62
    v_exp_f32 v63, v63
    v_exp_f32 v32, v32
    v_exp_f32 v33, v33
    v_smfmac_f32_32x32x32_bf16 v[16:31], v[188:191], v[56:63], v1
    v_exp_f32 v34, v34
    v_exp_f32 v35, v35
    v_exp_f32 v36, v36
    v_mfma_f32_32x32x16_bf16 v[48:63], v[100:103], v[8:11], 0
    v_exp_f32 v37, v37
    v_exp_f32 v38, v38
    v_exp_f32 v39, v39
    v_exp_f32 v40, v40
    v_exp_f32 v41, v41
    v_smfmac_f32_32x32x32_bf16 v[16:31], v[192:195], v[32:39], v1
    v_exp_f32 v42, v42
    v_exp_f32 v43, v43
    v_exp_f32 v44, v44
    v_exp_f32 v45, v45
    v_exp_f32 v46, v46
    v_exp_f32 v47, v47
    v_exp_f32 v48, v48
    v_exp_f32 v49, v49
    v_smfmac_f32_32x32x32_bf16 v[16:31], v[196:199], v[40:47], v1
    v_exp_f32 v50, v50
    v_exp_f32 v51, v51
    v_exp_f32 v52, v52
    v_mfma_f32_32x32x16_bf16 v[32:47], v[104:107], v[8:11], 0
    v_exp_f32 v53, v53
    v_exp_f32 v54, v54
    v_exp_f32 v55, v55
    v_exp_f32 v56, v56
    v_exp_f32 v57, v57
    v_smfmac_f32_32x32x32_bf16 v[16:31], v[200:203], v[48:55], v1
    v_exp_f32 v58, v58
    v_exp_f32 v59, v59
    v_exp_f32 v60, v60
    v_exp_f32 v61, v61
    v_exp_f32 v62, v62
    v_exp_f32 v63, v63
    v_exp_f32 v32, v32
    v_exp_f32 v33, v33
    v_smfmac_f32_32x32x32_bf16 v[16:31], v[204:207], v[56:63], v1
    v_exp_f32 v34, v34
    v_exp_f32 v35, v35
    v_exp_f32 v36, v36
    v_mfma_f32_32x32x16_bf16 v[48:63], v[108:111], v[8:11], 0
    v_exp_f32 v37, v37
    v_exp_f32 v38, v38
    v_exp_f32 v39, v39
    v_exp_f32 v40, v40
    v_exp_f32 v41, v41
    v_smfmac_f32_32x32x32_bf16 v[16:31], v[208:211], v[32:39], v1
    v_exp_f32 v42, v42
    v_exp_f32 v43, v43
    v_exp_f32 v44, v44
    v_exp_f32 v45, v45
    v_exp_f32 v46, v46
    v_exp_f32 v47, v47
    v_exp_f32 v48, v48
    v_exp_f32 v49, v49
    v_smfmac_f32_32x32x32_bf16 v[16:31], v[212:215], v[40:47], v1
    v_exp_f32 v50, v50
    v_exp_f32 v51, v51
    v_exp_f32 v52, v52
    v_mfma_f32_32x32x16_bf16 v[32:47], v[112:115], v[8:11], 0
    v_exp_f32 v53, v53
    v_exp_f32 v54, v54
    v_exp_f32 v55, v55
    v_exp_f32 v56, v56
    v_exp_f32 v57, v57
    v_smfmac_f32_32x32x32_bf16 v[16:31], v[216:219], v[48:55], v1
    v_exp_f32 v58, v58
    v_exp_f32 v59, v59
    v_exp_f32 v60, v60
    v_exp_f32 v61, v61
    v_exp_f32 v62, v62
    v_exp_f32 v63, v63
    v_exp_f32 v32, v32
    v_exp_f32 v33, v33
    v_smfmac_f32_32x32x32_bf16 v[16:31], v[220:223], v[56:63], v1
    v_exp_f32 v34, v34
    v_exp_f32 v35, v35
    v_exp_f32 v36, v36
    v_mfma_f32_32x32x16_bf16 v[48:63], v[116:119], v[8:11], 0
    v_exp_f32 v37, v37
    v_exp_f32 v38, v38
    v_exp_f32 v39, v39
    v_exp_f32 v40, v40
    v_exp_f32 v41, v41
    v_smfmac_f32_32x32x32_bf16 v[16:31], v[224:227], v[32:39], v1
    v_exp_f32 v42, v42
    v_exp_f32 v43, v43
    v_exp_f32 v44, v44
    v_exp_f32 v45, v45
    v_exp_f32 v46, v46
    v_exp_f32 v47, v47
    v_exp_f32 v48, v48
    v_exp_f32 v49, v49
    v_smfmac_f32_32x32x32_bf16 v[16:31], v[228:231], v[40:47], v1
    v_exp_f32 v50, v50
    v_exp_f32 v51, v51
    v_exp_f32 v52, v52
    v_mfma_f32_32x32x16_bf16 v[32:47], v[120:123], v[8:11], 0
    v_exp_f32 v53, v53
    v_exp_f32 v54, v54
    v_exp_f32 v55, v55
    v_exp_f32 v56, v56
    v_exp_f32 v57, v57
    v_smfmac_f32_32x32x32_bf16 v[16:31], v[232:235], v[48:55], v1
    v_exp_f32 v58, v58
    v_exp_f32 v59, v59
    v_exp_f32 v60, v60
    v_exp_f32 v61, v61
    v_exp_f32 v62, v62
    v_exp_f32 v63, v63
    v_exp_f32 v32, v32
    v_exp_f32 v33, v33
    v_smfmac_f32_32x32x32_bf16 v[16:31], v[236:239], v[56:63], v1
    v_exp_f32 v34, v34
    v_exp_f32 v35, v35
    v_exp_f32 v36, v36
    v_mfma_f32_32x32x16_bf16 v[48:63], v[124:127], v[8:11], 0
    ds_read_b128 v[8:11], v14 offset:4096
    ds_read_b32 v6, v5 offset:32
    v_exp_f32 v37, v37
    v_exp_f32 v38, v38
    v_exp_f32 v39, v39
    v_exp_f32 v40, v40
    v_exp_f32 v41, v41
    v_smfmac_f32_32x32x32_bf16 v[16:31], v[240:243], v[32:39], v1
    v_exp_f32 v42, v42
    v_exp_f32 v43, v43
    v_exp_f32 v44, v44
    v_exp_f32 v45, v45
    v_exp_f32 v46, v46
    v_exp_f32 v47, v47
    v_exp_f32 v48, v48
    v_exp_f32 v49, v49
    v_smfmac_f32_32x32x32_bf16 v[16:31], v[244:247], v[40:47], v1
    v_exp_f32 v50, v50
    v_exp_f32 v51, v51
    v_exp_f32 v52, v52
    s_waitcnt lgkmcnt(0)
    v_cmp_eq_u32 vcc, 0, v6
    v_mfma_f32_32x32x16_bf16 v[32:47], v[64:67], v[8:11], 0
    v_exp_f32 v53, v53
    v_exp_f32 v54, v54
    v_exp_f32 v55, v55
    v_exp_f32 v56, v56
    v_exp_f32 v57, v57
    v_smfmac_f32_32x32x32_bf16 v[16:31], v[248:251], v[48:55], v1
    v_exp_f32 v58, v58
    v_exp_f32 v59, v59
    v_exp_f32 v60, v60
    v_exp_f32 v61, v61
    v_exp_f32 v62, v62
    v_exp_f32 v63, v63
    v_exp_f32 v32, v32
    v_exp_f32 v33, v33
    v_smfmac_f32_32x32x32_bf16 v[16:31], v[252:255], v[56:63], v1
    v_exp_f32 v34, v34
    v_exp_f32 v35, v35
    v_exp_f32 v36, v36
    v_mfma_f32_32x32x16_bf16 v[48:63], v[68:71], v[8:11], 0
    v_exp_f32 v37, v37
    v_exp_f32 v38, v38
    v_exp_f32 v39, v39
    v_exp_f32 v40, v40
    v_exp_f32 v41, v41
    v_exp_f32 v42, v42
    v_exp_f32 v43, v43
    v_exp_f32 v44, v44
    s_cbranch_vccnz L_war_4
L_warb_5:
    v_add_u32_e64 v25, s52, 4
    ds_write_b128 v3, v[16:19] offset:0
    ds_write_b128 v3, v[20:23] offset:1024
    ds_write_b64 v4, v[24:25] offset:2048
    v_mov_b64 v[16:17], 0
    v_mov_b64 v[18:19], 0
    v_mov_b64 v[20:21], 0
    v_mov_b64 v[22:23], 0
    v_mov_b32 v24, 0
    v_exp_f32 v45, v45
    v_exp_f32 v46, v46
    v_smfmac_f32_32x32x32_bf16 v[16:31], v[128:131], v[32:39], v1
    v_exp_f32 v47, v47
    v_exp_f32 v48, v48
    v_exp_f32 v49, v49
    v_smfmac_f32_32x32x32_bf16 v[16:31], v[132:135], v[40:47], v1
    v_exp_f32 v50, v50
    v_exp_f32 v51, v51
    v_exp_f32 v52, v52
    v_mfma_f32_32x32x16_bf16 v[32:47], v[72:75], v[8:11], 0
    v_exp_f32 v53, v53
    v_exp_f32 v54, v54
    v_exp_f32 v55, v55
    v_exp_f32 v56, v56
    v_exp_f32 v57, v57
    v_smfmac_f32_32x32x32_bf16 v[16:31], v[136:139], v[48:55], v1
    v_exp_f32 v58, v58
    v_exp_f32 v59, v59
    v_exp_f32 v60, v60
    v_exp_f32 v61, v61
    v_exp_f32 v62, v62
    v_exp_f32 v63, v63
    v_exp_f32 v32, v32
    v_exp_f32 v33, v33
    v_smfmac_f32_32x32x32_bf16 v[16:31], v[140:143], v[56:63], v1
    v_exp_f32 v34, v34
    v_exp_f32 v35, v35
    v_exp_f32 v36, v36
    v_mfma_f32_32x32x16_bf16 v[48:63], v[76:79], v[8:11], 0
    v_exp_f32 v37, v37
    v_exp_f32 v38, v38
    v_exp_f32 v39, v39
    v_exp_f32 v40, v40
    v_exp_f32 v41, v41
    v_smfmac_f32_32x32x32_bf16 v[16:31], v[144:147], v[32:39], v1
    v_exp_f32 v42, v42
    v_exp_f32 v43, v43
    v_exp_f32 v44, v44
    v_exp_f32 v45, v45
    v_exp_f32 v46, v46
    v_exp_f32 v47, v47
    v_exp_f32 v48, v48
    v_exp_f32 v49, v49
    v_smfmac_f32_32x32x32_bf16 v[16:31], v[148:151], v[40:47], v1
    v_exp_f32 v50, v50
    v_exp_f32 v51, v51
    v_exp_f32 v52, v52
    v_mfma_f32_32x32x16_bf16 v[32:47], v[80:83], v[8:11], 0
    v_exp_f32 v53, v53
    v_exp_f32 v54, v54
    v_exp_f32 v55, v55
    v_exp_f32 v56, v56
    v_exp_f32 v57, v57
    v_smfmac_f32_32x32x32_bf16 v[16:31], v[152:155], v[48:55], v1
    v_exp_f32 v58, v58
    v_exp_f32 v59, v59
    v_exp_f32 v60, v60
    v_exp_f32 v61, v61
    v_exp_f32 v62, v62
    v_exp_f32 v63, v63
    v_exp_f32 v32, v32
    v_exp_f32 v33, v33
    v_smfmac_f32_32x32x32_bf16 v[16:31], v[156:159], v[56:63], v1
    v_exp_f32 v34, v34
    v_exp_f32 v35, v35
    v_exp_f32 v36, v36
    v_mfma_f32_32x32x16_bf16 v[48:63], v[84:87], v[8:11], 0
    v_exp_f32 v37, v37
    v_exp_f32 v38, v38
    v_exp_f32 v39, v39
    v_exp_f32 v40, v40
    v_exp_f32 v41, v41
    v_smfmac_f32_32x32x32_bf16 v[16:31], v[160:163], v[32:39], v1
    v_exp_f32 v42, v42
    v_exp_f32 v43, v43
    v_exp_f32 v44, v44
    v_exp_f32 v45, v45
    v_exp_f32 v46, v46
    v_exp_f32 v47, v47
    v_exp_f32 v48, v48
    v_exp_f32 v49, v49
    v_smfmac_f32_32x32x32_bf16 v[16:31], v[164:167], v[40:47], v1
    v_exp_f32 v50, v50
    v_exp_f32 v51, v51
    v_exp_f32 v52, v52
    v_mfma_f32_32x32x16_bf16 v[32:47], v[88:91], v[8:11], 0
    v_exp_f32 v53, v53
    v_exp_f32 v54, v54
    v_exp_f32 v55, v55
    v_exp_f32 v56, v56
    v_exp_f32 v57, v57
    v_smfmac_f32_32x32x32_bf16 v[16:31], v[168:171], v[48:55], v1
    v_exp_f32 v58, v58
    v_exp_f32 v59, v59
    v_exp_f32 v60, v60
    v_exp_f32 v61, v61
    v_exp_f32 v62, v62
    v_exp_f32 v63, v63
    v_exp_f32 v32, v32
    v_exp_f32 v33, v33
    v_smfmac_f32_32x32x32_bf16 v[16:31], v[172:175], v[56:63], v1
    v_exp_f32 v34, v34
    v_exp_f32 v35, v35
    v_exp_f32 v36, v36
    v_mfma_f32_32x32x16_bf16 v[48:63], v[92:95], v[8:11], 0
    v_exp_f32 v37, v37
    v_exp_f32 v38, v38
    v_exp_f32 v39, v39
    v_exp_f32 v40, v40
    v_exp_f32 v41, v41
    v_smfmac_f32_32x32x32_bf16 v[16:31], v[176:179], v[32:39], v1
    v_exp_f32 v42, v42
    v_exp_f32 v43, v43
    v_exp_f32 v44, v44
    v_exp_f32 v45, v45
    v_exp_f32 v46, v46
    v_exp_f32 v47, v47
    v_exp_f32 v48, v48
    v_exp_f32 v49, v49
    v_smfmac_f32_32x32x32_bf16 v[16:31], v[180:183], v[40:47], v1
    v_exp_f32 v50, v50
    v_exp_f32 v51, v51
    v_exp_f32 v52, v52
    v_mfma_f32_32x32x16_bf16 v[32:47], v[96:99], v[8:11], 0
    v_exp_f32 v53, v53
    v_exp_f32 v54, v54
    v_exp_f32 v55, v55
    v_exp_f32 v56, v56
    v_exp_f32 v57, v57
    v_smfmac_f32_32x32x32_bf16 v[16:31], v[184:187], v[48:55], v1
    v_exp_f32 v58, v58
    v_exp_f32 v59, v59
    v_exp_f32 v60, v60
    v_exp_f32 v61, v61
    v_exp_f32 v62, v62
    v_exp_f32 v63, v63
    v_exp_f32 v32, v32
    v_exp_f32 v33, v33
    v_smfmac_f32_32x32x32_bf16 v[16:31], v[188:191], v[56:63], v1
    v_exp_f32 v34, v34
    v_exp_f32 v35, v35
    v_exp_f32 v36, v36
    v_mfma_f32_32x32x16_bf16 v[48:63], v[100:103], v[8:11], 0
    v_exp_f32 v37, v37
    v_exp_f32 v38, v38
    v_exp_f32 v39, v39
    v_exp_f32 v40, v40
    v_exp_f32 v41, v41
    v_smfmac_f32_32x32x32_bf16 v[16:31], v[192:195], v[32:39], v1
    v_exp_f32 v42, v42
    v_exp_f32 v43, v43
    v_exp_f32 v44, v44
    v_exp_f32 v45, v45
    v_exp_f32 v46, v46
    v_exp_f32 v47, v47
    v_exp_f32 v48, v48
    v_exp_f32 v49, v49
    v_smfmac_f32_32x32x32_bf16 v[16:31], v[196:199], v[40:47], v1
    v_exp_f32 v50, v50
    v_exp_f32 v51, v51
    v_exp_f32 v52, v52
    v_mfma_f32_32x32x16_bf16 v[32:47], v[104:107], v[8:11], 0
    v_exp_f32 v53, v53
    v_exp_f32 v54, v54
    v_exp_f32 v55, v55
    v_exp_f32 v56, v56
    v_exp_f32 v57, v57
    v_smfmac_f32_32x32x32_bf16 v[16:31], v[200:203], v[48:55], v1
    v_exp_f32 v58, v58
    v_exp_f32 v59, v59
    v_exp_f32 v60, v60
    v_exp_f32 v61, v61
    v_exp_f32 v62, v62
    v_exp_f32 v63, v63
    v_exp_f32 v32, v32
    v_exp_f32 v33, v33
    v_smfmac_f32_32x32x32_bf16 v[16:31], v[204:207], v[56:63], v1
    v_exp_f32 v34, v34
    v_exp_f32 v35, v35
    v_exp_f32 v36, v36
    v_mfma_f32_32x32x16_bf16 v[48:63], v[108:111], v[8:11], 0
    v_exp_f32 v37, v37
    v_exp_f32 v38, v38
    v_exp_f32 v39, v39
    v_exp_f32 v40, v40
    v_exp_f32 v41, v41
    v_smfmac_f32_32x32x32_bf16 v[16:31], v[208:211], v[32:39], v1
    v_exp_f32 v42, v42
    v_exp_f32 v43, v43
    v_exp_f32 v44, v44
    v_exp_f32 v45, v45
    v_exp_f32 v46, v46
    v_exp_f32 v47, v47
    v_exp_f32 v48, v48
    v_exp_f32 v49, v49
    v_smfmac_f32_32x32x32_bf16 v[16:31], v[212:215], v[40:47], v1
    v_exp_f32 v50, v50
    v_exp_f32 v51, v51
    v_exp_f32 v52, v52
    v_mfma_f32_32x32x16_bf16 v[32:47], v[112:115], v[8:11], 0
    v_exp_f32 v53, v53
    v_exp_f32 v54, v54
    v_exp_f32 v55, v55
    v_exp_f32 v56, v56
    v_exp_f32 v57, v57
    v_smfmac_f32_32x32x32_bf16 v[16:31], v[216:219], v[48:55], v1
    v_exp_f32 v58, v58
    v_exp_f32 v59, v59
    v_exp_f32 v60, v60
    v_exp_f32 v61, v61
    v_exp_f32 v62, v62
    v_exp_f32 v63, v63
    v_exp_f32 v32, v32
    v_exp_f32 v33, v33
    v_smfmac_f32_32x32x32_bf16 v[16:31], v[220:223], v[56:63], v1
    v_exp_f32 v34, v34
    v_exp_f32 v35, v35
    v_exp_f32 v36, v36
    v_mfma_f32_32x32x16_bf16 v[48:63], v[116:119], v[8:11], 0
    v_exp_f32 v37, v37
    v_exp_f32 v38, v38
    v_exp_f32 v39, v39
    v_exp_f32 v40, v40
    v_exp_f32 v41, v41
    v_smfmac_f32_32x32x32_bf16 v[16:31], v[224:227], v[32:39], v1
    v_exp_f32 v42, v42
    v_exp_f32 v43, v43
    v_exp_f32 v44, v44
    v_exp_f32 v45, v45
    v_exp_f32 v46, v46
    v_exp_f32 v47, v47
    v_exp_f32 v48, v48
    v_exp_f32 v49, v49
    v_smfmac_f32_32x32x32_bf16 v[16:31], v[228:231], v[40:47], v1
    v_exp_f32 v50, v50
    v_exp_f32 v51, v51
    v_exp_f32 v52, v52
    v_mfma_f32_32x32x16_bf16 v[32:47], v[120:123], v[8:11], 0
    v_exp_f32 v53, v53
    v_exp_f32 v54, v54
    v_exp_f32 v55, v55
    v_exp_f32 v56, v56
    v_exp_f32 v57, v57
    v_smfmac_f32_32x32x32_bf16 v[16:31], v[232:235], v[48:55], v1
    v_exp_f32 v58, v58
    v_exp_f32 v59, v59
    v_exp_f32 v60, v60
    v_exp_f32 v61, v61
    v_exp_f32 v62, v62
    v_exp_f32 v63, v63
    v_exp_f32 v32, v32
    v_exp_f32 v33, v33
    v_smfmac_f32_32x32x32_bf16 v[16:31], v[236:239], v[56:63], v1
    v_exp_f32 v34, v34
    v_exp_f32 v35, v35
    v_exp_f32 v36, v36
    v_mfma_f32_32x32x16_bf16 v[48:63], v[124:127], v[8:11], 0
    ds_read_b128 v[8:11], v14 offset:5120
    ds_read_b32 v6, v5 offset:36
    v_exp_f32 v37, v37
    v_exp_f32 v38, v38
    v_exp_f32 v39, v39
    v_exp_f32 v40, v40
    v_exp_f32 v41, v41
    v_smfmac_f32_32x32x32_bf16 v[16:31], v[240:243], v[32:39], v1
    v_exp_f32 v42, v42
    v_exp_f32 v43, v43
    v_exp_f32 v44, v44
    v_exp_f32 v45, v45
    v_exp_f32 v46, v46
    v_exp_f32 v47, v47
    v_exp_f32 v48, v48
    v_exp_f32 v49, v49
    v_smfmac_f32_32x32x32_bf16 v[16:31], v[244:247], v[40:47], v1
    v_exp_f32 v50, v50
    v_exp_f32 v51, v51
    v_exp_f32 v52, v52
    s_waitcnt lgkmcnt(0)
    v_cmp_eq_u32 vcc, 0, v6
    v_mfma_f32_32x32x16_bf16 v[32:47], v[64:67], v[8:11], 0
    v_exp_f32 v53, v53
    v_exp_f32 v54, v54
    v_exp_f32 v55, v55
    v_exp_f32 v56, v56
    v_exp_f32 v57, v57
    v_smfmac_f32_32x32x32_bf16 v[16:31], v[248:251], v[48:55], v1
    v_exp_f32 v58, v58
    v_exp_f32 v59, v59
    v_exp_f32 v60, v60
    v_exp_f32 v61, v61
    v_exp_f32 v62, v62
    v_exp_f32 v63, v63
    v_exp_f32 v32, v32
    v_exp_f32 v33, v33
    v_smfmac_f32_32x32x32_bf16 v[16:31], v[252:255], v[56:63], v1
    v_exp_f32 v34, v34
    v_exp_f32 v35, v35
    v_exp_f32 v36, v36
    v_mfma_f32_32x32x16_bf16 v[48:63], v[68:71], v[8:11], 0
    v_exp_f32 v37, v37
    v_exp_f32 v38, v38
    v_exp_f32 v39, v39
    v_exp_f32 v40, v40
    v_exp_f32 v41, v41
    v_exp_f32 v42, v42
    v_exp_f32 v43, v43
    v_exp_f32 v44, v44
    s_cbranch_vccnz L_war_6
L_warb_7:
    v_add_u32_e64 v25, s52, 5
    ds_write_b128 v3, v[16:19] offset:10240
    ds_write_b128 v3, v[20:23] offset:11264
    ds_write_b64 v4, v[24:25] offset:12288
    v_mov_b64 v[16:17], 0
    v_mov_b64 v[18:19], 0
    v_mov_b64 v[20:21], 0
    v_mov_b64 v[22:23], 0
    v_mov_b32 v24, 0
    v_exp_f32 v45, v45
    v_exp_f32 v46, v46
    v_smfmac_f32_32x32x32_bf16 v[16:31], v[128:131], v[32:39], v1
    v_exp_f32 v47, v47
    v_exp_f32 v48, v48
    v_exp_f32 v49, v49
    v_smfmac_f32_32x32x32_bf16 v[16:31], v[132:135], v[40:47], v1
    v_exp_f32 v50, v50
    v_exp_f32 v51, v51
    v_exp_f32 v52, v52
    v_mfma_f32_32x32x16_bf16 v[32:47], v[72:75], v[8:11], 0
    v_exp_f32 v53, v53
    v_exp_f32 v54, v54
    v_exp_f32 v55, v55
    v_exp_f32 v56, v56
    v_exp_f32 v57, v57
    v_smfmac_f32_32x32x32_bf16 v[16:31], v[136:139], v[48:55], v1
    v_exp_f32 v58, v58
    v_exp_f32 v59, v59
    v_exp_f32 v60, v60
    v_exp_f32 v61, v61
    v_exp_f32 v62, v62
    v_exp_f32 v63, v63
    v_exp_f32 v32, v32
    v_exp_f32 v33, v33
    v_smfmac_f32_32x32x32_bf16 v[16:31], v[140:143], v[56:63], v1
    v_exp_f32 v34, v34
    v_exp_f32 v35, v35
    v_exp_f32 v36, v36
    v_mfma_f32_32x32x16_bf16 v[48:63], v[76:79], v[8:11], 0
    v_exp_f32 v37, v37
    v_exp_f32 v38, v38
    v_exp_f32 v39, v39
    v_exp_f32 v40, v40
    v_exp_f32 v41, v41
    v_smfmac_f32_32x32x32_bf16 v[16:31], v[144:147], v[32:39], v1
    v_exp_f32 v42, v42
    v_exp_f32 v43, v43
    v_exp_f32 v44, v44
    v_exp_f32 v45, v45
    v_exp_f32 v46, v46
    v_exp_f32 v47, v47
    v_exp_f32 v48, v48
    v_exp_f32 v49, v49
    v_smfmac_f32_32x32x32_bf16 v[16:31], v[148:151], v[40:47], v1
    v_exp_f32 v50, v50
    v_exp_f32 v51, v51
    v_exp_f32 v52, v52
    v_mfma_f32_32x32x16_bf16 v[32:47], v[80:83], v[8:11], 0
    v_exp_f32 v53, v53
    v_exp_f32 v54, v54
    v_exp_f32 v55, v55
    v_exp_f32 v56, v56
    v_exp_f32 v57, v57
    v_smfmac_f32_32x32x32_bf16 v[16:31], v[152:155], v[48:55], v1
    v_exp_f32 v58, v58
    v_exp_f32 v59, v59
    v_exp_f32 v60, v60
    v_exp_f32 v61, v61
    v_exp_f32 v62, v62
    v_exp_f32 v63, v63
    v_exp_f32 v32, v32
    v_exp_f32 v33, v33
    v_smfmac_f32_32x32x32_bf16 v[16:31], v[156:159], v[56:63], v1
    v_exp_f32 v34, v34
    v_exp_f32 v35, v35
    v_exp_f32 v36, v36
    v_mfma_f32_32x32x16_bf16 v[48:63], v[84:87], v[8:11], 0
    v_exp_f32 v37, v37
    v_exp_f32 v38, v38
    v_exp_f32 v39, v39
    v_exp_f32 v40, v40
    v_exp_f32 v41, v41
    v_smfmac_f32_32x32x32_bf16 v[16:31], v[160:163], v[32:39], v1
    v_exp_f32 v42, v42
    v_exp_f32 v43, v43
    v_exp_f32 v44, v44
    v_exp_f32 v45, v45
    v_exp_f32 v46, v46
    v_exp_f32 v47, v47
    v_exp_f32 v48, v48
    v_exp_f32 v49, v49
    v_smfmac_f32_32x32x32_bf16 v[16:31], v[164:167], v[40:47], v1
    v_exp_f32 v50, v50
    v_exp_f32 v51, v51
    v_exp_f32 v52, v52
    v_mfma_f32_32x32x16_bf16 v[32:47], v[88:91], v[8:11], 0
    v_exp_f32 v53, v53
    v_exp_f32 v54, v54
    v_exp_f32 v55, v55
    v_exp_f32 v56, v56
    v_exp_f32 v57, v57
    v_smfmac_f32_32x32x32_bf16 v[16:31], v[168:171], v[48:55], v1
    v_exp_f32 v58, v58
    v_exp_f32 v59, v59
    v_exp_f32 v60, v60
    v_exp_f32 v61, v61
    v_exp_f32 v62, v62
    v_exp_f32 v63, v63
    v_exp_f32 v32, v32
    v_exp_f32 v33, v33
    v_smfmac_f32_32x32x32_bf16 v[16:31], v[172:175], v[56:63], v1
    v_exp_f32 v34, v34
    v_exp_f32 v35, v35
    v_exp_f32 v36, v36
    v_mfma_f32_32x32x16_bf16 v[48:63], v[92:95], v[8:11], 0
    v_exp_f32 v37, v37
    v_exp_f32 v38, v38
    v_exp_f32 v39, v39
    v_exp_f32 v40, v40
    v_exp_f32 v41, v41
    v_smfmac_f32_32x32x32_bf16 v[16:31], v[176:179], v[32:39], v1
    v_exp_f32 v42, v42
    v_exp_f32 v43, v43
    v_exp_f32 v44, v44
    v_exp_f32 v45, v45
    v_exp_f32 v46, v46
    v_exp_f32 v47, v47
    v_exp_f32 v48, v48
    v_exp_f32 v49, v49
    v_smfmac_f32_32x32x32_bf16 v[16:31], v[180:183], v[40:47], v1
    v_exp_f32 v50, v50
    v_exp_f32 v51, v51
    v_exp_f32 v52, v52
    v_mfma_f32_32x32x16_bf16 v[32:47], v[96:99], v[8:11], 0
    v_exp_f32 v53, v53
    v_exp_f32 v54, v54
    v_exp_f32 v55, v55
    v_exp_f32 v56, v56
    v_exp_f32 v57, v57
    v_smfmac_f32_32x32x32_bf16 v[16:31], v[184:187], v[48:55], v1
    v_exp_f32 v58, v58
    v_exp_f32 v59, v59
    v_exp_f32 v60, v60
    v_exp_f32 v61, v61
    v_exp_f32 v62, v62
    v_exp_f32 v63, v63
    v_exp_f32 v32, v32
    v_exp_f32 v33, v33
    v_smfmac_f32_32x32x32_bf16 v[16:31], v[188:191], v[56:63], v1
    v_exp_f32 v34, v34
    v_exp_f32 v35, v35
    v_exp_f32 v36, v36
    v_mfma_f32_32x32x16_bf16 v[48:63], v[100:103], v[8:11], 0
    v_exp_f32 v37, v37
    v_exp_f32 v38, v38
    v_exp_f32 v39, v39
    v_exp_f32 v40, v40
    v_exp_f32 v41, v41
    v_smfmac_f32_32x32x32_bf16 v[16:31], v[192:195], v[32:39], v1
    v_exp_f32 v42, v42
    v_exp_f32 v43, v43
    v_exp_f32 v44, v44
    v_exp_f32 v45, v45
    v_exp_f32 v46, v46
    v_exp_f32 v47, v47
    v_exp_f32 v48, v48
    v_exp_f32 v49, v49
    v_smfmac_f32_32x32x32_bf16 v[16:31], v[196:199], v[40:47], v1
    v_exp_f32 v50, v50
    v_exp_f32 v51, v51
    v_exp_f32 v52, v52
    v_mfma_f32_32x32x16_bf16 v[32:47], v[104:107], v[8:11], 0
    v_exp_f32 v53, v53
    v_exp_f32 v54, v54
    v_exp_f32 v55, v55
    v_exp_f32 v56, v56
    v_exp_f32 v57, v57
    v_smfmac_f32_32x32x32_bf16 v[16:31], v[200:203], v[48:55], v1
    v_exp_f32 v58, v58
    v_exp_f32 v59, v59
    v_exp_f32 v60, v60
    v_exp_f32 v61, v61
    v_exp_f32 v62, v62
    v_exp_f32 v63, v63
    v_exp_f32 v32, v32
    v_exp_f32 v33, v33
    v_smfmac_f32_32x32x32_bf16 v[16:31], v[204:207], v[56:63], v1
    v_exp_f32 v34, v34
    v_exp_f32 v35, v35
    v_exp_f32 v36, v36
    v_mfma_f32_32x32x16_bf16 v[48:63], v[108:111], v[8:11], 0
    v_exp_f32 v37, v37
    v_exp_f32 v38, v38
    v_exp_f32 v39, v39
    v_exp_f32 v40, v40
    v_exp_f32 v41, v41
    v_smfmac_f32_32x32x32_bf16 v[16:31], v[208:211], v[32:39], v1
    v_exp_f32 v42, v42
    v_exp_f32 v43, v43
    v_exp_f32 v44, v44
    v_exp_f32 v45, v45
    v_exp_f32 v46, v46
    v_exp_f32 v47, v47
    v_exp_f32 v48, v48
    v_exp_f32 v49, v49
    v_smfmac_f32_32x32x32_bf16 v[16:31], v[212:215], v[40:47], v1
    v_exp_f32 v50, v50
    v_exp_f32 v51, v51
    v_exp_f32 v52, v52
    v_mfma_f32_32x32x16_bf16 v[32:47], v[112:115], v[8:11], 0
    v_exp_f32 v53, v53
    v_exp_f32 v54, v54
    v_exp_f32 v55, v55
    v_exp_f32 v56, v56
    v_exp_f32 v57, v57
    v_smfmac_f32_32x32x32_bf16 v[16:31], v[216:219], v[48:55], v1
    v_exp_f32 v58, v58
    v_exp_f32 v59, v59
    v_exp_f32 v60, v60
    v_exp_f32 v61, v61
    v_exp_f32 v62, v62
    v_exp_f32 v63, v63
    v_exp_f32 v32, v32
    v_exp_f32 v33, v33
    v_smfmac_f32_32x32x32_bf16 v[16:31], v[220:223], v[56:63], v1
    v_exp_f32 v34, v34
    v_exp_f32 v35, v35
    v_exp_f32 v36, v36
    v_mfma_f32_32x32x16_bf16 v[48:63], v[116:119], v[8:11], 0
    v_exp_f32 v37, v37
    v_exp_f32 v38, v38
    v_exp_f32 v39, v39
    v_exp_f32 v40, v40
    v_exp_f32 v41, v41
    v_smfmac_f32_32x32x32_bf16 v[16:31], v[224:227], v[32:39], v1
    v_exp_f32 v42, v42
    v_exp_f32 v43, v43
    v_exp_f32 v44, v44
    v_exp_f32 v45, v45
    v_exp_f32 v46, v46
    v_exp_f32 v47, v47
    v_exp_f32 v48, v48
    v_exp_f32 v49, v49
    v_smfmac_f32_32x32x32_bf16 v[16:31], v[228:231], v[40:47], v1
    v_exp_f32 v50, v50
    v_exp_f32 v51, v51
    v_exp_f32 v52, v52
    v_mfma_f32_32x32x16_bf16 v[32:47], v[120:123], v[8:11], 0
    v_exp_f32 v53, v53
    v_exp_f32 v54, v54
    v_exp_f32 v55, v55
    v_exp_f32 v56, v56
    v_exp_f32 v57, v57
    v_smfmac_f32_32x32x32_bf16 v[16:31], v[232:235], v[48:55], v1
    v_exp_f32 v58, v58
    v_exp_f32 v59, v59
    v_exp_f32 v60, v60
    v_exp_f32 v61, v61
    v_exp_f32 v62, v62
    v_exp_f32 v63, v63
    v_exp_f32 v32, v32
    v_exp_f32 v33, v33
    v_smfmac_f32_32x32x32_bf16 v[16:31], v[236:239], v[56:63], v1
    v_exp_f32 v34, v34
    v_exp_f32 v35, v35
    v_exp_f32 v36, v36
    v_mfma_f32_32x32x16_bf16 v[48:63], v[124:127], v[8:11], 0
    ds_read_b128 v[8:11], v14 offset:6144
    ds_read_b32 v6, v5 offset:40
    v_exp_f32 v37, v37
    v_exp_f32 v38, v38
    v_exp_f32 v39, v39
    v_exp_f32 v40, v40
    v_exp_f32 v41, v41
    v_smfmac_f32_32x32x32_bf16 v[16:31], v[240:243], v[32:39], v1
    v_exp_f32 v42, v42
    v_exp_f32 v43, v43
    v_exp_f32 v44, v44
    v_exp_f32 v45, v45
    v_exp_f32 v46, v46
    v_exp_f32 v47, v47
    v_exp_f32 v48, v48
    v_exp_f32 v49, v49
    v_smfmac_f32_32x32x32_bf16 v[16:31], v[244:247], v[40:47], v1
    v_exp_f32 v50, v50
    v_exp_f32 v51, v51
    v_exp_f32 v52, v52
    s_waitcnt lgkmcnt(0)
    v_cmp_eq_u32 vcc, 0, v6
    v_mfma_f32_32x32x16_bf16 v[32:47], v[64:67], v[8:11], 0
    v_exp_f32 v53, v53
    v_exp_f32 v54, v54
    v_exp_f32 v55, v55
    v_exp_f32 v56, v56
    v_exp_f32 v57, v57
    v_smfmac_f32_32x32x32_bf16 v[16:31], v[248:251], v[48:55], v1
    v_exp_f32 v58, v58
    v_exp_f32 v59, v59
    v_exp_f32 v60, v60
    v_exp_f32 v61, v61
    v_exp_f32 v62, v62
    v_exp_f32 v63, v63
    v_exp_f32 v32, v32
    v_exp_f32 v33, v33
    v_smfmac_f32_32x32x32_bf16 v[16:31], v[252:255], v[56:63], v1
    v_exp_f32 v34, v34
    v_exp_f32 v35, v35
    v_exp_f32 v36, v36
    v_mfma_f32_32x32x16_bf16 v[48:63], v[68:71], v[8:11], 0
    v_exp_f32 v37, v37
    v_exp_f32 v38, v38
    v_exp_f32 v39, v39
    v_exp_f32 v40, v40
    v_exp_f32 v41, v41
    v_exp_f32 v42, v42
    v_exp_f32 v43, v43
    v_exp_f32 v44, v44
    s_cbranch_vccnz L_war_8
L_warb_9:
    v_add_u32_e64 v25, s52, 6
    ds_write_b128 v3, v[16:19] offset:20480
    ds_write_b128 v3, v[20:23] offset:21504
    ds_write_b64 v4, v[24:25] offset:22528
    v_mov_b64 v[16:17], 0
    v_mov_b64 v[18:19], 0
    v_mov_b64 v[20:21], 0
    v_mov_b64 v[22:23], 0
    v_mov_b32 v24, 0
    v_exp_f32 v45, v45
    v_exp_f32 v46, v46
    v_smfmac_f32_32x32x32_bf16 v[16:31], v[128:131], v[32:39], v1
    v_exp_f32 v47, v47
    v_exp_f32 v48, v48
    v_exp_f32 v49, v49
    v_smfmac_f32_32x32x32_bf16 v[16:31], v[132:135], v[40:47], v1
    v_exp_f32 v50, v50
    v_exp_f32 v51, v51
    v_exp_f32 v52, v52
    v_mfma_f32_32x32x16_bf16 v[32:47], v[72:75], v[8:11], 0
    v_exp_f32 v53, v53
    v_exp_f32 v54, v54
    v_exp_f32 v55, v55
    v_exp_f32 v56, v56
    v_exp_f32 v57, v57
    v_smfmac_f32_32x32x32_bf16 v[16:31], v[136:139], v[48:55], v1
    v_exp_f32 v58, v58
    v_exp_f32 v59, v59
    v_exp_f32 v60, v60
    v_exp_f32 v61, v61
    v_exp_f32 v62, v62
    v_exp_f32 v63, v63
    v_exp_f32 v32, v32
    v_exp_f32 v33, v33
    v_smfmac_f32_32x32x32_bf16 v[16:31], v[140:143], v[56:63], v1
    v_exp_f32 v34, v34
    v_exp_f32 v35, v35
    v_exp_f32 v36, v36
    v_mfma_f32_32x32x16_bf16 v[48:63], v[76:79], v[8:11], 0
    v_exp_f32 v37, v37
    v_exp_f32 v38, v38
    v_exp_f32 v39, v39
    v_exp_f32 v40, v40
    v_exp_f32 v41, v41
    v_smfmac_f32_32x32x32_bf16 v[16:31], v[144:147], v[32:39], v1
    v_exp_f32 v42, v42
    v_exp_f32 v43, v43
    v_exp_f32 v44, v44
    v_exp_f32 v45, v45
    v_exp_f32 v46, v46
    v_exp_f32 v47, v47
    v_exp_f32 v48, v48
    v_exp_f32 v49, v49
    v_smfmac_f32_32x32x32_bf16 v[16:31], v[148:151], v[40:47], v1
    v_exp_f32 v50, v50
    v_exp_f32 v51, v51
    v_exp_f32 v52, v52
    v_mfma_f32_32x32x16_bf16 v[32:47], v[80:83], v[8:11], 0
    v_exp_f32 v53, v53
    v_exp_f32 v54, v54
    v_exp_f32 v55, v55
    v_exp_f32 v56, v56
    v_exp_f32 v57, v57
    v_smfmac_f32_32x32x32_bf16 v[16:31], v[152:155], v[48:55], v1
    v_exp_f32 v58, v58
    v_exp_f32 v59, v59
    v_exp_f32 v60, v60
    v_exp_f32 v61, v61
    v_exp_f32 v62, v62
    v_exp_f32 v63, v63
    v_exp_f32 v32, v32
    v_exp_f32 v33, v33
    v_smfmac_f32_32x32x32_bf16 v[16:31], v[156:159], v[56:63], v1
    v_exp_f32 v34, v34
    v_exp_f32 v35, v35
    v_exp_f32 v36, v36
    v_mfma_f32_32x32x16_bf16 v[48:63], v[84:87], v[8:11], 0
    v_exp_f32 v37, v37
    v_exp_f32 v38, v38
    v_exp_f32 v39, v39
    v_exp_f32 v40, v40
    v_exp_f32 v41, v41
    v_smfmac_f32_32x32x32_bf16 v[16:31], v[160:163], v[32:39], v1
    v_exp_f32 v42, v42
    v_exp_f32 v43, v43
    v_exp_f32 v44, v44
    v_exp_f32 v45, v45
    v_exp_f32 v46, v46
    v_exp_f32 v47, v47
    v_exp_f32 v48, v48
    v_exp_f32 v49, v49
    v_smfmac_f32_32x32x32_bf16 v[16:31], v[164:167], v[40:47], v1
    v_exp_f32 v50, v50
    v_exp_f32 v51, v51
    v_exp_f32 v52, v52
    v_mfma_f32_32x32x16_bf16 v[32:47], v[88:91], v[8:11], 0
    v_exp_f32 v53, v53
    v_exp_f32 v54, v54
    v_exp_f32 v55, v55
    v_exp_f32 v56, v56
    v_exp_f32 v57, v57
    v_smfmac_f32_32x32x32_bf16 v[16:31], v[168:171], v[48:55], v1
    v_exp_f32 v58, v58
    v_exp_f32 v59, v59
    v_exp_f32 v60, v60
    v_exp_f32 v61, v61
    v_exp_f32 v62, v62
    v_exp_f32 v63, v63
    v_exp_f32 v32, v32
    v_exp_f32 v33, v33
    v_smfmac_f32_32x32x32_bf16 v[16:31], v[172:175], v[56:63], v1
    v_exp_f32 v34, v34
    v_exp_f32 v35, v35
    v_exp_f32 v36, v36
    v_mfma_f32_32x32x16_bf16 v[48:63], v[92:95], v[8:11], 0
    v_exp_f32 v37, v37
    v_exp_f32 v38, v38
    v_exp_f32 v39, v39
    v_exp_f32 v40, v40
    v_exp_f32 v41, v41
    v_smfmac_f32_32x32x32_bf16 v[16:31], v[176:179], v[32:39], v1
    v_exp_f32 v42, v42
    v_exp_f32 v43, v43
    v_exp_f32 v44, v44
    v_exp_f32 v45, v45
    v_exp_f32 v46, v46
    v_exp_f32 v47, v47
    v_exp_f32 v48, v48
    v_exp_f32 v49, v49
    v_smfmac_f32_32x32x32_bf16 v[16:31], v[180:183], v[40:47], v1
    v_exp_f32 v50, v50
    v_exp_f32 v51, v51
    v_exp_f32 v52, v52
    v_mfma_f32_32x32x16_bf16 v[32:47], v[96:99], v[8:11], 0
    v_exp_f32 v53, v53
    v_exp_f32 v54, v54
    v_exp_f32 v55, v55
    v_exp_f32 v56, v56
    v_exp_f32 v57, v57
    v_smfmac_f32_32x32x32_bf16 v[16:31], v[184:187], v[48:55], v1
    v_exp_f32 v58, v58
    v_exp_f32 v59, v59
    v_exp_f32 v60, v60
    v_exp_f32 v61, v61
    v_exp_f32 v62, v62
    v_exp_f32 v63, v63
    v_exp_f32 v32, v32
    v_exp_f32 v33, v33
    v_smfmac_f32_32x32x32_bf16 v[16:31], v[188:191], v[56:63], v1
    v_exp_f32 v34, v34
    v_exp_f32 v35, v35
    v_exp_f32 v36, v36
    v_mfma_f32_32x32x16_bf16 v[48:63], v[100:103], v[8:11], 0
    v_exp_f32 v37, v37
    v_exp_f32 v38, v38
    v_exp_f32 v39, v39
    v_exp_f32 v40, v40
    v_exp_f32 v41, v41
    v_smfmac_f32_32x32x32_bf16 v[16:31], v[192:195], v[32:39], v1
    v_exp_f32 v42, v42
    v_exp_f32 v43, v43
    v_exp_f32 v44, v44
    v_exp_f32 v45, v45
    v_exp_f32 v46, v46
    v_exp_f32 v47, v47
    v_exp_f32 v48, v48
    v_exp_f32 v49, v49
    v_smfmac_f32_32x32x32_bf16 v[16:31], v[196:199], v[40:47], v1
    v_exp_f32 v50, v50
    v_exp_f32 v51, v51
    v_exp_f32 v52, v52
    v_mfma_f32_32x32x16_bf16 v[32:47], v[104:107], v[8:11], 0
    v_exp_f32 v53, v53
    v_exp_f32 v54, v54
    v_exp_f32 v55, v55
    v_exp_f32 v56, v56
    v_exp_f32 v57, v57
    v_smfmac_f32_32x32x32_bf16 v[16:31], v[200:203], v[48:55], v1
    v_exp_f32 v58, v58
    v_exp_f32 v59, v59
    v_exp_f32 v60, v60
    v_exp_f32 v61, v61
    v_exp_f32 v62, v62
    v_exp_f32 v63, v63
    v_exp_f32 v32, v32
    v_exp_f32 v33, v33
    v_smfmac_f32_32x32x32_bf16 v[16:31], v[204:207], v[56:63], v1
    v_exp_f32 v34, v34
    v_exp_f32 v35, v35
    v_exp_f32 v36, v36
    v_mfma_f32_32x32x16_bf16 v[48:63], v[108:111], v[8:11], 0
    v_exp_f32 v37, v37
    v_exp_f32 v38, v38
    v_exp_f32 v39, v39
    v_exp_f32 v40, v40
    v_exp_f32 v41, v41
    v_smfmac_f32_32x32x32_bf16 v[16:31], v[208:211], v[32:39], v1
    v_exp_f32 v42, v42
    v_exp_f32 v43, v43
    v_exp_f32 v44, v44
    v_exp_f32 v45, v45
    v_exp_f32 v46, v46
    v_exp_f32 v47, v47
    v_exp_f32 v48, v48
    v_exp_f32 v49, v49
    v_smfmac_f32_32x32x32_bf16 v[16:31], v[212:215], v[40:47], v1
    v_exp_f32 v50, v50
    v_exp_f32 v51, v51
    v_exp_f32 v52, v52
    v_mfma_f32_32x32x16_bf16 v[32:47], v[112:115], v[8:11], 0
    v_exp_f32 v53, v53
    v_exp_f32 v54, v54
    v_exp_f32 v55, v55
    v_exp_f32 v56, v56
    v_exp_f32 v57, v57
    v_smfmac_f32_32x32x32_bf16 v[16:31], v[216:219], v[48:55], v1
    v_exp_f32 v58, v58
    v_exp_f32 v59, v59
    v_exp_f32 v60, v60
    v_exp_f32 v61, v61
    v_exp_f32 v62, v62
    v_exp_f32 v63, v63
    v_exp_f32 v32, v32
    v_exp_f32 v33, v33
    v_smfmac_f32_32x32x32_bf16 v[16:31], v[220:223], v[56:63], v1
    v_exp_f32 v34, v34
    v_exp_f32 v35, v35
    v_exp_f32 v36, v36
    v_mfma_f32_32x32x16_bf16 v[48:63], v[116:119], v[8:11], 0
    v_exp_f32 v37, v37
    v_exp_f32 v38, v38
    v_exp_f32 v39, v39
    v_exp_f32 v40, v40
    v_exp_f32 v41, v41
    v_smfmac_f32_32x32x32_bf16 v[16:31], v[224:227], v[32:39], v1
    v_exp_f32 v42, v42
    v_exp_f32 v43, v43
    v_exp_f32 v44, v44
    v_exp_f32 v45, v45
    v_exp_f32 v46, v46
    v_exp_f32 v47, v47
    v_exp_f32 v48, v48
    v_exp_f32 v49, v49
    v_smfmac_f32_32x32x32_bf16 v[16:31], v[228:231], v[40:47], v1
    v_exp_f32 v50, v50
    v_exp_f32 v51, v51
    v_exp_f32 v52, v52
    v_mfma_f32_32x32x16_bf16 v[32:47], v[120:123], v[8:11], 0
    v_exp_f32 v53, v53
    v_exp_f32 v54, v54
    v_exp_f32 v55, v55
    v_exp_f32 v56, v56
    v_exp_f32 v57, v57
    v_smfmac_f32_32x32x32_bf16 v[16:31], v[232:235], v[48:55], v1
    v_exp_f32 v58, v58
    v_exp_f32 v59, v59
    v_exp_f32 v60, v60
    v_exp_f32 v61, v61
    v_exp_f32 v62, v62
    v_exp_f32 v63, v63
    v_exp_f32 v32, v32
    v_exp_f32 v33, v33
    v_smfmac_f32_32x32x32_bf16 v[16:31], v[236:239], v[56:63], v1
    v_exp_f32 v34, v34
    v_exp_f32 v35, v35
    v_exp_f32 v36, v36
    v_mfma_f32_32x32x16_bf16 v[48:63], v[124:127], v[8:11], 0
    ds_read_b128 v[8:11], v14 offset:7168
    ds_read_b32 v6, v5 offset:44
    v_exp_f32 v37, v37
    v_exp_f32 v38, v38
    v_exp_f32 v39, v39
    v_exp_f32 v40, v40
    v_exp_f32 v41, v41
    v_smfmac_f32_32x32x32_bf16 v[16:31], v[240:243], v[32:39], v1
    v_exp_f32 v42, v42
    v_exp_f32 v43, v43
    v_exp_f32 v44, v44
    v_exp_f32 v45, v45
    v_exp_f32 v46, v46
    v_exp_f32 v47, v47
    v_exp_f32 v48, v48
    v_exp_f32 v49, v49
    v_smfmac_f32_32x32x32_bf16 v[16:31], v[244:247], v[40:47], v1
    v_exp_f32 v50, v50
    v_exp_f32 v51, v51
    v_exp_f32 v52, v52
    s_waitcnt lgkmcnt(0)
    v_cmp_eq_u32 vcc, 0, v6
    v_mfma_f32_32x32x16_bf16 v[32:47], v[64:67], v[8:11], 0
    v_exp_f32 v53, v53
    v_exp_f32 v54, v54
    v_exp_f32 v55, v55
    v_exp_f32 v56, v56
    v_exp_f32 v57, v57
    v_smfmac_f32_32x32x32_bf16 v[16:31], v[248:251], v[48:55], v1
    v_exp_f32 v58, v58
    v_exp_f32 v59, v59
    v_exp_f32 v60, v60
    v_exp_f32 v61, v61
    v_exp_f32 v62, v62
    v_exp_f32 v63, v63
    v_exp_f32 v32, v32
    v_exp_f32 v33, v33
    v_smfmac_f32_32x32x32_bf16 v[16:31], v[252:255], v[56:63], v1
    v_exp_f32 v34, v34
    v_exp_f32 v35, v35
    v_exp_f32 v36, v36
    v_mfma_f32_32x32x16_bf16 v[48:63], v[68:71], v[8:11], 0
    v_exp_f32 v37, v37
    v_exp_f32 v38, v38
    v_exp_f32 v39, v39
    v_exp_f32 v40, v40
    v_exp_f32 v41, v41
    v_exp_f32 v42, v42
    v_exp_f32 v43, v43
    v_exp_f32 v44, v44
    s_cbranch_vccnz L_war_10
L_warb_11:
    v_add_u32_e64 v25, s52, 7
    ds_write_b128 v3, v[16:19] offset:0
    ds_write_b128 v3, v[20:23] offset:1024
    ds_write_b64 v4, v[24:25] offset:2048
    v_mov_b64 v[16:17], 0
    v_mov_b64 v[18:19], 0
    v_mov_b64 v[20:21], 0
    v_mov_b64 v[22:23], 0
    v_mov_b32 v24, 0
    v_exp_f32 v45, v45
    v_exp_f32 v46, v46
    v_smfmac_f32_32x32x32_bf16 v[16:31], v[128:131], v[32:39], v1
    v_exp_f32 v47, v47
    v_exp_f32 v48, v48
    v_exp_f32 v49, v49
    v_smfmac_f32_32x32x32_bf16 v[16:31], v[132:135], v[40:47], v1
    v_exp_f32 v50, v50
    v_exp_f32 v51, v51
    v_exp_f32 v52, v52
    v_mfma_f32_32x32x16_bf16 v[32:47], v[72:75], v[8:11], 0
    v_exp_f32 v53, v53
    v_exp_f32 v54, v54
    v_exp_f32 v55, v55
    v_exp_f32 v56, v56
    v_exp_f32 v57, v57
    v_smfmac_f32_32x32x32_bf16 v[16:31], v[136:139], v[48:55], v1
    v_exp_f32 v58, v58
    v_exp_f32 v59, v59
    v_exp_f32 v60, v60
    v_exp_f32 v61, v61
    v_exp_f32 v62, v62
    v_exp_f32 v63, v63
    v_exp_f32 v32, v32
    v_exp_f32 v33, v33
    v_smfmac_f32_32x32x32_bf16 v[16:31], v[140:143], v[56:63], v1
    v_exp_f32 v34, v34
    v_exp_f32 v35, v35
    v_exp_f32 v36, v36
    v_mfma_f32_32x32x16_bf16 v[48:63], v[76:79], v[8:11], 0
    v_exp_f32 v37, v37
    v_exp_f32 v38, v38
    v_exp_f32 v39, v39
    v_exp_f32 v40, v40
    v_exp_f32 v41, v41
    v_smfmac_f32_32x32x32_bf16 v[16:31], v[144:147], v[32:39], v1
    v_exp_f32 v42, v42
    v_exp_f32 v43, v43
    v_exp_f32 v44, v44
    v_exp_f32 v45, v45
    v_exp_f32 v46, v46
    v_exp_f32 v47, v47
    v_exp_f32 v48, v48
    v_exp_f32 v49, v49
    v_smfmac_f32_32x32x32_bf16 v[16:31], v[148:151], v[40:47], v1
    v_exp_f32 v50, v50
    v_exp_f32 v51, v51
    v_exp_f32 v52, v52
    v_mfma_f32_32x32x16_bf16 v[32:47], v[80:83], v[8:11], 0
    v_exp_f32 v53, v53
    v_exp_f32 v54, v54
    v_exp_f32 v55, v55
    v_exp_f32 v56, v56
    v_exp_f32 v57, v57
    v_smfmac_f32_32x32x32_bf16 v[16:31], v[152:155], v[48:55], v1
    v_exp_f32 v58, v58
    v_exp_f32 v59, v59
    v_exp_f32 v60, v60
    v_exp_f32 v61, v61
    v_exp_f32 v62, v62
    v_exp_f32 v63, v63
    v_exp_f32 v32, v32
    v_exp_f32 v33, v33
    v_smfmac_f32_32x32x32_bf16 v[16:31], v[156:159], v[56:63], v1
    v_exp_f32 v34, v34
    v_exp_f32 v35, v35
    v_exp_f32 v36, v36
    v_mfma_f32_32x32x16_bf16 v[48:63], v[84:87], v[8:11], 0
    v_exp_f32 v37, v37
    v_exp_f32 v38, v38
    v_exp_f32 v39, v39
    v_exp_f32 v40, v40
    v_exp_f32 v41, v41
    v_smfmac_f32_32x32x32_bf16 v[16:31], v[160:163], v[32:39], v1
    v_exp_f32 v42, v42
    v_exp_f32 v43, v43
    v_exp_f32 v44, v44
    v_exp_f32 v45, v45
    v_exp_f32 v46, v46
    v_exp_f32 v47, v47
    v_exp_f32 v48, v48
    v_exp_f32 v49, v49
    v_smfmac_f32_32x32x32_bf16 v[16:31], v[164:167], v[40:47], v1
    v_exp_f32 v50, v50
    v_exp_f32 v51, v51
    v_exp_f32 v52, v52
    v_mfma_f32_32x32x16_bf16 v[32:47], v[88:91], v[8:11], 0
    v_exp_f32 v53, v53
    v_exp_f32 v54, v54
    v_exp_f32 v55, v55
    v_exp_f32 v56, v56
    v_exp_f32 v57, v57
    v_smfmac_f32_32x32x32_bf16 v[16:31], v[168:171], v[48:55], v1
    v_exp_f32 v58, v58
    v_exp_f32 v59, v59
    v_exp_f32 v60, v60
    v_exp_f32 v61, v61
    v_exp_f32 v62, v62
    v_exp_f32 v63, v63
    v_exp_f32 v32, v32
    v_exp_f32 v33, v33
    v_smfmac_f32_32x32x32_bf16 v[16:31], v[172:175], v[56:63], v1
    v_exp_f32 v34, v34
    v_exp_f32 v35, v35
    v_exp_f32 v36, v36
    v_mfma_f32_32x32x16_bf16 v[48:63], v[92:95], v[8:11], 0
    v_exp_f32 v37, v37
    v_exp_f32 v38, v38
    v_exp_f32 v39, v39
    v_exp_f32 v40, v40
    v_exp_f32 v41, v41
    v_smfmac_f32_32x32x32_bf16 v[16:31], v[176:179], v[32:39], v1
    v_exp_f32 v42, v42
    v_exp_f32 v43, v43
    v_exp_f32 v44, v44
    v_exp_f32 v45, v45
    v_exp_f32 v46, v46
    v_exp_f32 v47, v47
    v_exp_f32 v48, v48
    v_exp_f32 v49, v49
    v_smfmac_f32_32x32x32_bf16 v[16:31], v[180:183], v[40:47], v1
    v_exp_f32 v50, v50
    v_exp_f32 v51, v51
    v_exp_f32 v52, v52
    v_mfma_f32_32x32x16_bf16 v[32:47], v[96:99], v[8:11], 0
    v_exp_f32 v53, v53
    v_exp_f32 v54, v54
    v_exp_f32 v55, v55
    v_exp_f32 v56, v56
    v_exp_f32 v57, v57
    v_smfmac_f32_32x32x32_bf16 v[16:31], v[184:187], v[48:55], v1
    v_exp_f32 v58, v58
    v_exp_f32 v59, v59
    v_exp_f32 v60, v60
    v_exp_f32 v61, v61
    v_exp_f32 v62, v62
    v_exp_f32 v63, v63
    v_exp_f32 v32, v32
    v_exp_f32 v33, v33
    v_smfmac_f32_32x32x32_bf16 v[16:31], v[188:191], v[56:63], v1
    v_exp_f32 v34, v34
    v_exp_f32 v35, v35
    v_exp_f32 v36, v36
    v_mfma_f32_32x32x16_bf16 v[48:63], v[100:103], v[8:11], 0
    v_exp_f32 v37, v37
    v_exp_f32 v38, v38
    v_exp_f32 v39, v39
    v_exp_f32 v40, v40
    v_exp_f32 v41, v41
    v_smfmac_f32_32x32x32_bf16 v[16:31], v[192:195], v[32:39], v1
    v_exp_f32 v42, v42
    v_exp_f32 v43, v43
    v_exp_f32 v44, v44
    v_exp_f32 v45, v45
    v_exp_f32 v46, v46
    v_exp_f32 v47, v47
    v_exp_f32 v48, v48
    v_exp_f32 v49, v49
    v_smfmac_f32_32x32x32_bf16 v[16:31], v[196:199], v[40:47], v1
    v_exp_f32 v50, v50
    v_exp_f32 v51, v51
    v_exp_f32 v52, v52
    v_mfma_f32_32x32x16_bf16 v[32:47], v[104:107], v[8:11], 0
    v_exp_f32 v53, v53
    v_exp_f32 v54, v54
    v_exp_f32 v55, v55
    v_exp_f32 v56, v56
    v_exp_f32 v57, v57
    v_smfmac_f32_32x32x32_bf16 v[16:31], v[200:203], v[48:55], v1
    v_exp_f32 v58, v58
    v_exp_f32 v59, v59
    v_exp_f32 v60, v60
    v_exp_f32 v61, v61
    v_exp_f32 v62, v62
    v_exp_f32 v63, v63
    v_exp_f32 v32, v32
    v_exp_f32 v33, v33
    v_smfmac_f32_32x32x32_bf16 v[16:31], v[204:207], v[56:63], v1
    v_exp_f32 v34, v34
    v_exp_f32 v35, v35
    v_exp_f32 v36, v36
    v_mfma_f32_32x32x16_bf16 v[48:63], v[108:111], v[8:11], 0
    v_exp_f32 v37, v37
    v_exp_f32 v38, v38
    v_exp_f32 v39, v39
    v_exp_f32 v40, v40
    v_exp_f32 v41, v41
    v_smfmac_f32_32x32x32_bf16 v[16:31], v[208:211], v[32:39], v1
    v_exp_f32 v42, v42
    v_exp_f32 v43, v43
    v_exp_f32 v44, v44
    v_exp_f32 v45, v45
    v_exp_f32 v46, v46
    v_exp_f32 v47, v47
    v_exp_f32 v48, v48
    v_exp_f32 v49, v49
    v_smfmac_f32_32x32x32_bf16 v[16:31], v[212:215], v[40:47], v1
    v_exp_f32 v50, v50
    v_exp_f32 v51, v51
    v_exp_f32 v52, v52
    v_mfma_f32_32x32x16_bf16 v[32:47], v[112:115], v[8:11], 0
    v_exp_f32 v53, v53
    v_exp_f32 v54, v54
    v_exp_f32 v55, v55
    v_exp_f32 v56, v56
    v_exp_f32 v57, v57
    v_smfmac_f32_32x32x32_bf16 v[16:31], v[216:219], v[48:55], v1
    v_exp_f32 v58, v58
    v_exp_f32 v59, v59
    v_exp_f32 v60, v60
    v_exp_f32 v61, v61
    v_exp_f32 v62, v62
    v_exp_f32 v63, v63
    v_exp_f32 v32, v32
    v_exp_f32 v33, v33
    v_smfmac_f32_32x32x32_bf16 v[16:31], v[220:223], v[56:63], v1
    v_exp_f32 v34, v34
    v_exp_f32 v35, v35
    v_exp_f32 v36, v36
    v_mfma_f32_32x32x16_bf16 v[48:63], v[116:119], v[8:11], 0
    v_exp_f32 v37, v37
    v_exp_f32 v38, v38
    v_exp_f32 v39, v39
    v_exp_f32 v40, v40
    v_exp_f32 v41, v41
    v_smfmac_f32_32x32x32_bf16 v[16:31], v[224:227], v[32:39], v1
    v_exp_f32 v42, v42
    v_exp_f32 v43, v43
    v_exp_f32 v44, v44
    v_exp_f32 v45, v45
    v_exp_f32 v46, v46
    v_exp_f32 v47, v47
    v_exp_f32 v48, v48
    v_exp_f32 v49, v49
    v_smfmac_f32_32x32x32_bf16 v[16:31], v[228:231], v[40:47], v1
    v_exp_f32 v50, v50
    v_exp_f32 v51, v51
    v_exp_f32 v52, v52
    v_mfma_f32_32x32x16_bf16 v[32:47], v[120:123], v[8:11], 0
    v_exp_f32 v53, v53
    v_exp_f32 v54, v54
    v_exp_f32 v55, v55
    v_exp_f32 v56, v56
    v_exp_f32 v57, v57
    v_smfmac_f32_32x32x32_bf16 v[16:31], v[232:235], v[48:55], v1
    v_exp_f32 v58, v58
    v_exp_f32 v59, v59
    v_exp_f32 v60, v60
    v_exp_f32 v61, v61
    v_exp_f32 v62, v62
    v_exp_f32 v63, v63
    v_exp_f32 v32, v32
    v_exp_f32 v33, v33
    v_smfmac_f32_32x32x32_bf16 v[16:31], v[236:239], v[56:63], v1
    v_exp_f32 v34, v34
    v_exp_f32 v35, v35
    v_exp_f32 v36, v36
    v_mfma_f32_32x32x16_bf16 v[48:63], v[124:127], v[8:11], 0
    ds_read_b32 v6, v5 offset:48
    ds_read_b32 v15, v15
    v_exp_f32 v37, v37
    v_exp_f32 v38, v38
    v_exp_f32 v39, v39
    v_exp_f32 v40, v40
    v_exp_f32 v41, v41
    v_smfmac_f32_32x32x32_bf16 v[16:31], v[240:243], v[32:39], v1
    v_exp_f32 v42, v42
    v_exp_f32 v43, v43
    v_exp_f32 v44, v44
    v_exp_f32 v45, v45
    v_exp_f32 v46, v46
    v_exp_f32 v47, v47
    v_exp_f32 v48, v48
    v_exp_f32 v49, v49
    v_smfmac_f32_32x32x32_bf16 v[16:31], v[244:247], v[40:47], v1
    v_exp_f32 v50, v50
    v_exp_f32 v51, v51
    v_exp_f32 v52, v52
    s_waitcnt lgkmcnt(0)
    v_cmp_eq_u32 vcc, 0, v6
    v_exp_f32 v53, v53
    v_exp_f32 v54, v54
    v_exp_f32 v55, v55
    v_exp_f32 v56, v56
    v_exp_f32 v57, v57
    v_smfmac_f32_32x32x32_bf16 v[16:31], v[248:251], v[48:55], v1
    v_exp_f32 v58, v58
    v_exp_f32 v59, v59
    v_exp_f32 v60, v60
    v_exp_f32 v61, v61
    v_exp_f32 v62, v62
    v_exp_f32 v63, v63
L_mainend:
    v_lshlrev_b32 v7, 3, v0
    v_add_u32 v7, 122880, v7
    v_smfmac_f32_32x32x32_bf16 v[16:31], v[252:255], v[56:63], v1
    s_nop 11
    s_cbranch_vccnz L_war_12
L_warb_13:
    v_add_u32_e64 v25, s52, 8
    ds_write_b128 v3, v[16:19] offset:10240
    ds_write_b128 v3, v[20:23] offset:11264
    ds_write_b64 v4, v[24:25] offset:12288
    ds_read_b64 v[16:17], v7 offset:12288
    ds_read_b64 v[18:19], v7 offset:14848
    ds_read_b64 v[20:21], v7 offset:17408
    ds_read_b64 v[22:23], v7 offset:19968
    ds_read_b128 v[32:35], v12 offset:10240
    ds_read_b128 v[36:39], v12 offset:12800
    ds_read_b128 v[40:43], v12 offset:15360
    ds_read_b128 v[44:47], v12 offset:17920
    ds_read_b128 v[48:51], v12 offset:11264
    ds_read_b128 v[52:55], v12 offset:13824
    ds_read_b128 v[56:59], v12 offset:16384
    ds_read_b128 v[60:63], v12 offset:18944
    s_waitcnt lgkmcnt(8)
    v_add3_u32 v17, v17, v19, v21
    v_add_u32 v17, v17, v23
    v_cmp_ne_u32 s[70:71], s77, v17
    v_add_f32 v16, v16, v18
    v_add_f32 v20, v20, v22
    v_add_f32 v16, v16, v20
    v_rcp_f32 v17, v16
    v_subrev_u32 v16, 0x21800000, v16
    v_cmp_lt_u32 vcc, 0x46000000, v16
    v_mul_f32 v18, v17, v15
    s_waitcnt lgkmcnt(4)
    v_pk_add_f32 v[32:33], v[32:33], v[36:37]
    v_pk_add_f32 v[40:41], v[40:41], v[44:45]
    v_pk_add_f32 v[34:35], v[34:35], v[38:39]
    v_pk_add_f32 v[42:43], v[42:43], v[46:47]
    v_pk_add_f32 v[32:33], v[32:33], v[40:41]
    v_pk_add_f32 v[34:35], v[34:35], v[42:43]
    v_pk_mul_f32 v[32:33], v[32:33], v[18:19] op_sel_hi:[1,0]
    v_pk_mul_f32 v[34:35], v[34:35], v[18:19] op_sel_hi:[1,0]
    v_cvt_pk_bf16_f32 v26, v32, v33
    v_cvt_pk_bf16_f32 v27, v34, v35
    v_mov_b32 v24, s52
    v_mov_b32 v30, s52
    s_waitcnt lgkmcnt(0)
    v_pk_add_f32 v[48:49], v[48:49], v[52:53]
    v_pk_add_f32 v[56:57], v[56:57], v[60:61]
    v_pk_add_f32 v[50:51], v[50:51], v[54:55]
    v_pk_add_f32 v[58:59], v[58:59], v[62:63]
    v_pk_add_f32 v[48:49], v[48:49], v[56:57]
    v_pk_add_f32 v[50:51], v[50:51], v[58:59]
    v_pk_mul_f32 v[48:49], v[48:49], v[18:19] op_sel_hi:[1,0]
    v_pk_mul_f32 v[50:51], v[50:51], v[18:19] op_sel_hi:[1,0]
    v_cvt_pk_bf16_f32 v28, v48, v49
    v_cvt_pk_bf16_f32 v29, v50, v51
    s_cmp_lg_u64 s[70:71], 0
    s_cbranch_scc1 L_fin7_done
    v_mov_b32 v16, 2
    s_cbranch_vccnz L_bad_14
    v_mov_b32 v16, 1
    buffer_store_dwordx4 v[24:27], v2, s[48:51], s76 offen sc1
    buffer_store_dwordx4 v[28:31], v2, s[48:51], s76 offen offset:1024 sc1
    s_waitcnt vmcnt(0)
L_bad_14:
    ds_write_b32 v5, v16 offset:60
L_fin7_done:
    s_setprio 0
    v_and_b32 v12, 7, v0
    v_lshlrev_b32 v12, 2, v12
    v_add_u32 v12, 155680, v12
L_lw_15:
    ds_read_b32 v6, v12 offset:0
    s_waitcnt lgkmcnt(0)
    v_cmp_le_u32 vcc, 1, v6
    s_cmp_eq_u64 vcc, -1
    s_cbranch_scc1 L_lwe_16
    s_sub_u32 s60, s60, 1
    s_cbranch_scc1 L_bail
    s_sleep 2
    s_branch L_lw_15
L_lwe_16:
    v_cmp_eq_u32 vcc, 2, v6
    s_and_b32 s80, vcc_lo, 0xff
    s_cbranch_scc0 L_att_end
    s_mov_b32 s82, 0
    s_lshl_b32 s68, s59, 2
    s_add_u32 s68, s68, 155664
    v_mov_b32 v12, s68
L_slow_loop:
    s_ff1_i32_b32 s81, s80
    s_bitset0_b32 s80, s81
    s_lshl_b32 s68, s81, 10
    v_add_u32 v15, s68, v14
    ds_read_b128 v[8:11], v15
    v_mov_b32 v48, 0xff800000
    s_waitcnt lgkmcnt(0)
    v_mfma_f32_32x32x16_bf16 v[32:47], v[64:67], v[8:11], 0
    s_nop 11
    v_max3_f32 v48, v48, v32, v33
    v_max3_f32 v48, v48, v34, v35
    v_max3_f32 v48, v48, v36, v37
    v_max3_f32 v48, v48, v38, v39
    v_max3_f32 v48, v48, v40, v41
    v_max3_f32 v48, v48, v42, v43
    v_max3_f32 v48, v48, v44, v45
    v_max3_f32 v48, v48, v46, v47
    v_mfma_f32_32x32x16_bf16 v[32:47], v[68:71], v[8:11], 0
    s_nop 11
    v_max3_f32 v48, v48, v32, v33
    v_max3_f32 v48, v48, v34, v35
    v_max3_f32 v48, v48, v36, v37
    v_max3_f32 v48, v48, v38, v39
    v_max3_f32 v48, v48, v40, v41
    v_max3_f32 v48, v48, v42, v43
    v_max3_f32 v48, v48, v44, v45
    v_max3_f32 v48, v48, v46, v47
    v_mfma_f32_32x32x16_bf16 v[32:47], v[72:75], v[8:11], 0
    s_nop 11
    v_max3_f32 v48, v48, v32, v33
    v_max3_f32 v48, v48, v34, v35
    v_max3_f32 v48, v48, v36, v37
    v_max3_f32 v48, v48, v38, v39
    v_max3_f32 v48, v48, v40, v41
    v_max3_f32 v48, v48, v42, v43
    v_max3_f32 v48, v48, v44, v45
    v_max3_f32 v48, v48, v46, v47
    v_mfma_f32_32x32x16_bf16 v[32:47], v[76:79], v[8:11], 0
    s_nop 11
    v_max3_f32 v48, v48, v32, v33
    v_max3_f32 v48, v48, v34, v35
    v_max3_f32 v48, v48, v36, v37
    v_max3_f32 v48, v48, v38, v39
    v_max3_f32 v48, v48, v40, v41
    v_max3_f32 v48, v48, v42, v43
    v_max3_f32 v48, v48, v44, v45
    v_max3_f32 v48, v48, v46, v47
    v_mfma_f32_32x32x16_bf16 v[32:47], v[80:83], v[8:11], 0
    s_nop 11
    v_max3_f32 v48, v48, v32, v33
    v_max3_f32 v48, v48, v34, v35
    v_max3_f32 v48, v48, v36, v37
    v_max3_f32 v48, v48, v38, v39
    v_max3_f32 v48, v48, v40, v41
    v_max3_f32 v48, v48, v42, v43
    v_max3_f32 v48, v48, v44, v45
    v_max3_f32 v48, v48, v46, v47
    v_mfma_f32_32x32x16_bf16 v[32:47], v[84:87], v[8:11], 0
    s_nop 11
    v_max3_f32 v48, v48, v32, v33
    v_max3_f32 v48, v48, v34, v35
    v_max3_f32 v48, v48, v36, v37
    v_max3_f32 v48, v48, v38, v39
    v_max3_f32 v48, v48, v40, v41
    v_max3_f32 v48, v48, v42, v43
    v_max3_f32 v48, v48, v44, v45
    v_max3_f32 v48, v48, v46, v47
    v_mfma_f32_32x32x16_bf16 v[32:47], v[88:91], v[8:11], 0
    s_nop 11
    v_max3_f32 v48, v48, v32, v33
    v_max3_f32 v48, v48, v34, v35
    v_max3_f32 v48, v48, v36, v37
    v_max3_f32 v48, v48, v38, v39
    v_max3_f32 v48, v48, v40, v41
    v_max3_f32 v48, v48, v42, v43
    v_max3_f32 v48, v48, v44, v45
    v_max3_f32 v48, v48, v46, v47
    v_mfma_f32_32x32x16_bf16 v[32:47], v[92:95], v[8:11], 0
    s_nop 11
    v_max3_f32 v48, v48, v32, v33
    v_max3_f32 v48, v48, v34, v35
    v_max3_f32 v48, v48, v36, v37
    v_max3_f32 v48, v48, v38, v39
    v_max3_f32 v48, v48, v40, v41
    v_max3_f32 v48, v48, v42, v43
    v_max3_f32 v48, v48, v44, v45
    v_max3_f32 v48, v48, v46, v47
    v_mfma_f32_32x32x16_bf16 v[32:47], v[96:99], v[8:11], 0
    s_nop 11
    v_max3_f32 v48, v48, v32, v33
    v_max3_f32 v48, v48, v34, v35
    v_max3_f32 v48, v48, v36, v37
    v_max3_f32 v48, v48, v38, v39
    v_max3_f32 v48, v48, v40, v41
    v_max3_f32 v48, v48, v42, v43
    v_max3_f32 v48, v48, v44, v45
    v_max3_f32 v48, v48, v46, v47
    v_mfma_f32_32x32x16_bf16 v[32:47], v[100:103], v[8:11], 0
    s_nop 11
    v_max3_f32 v48, v48, v32, v33
    v_max3_f32 v48, v48, v34, v35
    v_max3_f32 v48, v48, v36, v37
    v_max3_f32 v48, v48, v38, v39
    v_max3_f32 v48, v48, v40, v41
    v_max3_f32 v48, v48, v42, v43
    v_max3_f32 v48, v48, v44, v45
    v_max3_f32 v48, v48, v46, v47
    v_mfma_f32_32x32x16_bf16 v[32:47], v[104:107], v[8:11], 0
    s_nop 11
    v_max3_f32 v48, v48, v32, v33
    v_max3_f32 v48, v48, v34, v35
    v_max3_f32 v48, v48, v36, v37
    v_max3_f32 v48, v48, v38, v39
    v_max3_f32 v48, v48, v40, v41
    v_max3_f32 v48, v48, v42, v43
    v_max3_f32 v48, v48, v44, v45
    v_max3_f32 v48, v48, v46, v47
    v_mfma_f32_32x32x16_bf16 v[32:47], v[108:111], v[8:11], 0
    s_nop 11
    v_max3_f32 v48, v48, v32, v33
    v_max3_f32 v48, v48, v34, v35
    v_max3_f32 v48, v48, v36, v37
    v_max3_f32 v48, v48, v38, v39
    v_max3_f32 v48, v48, v40, v41
    v_max3_f32 v48, v48, v42, v43
    v_max3_f32 v48, v48, v44, v45
    v_max3_f32 v48, v48, v46, v47
    v_mfma_f32_32x32x16_bf16 v[32:47], v[112:115], v[8:11], 0
    s_nop 11
    v_max3_f32 v48, v48, v32, v33
    v_max3_f32 v48, v48, v34, v35
    v_max3_f32 v48, v48, v36, v37
    v_max3_f32 v48, v48, v38, v39
    v_max3_f32 v48, v48, v40, v41
    v_max3_f32 v48, v48, v42, v43
    v_max3_f32 v48, v48, v44, v45
    v_max3_f32 v48, v48, v46, v47
    v_mfma_f32_32x32x16_bf16 v[32:47], v[116:119], v[8:11], 0
    s_nop 11
    v_max3_f32 v48, v48, v32, v33
    v_max3_f32 v48, v48, v34, v35
    v_max3_f32 v48, v48, v36, v37
    v_max3_f32 v48, v48, v38, v39
    v_max3_f32 v48, v48, v40, v41
    v_max3_f32 v48, v48, v42, v43
    v_max3_f32 v48, v48, v44, v45
    v_max3_f32 v48, v48, v46, v47
    v_mfma_f32_32x32x16_bf16 v[32:47], v[120:123], v[8:11], 0
    s_nop 11
    v_max3_f32 v48, v48, v32, v33
    v_max3_f32 v48, v48, v34, v35
    v_max3_f32 v48, v48, v36, v37
    v_max3_f32 v48, v48, v38, v39
    v_max3_f32 v48, v48, v40, v41
    v_max3_f32 v48, v48, v42, v43
    v_max3_f32 v48, v48, v44, v45
    v_max3_f32 v48, v48, v46, v47
    v_mfma_f32_32x32x16_bf16 v[32:47], v[124:127], v[8:11], 0
    s_nop 11
    v_max3_f32 v48, v48, v32, v33
    v_max3_f32 v48, v48, v34, v35
    v_max3_f32 v48, v48, v36, v37
    v_max3_f32 v48, v48, v38, v39
    v_max3_f32 v48, v48, v40, v41
    v_max3_f32 v48, v48, v42, v43
    v_max3_f32 v48, v48, v44, v45
    v_max3_f32 v48, v48, v46, v47
    v_mov_b32 v49, v48
    s_nop 1
    v_permlane32_swap_b32 v48, v49
    v_max_f32 v48, v48, v49
    s_lshl_b32 s68, s59, 8
    s_add_u32 s68, s68, 158208
    v_lshlrev_b32 v50, 2, v0
    v_add_u32 v51, s68, v50
    v_add_u32 v50, 158208, v50
    ds_write_b32 v51, v48
    s_add_u32 s82, s82, 1
    v_mov_b32 v6, s82
    ds_write_b32 v12, v6
L_lw_17:
    ds_read_b32 v6, v13 offset:16
    s_waitcnt lgkmcnt(0)
    v_cmp_le_u32 vcc, s82, v6
    s_cmp_eq_u64 vcc, -1
    s_cbranch_scc1 L_lwe_18
    s_sub_u32 s60, s60, 1
    s_cbranch_scc1 L_bail
    s_sleep 1
    s_branch L_lw_17
L_lwe_18:
    ds_read_b32 v52, v50 offset:0
    ds_read_b32 v53, v50 offset:256
    ds_read_b32 v54, v50 offset:512
    ds_read_b32 v55, v50 offset:768
    v_mov_b64 v[16:17], 0
    v_mov_b64 v[18:19], 0
    v_mov_b64 v[20:21], 0
    v_mov_b64 v[22:23], 0
    v_mov_b64 v[24:25], 0
    v_mov_b64 v[26:27], 0
    v_mov_b64 v[28:29], 0
    v_mov_b64 v[30:31], 0
    s_waitcnt lgkmcnt(0)
    v_max3_f32 v48, v52, v53, v54
    v_max_f32 v48, v48, v55
    v_mfma_f32_32x32x16_bf16 v[32:47], v[64:67], v[8:11], 0
    s_nop 11
    v_sub_f32 v32, v32, v48
    v_sub_f32 v33, v33, v48
    v_sub_f32 v34, v34, v48
    v_sub_f32 v35, v35, v48
    v_sub_f32 v36, v36, v48
    v_sub_f32 v37, v37, v48
    v_sub_f32 v38, v38, v48
    v_sub_f32 v39, v39, v48
    v_sub_f32 v40, v40, v48
    v_sub_f32 v41, v41, v48
    v_sub_f32 v42, v42, v48
    v_sub_f32 v43, v43, v48
    v_sub_f32 v44, v44, v48
    v_sub_f32 v45, v45, v48
    v_sub_f32 v46, v46, v48
    v_sub_f32 v47, v47, v48
    v_exp_f32 v32, v32
    v_exp_f32 v33, v33
    v_exp_f32 v34, v34
    v_exp_f32 v35, v35
    v_exp_f32 v36, v36
    v_exp_f32 v37, v37
    v_exp_f32 v38, v38
    v_exp_f32 v39, v39
    v_exp_f32 v40, v40
    v_exp_f32 v41, v41
    v_exp_f32 v42, v42
    v_exp_f32 v43, v43
    v_exp_f32 v44, v44
    v_exp_f32 v45, v45
    v_exp_f32 v46, v46
    v_exp_f32 v47, v47
    s_nop 1
    v_smfmac_f32_32x32x32_bf16 v[16:31], v[128:131], v[32:39], v1
    v_smfmac_f32_32x32x32_bf16 v[16:31], v[132:135], v[40:47], v1
    v_mfma_f32_32x32x16_bf16 v[32:47], v[68:71], v[8:11], 0
    s_nop 11
    v_sub_f32 v32, v32, v48
    v_sub_f32 v33, v33, v48
    v_sub_f32 v34, v34, v48
    v_sub_f32 v35, v35, v48
    v_sub_f32 v36, v36, v48
    v_sub_f32 v37, v37, v48
    v_sub_f32 v38, v38, v48
    v_sub_f32 v39, v39, v48
    v_sub_f32 v40, v40, v48
    v_sub_f32 v41, v41, v48
    v_sub_f32 v42, v42, v48
    v_sub_f32 v43, v43, v48
    v_sub_f32 v44, v44, v48
    v_sub_f32 v45, v45, v48
    v_sub_f32 v46, v46, v48
    v_sub_f32 v47, v47, v48
    v_exp_f32 v32, v32
    v_exp_f32 v33, v33
    v_exp_f32 v34, v34
    v_exp_f32 v35, v35
    v_exp_f32 v36, v36
    v_exp_f32 v37, v37
    v_exp_f32 v38, v38
    v_exp_f32 v39, v39
    v_exp_f32 v40, v40
    v_exp_f32 v41, v41
    v_exp_f32 v42, v42
    v_exp_f32 v43, v43
    v_exp_f32 v44, v44
    v_exp_f32 v45, v45
    v_exp_f32 v46, v46
    v_exp_f32 v47, v47
    s_nop 1
    v_smfmac_f32_32x32x32_bf16 v[16:31], v[136:139], v[32:39], v1
    v_smfmac_f32_32x32x32_bf16 v[16:31], v[140:143], v[40:47], v1
    v_mfma_f32_32x32x16_bf16 v[32:47], v[72:75], v[8:11], 0
    s_nop 11
    v_sub_f32 v32, v32, v48
    v_sub_f32 v33, v33, v48
    v_sub_f32 v34, v34, v48
    v_sub_f32 v35, v35, v48
    v_sub_f32 v36, v36, v48
    v_sub_f32 v37, v37, v48
    v_sub_f32 v38, v38, v48
    v_sub_f32 v39, v39, v48
    v_sub_f32 v40, v40, v48
    v_sub_f32 v41, v41, v48
    v_sub_f32 v42, v42, v48
    v_sub_f32 v43, v43, v48
    v_sub_f32 v44, v44, v48
    v_sub_f32 v45, v45, v48
    v_sub_f32 v46, v46, v48
    v_sub_f32 v47, v47, v48
    v_exp_f32 v32, v32
    v_exp_f32 v33, v33
    v_exp_f32 v34, v34
    v_exp_f32 v35, v35
    v_exp_f32 v36, v36
    v_exp_f32 v37, v37
    v_exp_f32 v38, v38
    v_exp_f32 v39, v39
    v_exp_f32 v40, v40
    v_exp_f32 v41, v41
    v_exp_f32 v42, v42
    v_exp_f32 v43, v43
    v_exp_f32 v44, v44
    v_exp_f32 v45, v45
    v_exp_f32 v46, v46
    v_exp_f32 v47, v47
    s_nop 1
    v_smfmac_f32_32x32x32_bf16 v[16:31], v[144:147], v[32:39], v1
    v_smfmac_f32_32x32x32_bf16 v[16:31], v[148:151], v[40:47], v1
    v_mfma_f32_32x32x16_bf16 v[32:47], v[76:79], v[8:11], 0
    s_nop 11
    v_sub_f32 v32, v32, v48
    v_sub_f32 v33, v33, v48
    v_sub_f32 v34, v34, v48
    v_sub_f32 v35, v35, v48
    v_sub_f32 v36, v36, v48
    v_sub_f32 v37, v37, v48
    v_sub_f32 v38, v38, v48
    v_sub_f32 v39, v39, v48
    v_sub_f32 v40, v40, v48
    v_sub_f32 v41, v41, v48
    v_sub_f32 v42, v42, v48
    v_sub_f32 v43, v43, v48
    v_sub_f32 v44, v44, v48
    v_sub_f32 v45, v45, v48
    v_sub_f32 v46, v46, v48
    v_sub_f32 v47, v47, v48
    v_exp_f32 v32, v32
    v_exp_f32 v33, v33
    v_exp_f32 v34, v34
    v_exp_f32 v35, v35
    v_exp_f32 v36, v36
    v_exp_f32 v37, v37
    v_exp_f32 v38, v38
    v_exp_f32 v39, v39
    v_exp_f32 v40, v40
    v_exp_f32 v41, v41
    v_exp_f32 v42, v42
    v_exp_f32 v43, v43
    v_exp_f32 v44, v44
    v_exp_f32 v45, v45
    v_exp_f32 v46, v46
    v_exp_f32 v47, v47
    s_nop 1
    v_smfmac_f32_32x32x32_bf16 v[16:31], v[152:155], v[32:39], v1
    v_smfmac_f32_32x32x32_bf16 v[16:31], v[156:159], v[40:47], v1
    v_mfma_f32_32x32x16_bf16 v[32:47], v[80:83], v[8:11], 0
    s_nop 11
    v_sub_f32 v32, v32, v48
    v_sub_f32 v33, v33, v48
    v_sub_f32 v34, v34, v48
    v_sub_f32 v35, v35, v48
    v_sub_f32 v36, v36, v48
    v_sub_f32 v37, v37, v48
    v_sub_f32 v38, v38, v48
    v_sub_f32 v39, v39, v48
    v_sub_f32 v40, v40, v48
    v_sub_f32 v41, v41, v48
    v_sub_f32 v42, v42, v48
    v_sub_f32 v43, v43, v48
    v_sub_f32 v44, v44, v48
    v_sub_f32 v45, v45, v48
    v_sub_f32 v46, v46, v48
    v_sub_f32 v47, v47, v48
    v_exp_f32 v32, v32
    v_exp_f32 v33, v33
    v_exp_f32 v34, v34
    v_exp_f32 v35, v35
    v_exp_f32 v36, v36
    v_exp_f32 v37, v37
    v_exp_f32 v38, v38
    v_exp_f32 v39, v39
    v_exp_f32 v40, v40
    v_exp_f32 v41, v41
    v_exp_f32 v42, v42
    v_exp_f32 v43, v43
    v_exp_f32 v44, v44
    v_exp_f32 v45, v45
    v_exp_f32 v46, v46
    v_exp_f32 v47, v47
    s_nop 1
    v_smfmac_f32_32x32x32_bf16 v[16:31], v[160:163], v[32:39], v1
    v_smfmac_f32_32x32x32_bf16 v[16:31], v[164:167], v[40:47], v1
    v_mfma_f32_32x32x16_bf16 v[32:47], v[84:87], v[8:11], 0
    s_nop 11
    v_sub_f32 v32, v32, v48
    v_sub_f32 v33, v33, v48
    v_sub_f32 v34, v34, v48
    v_sub_f32 v35, v35, v48
    v_sub_f32 v36, v36, v48
    v_sub_f32 v37, v37, v48
    v_sub_f32 v38, v38, v48
    v_sub_f32 v39, v39, v48
    v_sub_f32 v40, v40, v48
    v_sub_f32 v41, v41, v48
    v_sub_f32 v42, v42, v48
    v_sub_f32 v43, v43, v48
    v_sub_f32 v44, v44, v48
    v_sub_f32 v45, v45, v48
    v_sub_f32 v46, v46, v48
    v_sub_f32 v47, v47, v48
    v_exp_f32 v32, v32
    v_exp_f32 v33, v33
    v_exp_f32 v34, v34
    v_exp_f32 v35, v35
    v_exp_f32 v36, v36
    v_exp_f32 v37, v37
    v_exp_f32 v38, v38
    v_exp_f32 v39, v39
    v_exp_f32 v40, v40
    v_exp_f32 v41, v41
    v_exp_f32 v42, v42
    v_exp_f32 v43, v43
    v_exp_f32 v44, v44
    v_exp_f32 v45, v45
    v_exp_f32 v46, v46
    v_exp_f32 v47, v47
    s_nop 1
    v_smfmac_f32_32x32x32_bf16 v[16:31], v[168:171], v[32:39], v1
    v_smfmac_f32_32x32x32_bf16 v[16:31], v[172:175], v[40:47], v1
    v_mfma_f32_32x32x16_bf16 v[32:47], v[88:91], v[8:11], 0
    s_nop 11
    v_sub_f32 v32, v32, v48
    v_sub_f32 v33, v33, v48
    v_sub_f32 v34, v34, v48
    v_sub_f32 v35, v35, v48
    v_sub_f32 v36, v36, v48
    v_sub_f32 v37, v37, v48
    v_sub_f32 v38, v38, v48
    v_sub_f32 v39, v39, v48
    v_sub_f32 v40, v40, v48
    v_sub_f32 v41, v41, v48
    v_sub_f32 v42, v42, v48
    v_sub_f32 v43, v43, v48
    v_sub_f32 v44, v44, v48
    v_sub_f32 v45, v45, v48
    v_sub_f32 v46, v46, v48
    v_sub_f32 v47, v47, v48
    v_exp_f32 v32, v32
    v_exp_f32 v33, v33
    v_exp_f32 v34, v34
    v_exp_f32 v35, v35
    v_exp_f32 v36, v36
    v_exp_f32 v37, v37
    v_exp_f32 v38, v38
    v_exp_f32 v39, v39
    v_exp_f32 v40, v40
    v_exp_f32 v41, v41
    v_exp_f32 v42, v42
    v_exp_f32 v43, v43
    v_exp_f32 v44, v44
    v_exp_f32 v45, v45
    v_exp_f32 v46, v46
    v_exp_f32 v47, v47
    s_nop 1
    v_smfmac_f32_32x32x32_bf16 v[16:31], v[176:179], v[32:39], v1
    v_smfmac_f32_32x32x32_bf16 v[16:31], v[180:183], v[40:47], v1
    v_mfma_f32_32x32x16_bf16 v[32:47], v[92:95], v[8:11], 0
    s_nop 11
    v_sub_f32 v32, v32, v48
    v_sub_f32 v33, v33, v48
    v_sub_f32 v34, v34, v48
    v_sub_f32 v35, v35, v48
    v_sub_f32 v36, v36, v48
    v_sub_f32 v37, v37, v48
    v_sub_f32 v38, v38, v48
    v_sub_f32 v39, v39, v48
    v_sub_f32 v40, v40, v48
    v_sub_f32 v41, v41, v48
    v_sub_f32 v42, v42, v48
    v_sub_f32 v43, v43, v48
    v_sub_f32 v44, v44, v48
    v_sub_f32 v45, v45, v48
    v_sub_f32 v46, v46, v48
    v_sub_f32 v47, v47, v48
    v_exp_f32 v32, v32
    v_exp_f32 v33, v33
    v_exp_f32 v34, v34
    v_exp_f32 v35, v35
    v_exp_f32 v36, v36
    v_exp_f32 v37, v37
    v_exp_f32 v38, v38
    v_exp_f32 v39, v39
    v_exp_f32 v40, v40
    v_exp_f32 v41, v41
    v_exp_f32 v42, v42
    v_exp_f32 v43, v43
    v_exp_f32 v44, v44
    v_exp_f32 v45, v45
    v_exp_f32 v46, v46
    v_exp_f32 v47, v47
    s_nop 1
    v_smfmac_f32_32x32x32_bf16 v[16:31], v[184:187], v[32:39], v1
    v_smfmac_f32_32x32x32_bf16 v[16:31], v[188:191], v[40:47], v1
    v_mfma_f32_32x32x16_bf16 v[32:47], v[96:99], v[8:11], 0
    s_nop 11
    v_sub_f32 v32, v32, v48
    v_sub_f32 v33, v33, v48
    v_sub_f32 v34, v34, v48
    v_sub_f32 v35, v35, v48
    v_sub_f32 v36, v36, v48
    v_sub_f32 v37, v37, v48
    v_sub_f32 v38, v38, v48
    v_sub_f32 v39, v39, v48
    v_sub_f32 v40, v40, v48
    v_sub_f32 v41, v41, v48
    v_sub_f32 v42, v42, v48
    v_sub_f32 v43, v43, v48
    v_sub_f32 v44, v44, v48
    v_sub_f32 v45, v45, v48
    v_sub_f32 v46, v46, v48
    v_sub_f32 v47, v47, v48
    v_exp_f32 v32, v32
    v_exp_f32 v33, v33
    v_exp_f32 v34, v34
    v_exp_f32 v35, v35
    v_exp_f32 v36, v36
    v_exp_f32 v37, v37
    v_exp_f32 v38, v38
    v_exp_f32 v39, v39
    v_exp_f32 v40, v40
    v_exp_f32 v41, v41
    v_exp_f32 v42, v42
    v_exp_f32 v43, v43
    v_exp_f32 v44, v44
    v_exp_f32 v45, v45
    v_exp_f32 v46, v46
    v_exp_f32 v47, v47
    s_nop 1
    v_smfmac_f32_32x32x32_bf16 v[16:31], v[192:195], v[32:39], v1
    v_smfmac_f32_32x32x32_bf16 v[16:31], v[196:199], v[40:47], v1
    v_mfma_f32_32x32x16_bf16 v[32:47], v[100:103], v[8:11], 0
    s_nop 11
    v_sub_f32 v32, v32, v48
    v_sub_f32 v33, v33, v48
    v_sub_f32 v34, v34, v48
    v_sub_f32 v35, v35, v48
    v_sub_f32 v36, v36, v48
    v_sub_f32 v37, v37, v48
    v_sub_f32 v38, v38, v48
    v_sub_f32 v39, v39, v48
    v_sub_f32 v40, v40, v48
    v_sub_f32 v41, v41, v48
    v_sub_f32 v42, v42, v48
    v_sub_f32 v43, v43, v48
    v_sub_f32 v44, v44, v48
    v_sub_f32 v45, v45, v48
    v_sub_f32 v46, v46, v48
    v_sub_f32 v47, v47, v48
    v_exp_f32 v32, v32
    v_exp_f32 v33, v33
    v_exp_f32 v34, v34
    v_exp_f32 v35, v35
    v_exp_f32 v36, v36
    v_exp_f32 v37, v37
    v_exp_f32 v38, v38
    v_exp_f32 v39, v39
    v_exp_f32 v40, v40
    v_exp_f32 v41, v41
    v_exp_f32 v42, v42
    v_exp_f32 v43, v43
    v_exp_f32 v44, v44
    v_exp_f32 v45, v45
    v_exp_f32 v46, v46
    v_exp_f32 v47, v47
    s_nop 1
    v_smfmac_f32_32x32x32_bf16 v[16:31], v[200:203], v[32:39], v1
    v_smfmac_f32_32x32x32_bf16 v[16:31], v[204:207], v[40:47], v1
    v_mfma_f32_32x32x16_bf16 v[32:47], v[104:107], v[8:11], 0
    s_nop 11
    v_sub_f32 v32, v32, v48
    v_sub_f32 v33, v33, v48
    v_sub_f32 v34, v34, v48
    v_sub_f32 v35, v35, v48
    v_sub_f32 v36, v36, v48
    v_sub_f32 v37, v37, v48
    v_sub_f32 v38, v38, v48
    v_sub_f32 v39, v39, v48
    v_sub_f32 v40, v40, v48
    v_sub_f32 v41, v41, v48
    v_sub_f32 v42, v42, v48
    v_sub_f32 v43, v43, v48
    v_sub_f32 v44, v44, v48
    v_sub_f32 v45, v45, v48
    v_sub_f32 v46, v46, v48
    v_sub_f32 v47, v47, v48
    v_exp_f32 v32, v32
    v_exp_f32 v33, v33
    v_exp_f32 v34, v34
    v_exp_f32 v35, v35
    v_exp_f32 v36, v36
    v_exp_f32 v37, v37
    v_exp_f32 v38, v38
    v_exp_f32 v39, v39
    v_exp_f32 v40, v40
    v_exp_f32 v41, v41
    v_exp_f32 v42, v42
    v_exp_f32 v43, v43
    v_exp_f32 v44, v44
    v_exp_f32 v45, v45
    v_exp_f32 v46, v46
    v_exp_f32 v47, v47
    s_nop 1
    v_smfmac_f32_32x32x32_bf16 v[16:31], v[208:211], v[32:39], v1
    v_smfmac_f32_32x32x32_bf16 v[16:31], v[212:215], v[40:47], v1
    v_mfma_f32_32x32x16_bf16 v[32:47], v[108:111], v[8:11], 0
    s_nop 11
    v_sub_f32 v32, v32, v48
    v_sub_f32 v33, v33, v48
    v_sub_f32 v34, v34, v48
    v_sub_f32 v35, v35, v48
    v_sub_f32 v36, v36, v48
    v_sub_f32 v37, v37, v48
    v_sub_f32 v38, v38, v48
    v_sub_f32 v39, v39, v48
    v_sub_f32 v40, v40, v48
    v_sub_f32 v41, v41, v48
    v_sub_f32 v42, v42, v48
    v_sub_f32 v43, v43, v48
    v_sub_f32 v44, v44, v48
    v_sub_f32 v45, v45, v48
    v_sub_f32 v46, v46, v48
    v_sub_f32 v47, v47, v48
    v_exp_f32 v32, v32
    v_exp_f32 v33, v33
    v_exp_f32 v34, v34
    v_exp_f32 v35, v35
    v_exp_f32 v36, v36
    v_exp_f32 v37, v37
    v_exp_f32 v38, v38
    v_exp_f32 v39, v39
    v_exp_f32 v40, v40
    v_exp_f32 v41, v41
    v_exp_f32 v42, v42
    v_exp_f32 v43, v43
    v_exp_f32 v44, v44
    v_exp_f32 v45, v45
    v_exp_f32 v46, v46
    v_exp_f32 v47, v47
    s_nop 1
    v_smfmac_f32_32x32x32_bf16 v[16:31], v[216:219], v[32:39], v1
    v_smfmac_f32_32x32x32_bf16 v[16:31], v[220:223], v[40:47], v1
    v_mfma_f32_32x32x16_bf16 v[32:47], v[112:115], v[8:11], 0
    s_nop 11
    v_sub_f32 v32, v32, v48
    v_sub_f32 v33, v33, v48
    v_sub_f32 v34, v34, v48
    v_sub_f32 v35, v35, v48
    v_sub_f32 v36, v36, v48
    v_sub_f32 v37, v37, v48
    v_sub_f32 v38, v38, v48
    v_sub_f32 v39, v39, v48
    v_sub_f32 v40, v40, v48
    v_sub_f32 v41, v41, v48
    v_sub_f32 v42, v42, v48
    v_sub_f32 v43, v43, v48
    v_sub_f32 v44, v44, v48
    v_sub_f32 v45, v45, v48
    v_sub_f32 v46, v46, v48
    v_sub_f32 v47, v47, v48
    v_exp_f32 v32, v32
    v_exp_f32 v33, v33
    v_exp_f32 v34, v34
    v_exp_f32 v35, v35
    v_exp_f32 v36, v36
    v_exp_f32 v37, v37
    v_exp_f32 v38, v38
    v_exp_f32 v39, v39
    v_exp_f32 v40, v40
    v_exp_f32 v41, v41
    v_exp_f32 v42, v42
    v_exp_f32 v43, v43
    v_exp_f32 v44, v44
    v_exp_f32 v45, v45
    v_exp_f32 v46, v46
    v_exp_f32 v47, v47
    s_nop 1
    v_smfmac_f32_32x32x32_bf16 v[16:31], v[224:227], v[32:39], v1
    v_smfmac_f32_32x32x32_bf16 v[16:31], v[228:231], v[40:47], v1
    v_mfma_f32_32x32x16_bf16 v[32:47], v[116:119], v[8:11], 0
    s_nop 11
    v_sub_f32 v32, v32, v48
    v_sub_f32 v33, v33, v48
    v_sub_f32 v34, v34, v48
    v_sub_f32 v35, v35, v48
    v_sub_f32 v36, v36, v48
    v_sub_f32 v37, v37, v48
    v_sub_f32 v38, v38, v48
    v_sub_f32 v39, v39, v48
    v_sub_f32 v40, v40, v48
    v_sub_f32 v41, v41, v48
    v_sub_f32 v42, v42, v48
    v_sub_f32 v43, v43, v48
    v_sub_f32 v44, v44, v48
    v_sub_f32 v45, v45, v48
    v_sub_f32 v46, v46, v48
    v_sub_f32 v47, v47, v48
    v_exp_f32 v32, v32
    v_exp_f32 v33, v33
    v_exp_f32 v34, v34
    v_exp_f32 v35, v35
    v_exp_f32 v36, v36
    v_exp_f32 v37, v37
    v_exp_f32 v38, v38
    v_exp_f32 v39, v39
    v_exp_f32 v40, v40
    v_exp_f32 v41, v41
    v_exp_f32 v42, v42
    v_exp_f32 v43, v43
    v_exp_f32 v44, v44
    v_exp_f32 v45, v45
    v_exp_f32 v46, v46
    v_exp_f32 v47, v47
    s_nop 1
    v_smfmac_f32_32x32x32_bf16 v[16:31], v[232:235], v[32:39], v1
    v_smfmac_f32_32x32x32_bf16 v[16:31], v[236:239], v[40:47], v1
    v_mfma_f32_32x32x16_bf16 v[32:47], v[120:123], v[8:11], 0
    s_nop 11
    v_sub_f32 v32, v32, v48
    v_sub_f32 v33, v33, v48
    v_sub_f32 v34, v34, v48
    v_sub_f32 v35, v35, v48
    v_sub_f32 v36, v36, v48
    v_sub_f32 v37, v37, v48
    v_sub_f32 v38, v38, v48
    v_sub_f32 v39, v39, v48
    v_sub_f32 v40, v40, v48
    v_sub_f32 v41, v41, v48
    v_sub_f32 v42, v42, v48
    v_sub_f32 v43, v43, v48
    v_sub_f32 v44, v44, v48
    v_sub_f32 v45, v45, v48
    v_sub_f32 v46, v46, v48
    v_sub_f32 v47, v47, v48
    v_exp_f32 v32, v32
    v_exp_f32 v33, v33
    v_exp_f32 v34, v34
    v_exp_f32 v35, v35
    v_exp_f32 v36, v36
    v_exp_f32 v37, v37
    v_exp_f32 v38, v38
    v_exp_f32 v39, v39
    v_exp_f32 v40, v40
    v_exp_f32 v41, v41
    v_exp_f32 v42, v42
    v_exp_f32 v43, v43
    v_exp_f32 v44, v44
    v_exp_f32 v45, v45
    v_exp_f32 v46, v46
    v_exp_f32 v47, v47
    s_nop 1
    v_smfmac_f32_32x32x32_bf16 v[16:31], v[240:243], v[32:39], v1
    v_smfmac_f32_32x32x32_bf16 v[16:31], v[244:247], v[40:47], v1
    v_mfma_f32_32x32x16_bf16 v[32:47], v[124:127], v[8:11], 0
    s_nop 11
    v_sub_f32 v32, v32, v48
    v_sub_f32 v33, v33, v48
    v_sub_f32 v34, v34, v48
    v_sub_f32 v35, v35, v48
    v_sub_f32 v36, v36, v48
    v_sub_f32 v37, v37, v48
    v_sub_f32 v38, v38, v48
    v_sub_f32 v39, v39, v48
    v_sub_f32 v40, v40, v48
    v_sub_f32 v41, v41, v48
    v_sub_f32 v42, v42, v48
    v_sub_f32 v43, v43, v48
    v_sub_f32 v44, v44, v48
    v_sub_f32 v45, v45, v48
    v_sub_f32 v46, v46, v48
    v_sub_f32 v47, v47, v48
    v_exp_f32 v32, v32
    v_exp_f32 v33, v33
    v_exp_f32 v34, v34
    v_exp_f32 v35, v35
    v_exp_f32 v36, v36
    v_exp_f32 v37, v37
    v_exp_f32 v38, v38
    v_exp_f32 v39, v39
    v_exp_f32 v40, v40
    v_exp_f32 v41, v41
    v_exp_f32 v42, v42
    v_exp_f32 v43, v43
    v_exp_f32 v44, v44
    v_exp_f32 v45, v45
    v_exp_f32 v46, v46
    v_exp_f32 v47, v47
    s_nop 1
    v_smfmac_f32_32x32x32_bf16 v[16:31], v[248:251], v[32:39], v1
    v_smfmac_f32_32x32x32_bf16 v[16:31], v[252:255], v[40:47], v1
    s_nop 11
    ds_write_b128 v3, v[16:19]
    ds_write_b128 v3, v[20:23] offset:1024
    ds_write_b64 v4, v[24:25] offset:2048
    s_add_u32 s82, s82, 1
    v_mov_b32 v6, s82
    ds_write_b32 v12, v6
L_lw_19:
    ds_read_b32 v6, v13 offset:16
    s_waitcnt lgkmcnt(0)
    v_cmp_le_u32 vcc, s82, v6
    s_cmp_eq_u64 vcc, -1
    s_cbranch_scc1 L_lwe_20
    s_sub_u32 s60, s60, 1
    s_cbranch_scc1 L_bail
    s_sleep 1
    s_branch L_lw_19
L_lwe_20:
    s_cmp_lg_u32 s59, 0
    s_cbranch_scc1 L_slow_nofin
    s_and_b32 s68, s81, 1
    s_lshl_b32 s68, s68, 7
    s_add_u32 s68, s68, 155904
    v_and_b32 v15, 31, v0
    v_lshlrev_b32 v15, 2, v15
    v_add_u32 v15, s68, v15
    ds_read_b32 v15, v15
    v_add_u32 v30, 2048, v4
    s_and_b32 s68, s81, 1
    s_lshl_b32 s69, s53, 1
    s_add_u32 s68, s68, s69
    s_lshl_b32 s68, s68, 3
    s_add_u32 s68, s68, s54
    s_lshl_b32 s68, s68, 2
    s_lshr_b32 s69, s81, 1
    s_add_u32 s68, s68, s69
    s_lshl_b32 s68, s68, 11
    s_add_u32 s68, s68, 5242880
    s_waitcnt lgkmcnt(0)
    ds_read_b32 v16, v30 offset:0
    ds_read_b32 v17, v30 offset:2560
    ds_read_b32 v18, v30 offset:5120
    ds_read_b32 v19, v30 offset:7680
    ds_read_b128 v[32:35], v3 offset:0
    ds_read_b128 v[36:39], v3 offset:2560
    ds_read_b128 v[40:43], v3 offset:5120
    ds_read_b128 v[44:47], v3 offset:7680
    ds_read_b128 v[48:51], v3 offset:1024
    ds_read_b128 v[52:55], v3 offset:3584
    ds_read_b128 v[56:59], v3 offset:6144
    ds_read_b128 v[60:63], v3 offset:8704
    s_waitcnt lgkmcnt(8)
    v_pk_add_f32 v[16:17], v[16:17], v[18:19]
    v_add_f32 v16, v16, v17
    v_rcp_f32 v17, v16
    s_nop 0
    v_mul_f32 v18, v17, v15
    s_waitcnt lgkmcnt(4)
    v_pk_add_f32 v[32:33], v[32:33], v[36:37]
    v_pk_add_f32 v[40:41], v[40:41], v[44:45]
    v_pk_add_f32 v[34:35], v[34:35], v[38:39]
    v_pk_add_f32 v[42:43], v[42:43], v[46:47]
    v_pk_add_f32 v[32:33], v[32:33], v[40:41]
    v_pk_add_f32 v[34:35], v[34:35], v[42:43]
    v_pk_mul_f32 v[32:33], v[32:33], v[18:19] op_sel_hi:[1,0]
    v_pk_mul_f32 v[34:35], v[34:35], v[18:19] op_sel_hi:[1,0]
    v_cvt_pk_bf16_f32 v22, v32, v33
    v_cvt_pk_bf16_f32 v23, v34, v35
    v_mov_b32 v20, s52
    v_mov_b32 v26, s52
    s_waitcnt lgkmcnt(0)
    v_pk_add_f32 v[48:49], v[48:49], v[52:53]
    v_pk_add_f32 v[56:57], v[56:57], v[60:61]
    v_pk_add_f32 v[50:51], v[50:51], v[54:55]
    v_pk_add_f32 v[58:59], v[58:59], v[62:63]
    v_pk_add_f32 v[48:49], v[48:49], v[56:57]
    v_pk_add_f32 v[50:51], v[50:51], v[58:59]
    v_pk_mul_f32 v[48:49], v[48:49], v[18:19] op_sel_hi:[1,0]
    v_pk_mul_f32 v[50:51], v[50:51], v[18:19] op_sel_hi:[1,0]
    v_cvt_pk_bf16_f32 v24, v48, v49
    v_cvt_pk_bf16_f32 v25, v50, v51
    buffer_store_dwordx4 v[20:23], v2, s[48:51], s68 offen sc1
    buffer_store_dwordx4 v[24:27], v2, s[48:51], s68 offen offset:1024 sc1
L_slow_nofin:
    s_add_u32 s82, s82, 1
    v_mov_b32 v6, s82
    ds_write_b32 v12, v6
L_lw_21:
    ds_read_b32 v6, v13 offset:16
    s_waitcnt lgkmcnt(0)
    v_cmp_le_u32 vcc, s82, v6
    s_cmp_eq_u64 vcc, -1
    s_cbranch_scc1 L_lwe_22
    s_sub_u32 s60, s60, 1
    s_cbranch_scc1 L_bail
    s_sleep 1
    s_branch L_lw_21
L_lwe_22:
    s_cmp_lg_u32 s80, 0
    s_cbranch_scc1 L_slow_loop
L_att_end:
    s_endpgm
L_war_4:
L_lw_23:
    ds_read_b32 v6, v5 offset:32
    s_waitcnt lgkmcnt(0)
    v_cmp_le_u32 vcc, 1, v6
    s_cmp_eq_u64 vcc, -1
    s_cbranch_scc1 L_lwe_24
    s_sub_u32 s60, s60, 1
    s_cbranch_scc1 L_bail
    s_sleep 1
    s_branch L_lw_23
L_lwe_24:
    s_branch L_warb_5
L_war_6:
L_lw_25:
    ds_read_b32 v6, v5 offset:36
    s_waitcnt lgkmcnt(0)
    v_cmp_le_u32 vcc, 1, v6
    s_cmp_eq_u64 vcc, -1
    s_cbranch_scc1 L_lwe_26
    s_sub_u32 s60, s60, 1
    s_cbranch_scc1 L_bail
    s_sleep 1
    s_branch L_lw_25
L_lwe_26:
    s_branch L_warb_7
L_war_8:
L_lw_27:
    ds_read_b32 v6, v5 offset:40
    s_waitcnt lgkmcnt(0)
    v_cmp_le_u32 vcc, 1, v6
    s_cmp_eq_u64 vcc, -1
    s_cbranch_scc1 L_lwe_28
    s_sub_u32 s60, s60, 1
    s_cbranch_scc1 L_bail
    s_sleep 1
    s_branch L_lw_27
L_lwe_28:
    s_branch L_warb_9
L_war_10:
L_lw_29:
    ds_read_b32 v6, v5 offset:44
    s_waitcnt lgkmcnt(0)
    v_cmp_le_u32 vcc, 1, v6
    s_cmp_eq_u64 vcc, -1
    s_cbranch_scc1 L_lwe_30
    s_sub_u32 s60, s60, 1
    s_cbranch_scc1 L_bail
    s_sleep 1
    s_branch L_lw_29
L_lwe_30:
    s_branch L_warb_11
L_war_12:
L_lw_31:
    ds_read_b32 v6, v5 offset:48
    s_waitcnt lgkmcnt(0)
    v_cmp_le_u32 vcc, 1, v6
    s_cmp_eq_u64 vcc, -1
    s_cbranch_scc1 L_lwe_32
    s_sub_u32 s60, s60, 1
    s_cbranch_scc1 L_bail
    s_sleep 1
    s_branch L_lw_31
L_lwe_32:
    s_branch L_warb_13
L_gemm:
    s_mov_b32 s56, s58
    s_mul_i32 s57, s57, 28
    s_add_u32 s57, s57, s56
    s_lshr_b32 s56, s57, 3
    s_and_b32 s57, s57, 7
    s_and_b32 s59, s3, 3
    s_mov_b32 s60, 0x40000
    s_mov_b32 s6, 2097152
    s_mov_b32 s7, 0x00020000
    s_mov_b32 s10, 524288
    s_mov_b32 s11, 0x00020000
    s_mov_b32 s22, 524288
    s_mov_b32 s23, 0x00020000
    s_mov_b32 s26, 7340032
    s_mov_b32 s27, 0x00020000
    s_mov_b32 s30, 3584
    s_mov_b32 s31, 0x00020000
    s_mov_b32 s34, 7340032
    s_mov_b32 s35, 0x00020000
    s_mov_b32 s38, 4096
    s_mov_b32 s39, 0x00020000
    s_mov_b32 s42, 1024
    s_mov_b32 s43, 0x00020000
    s_mov_b32 s46, 2097152
    s_mov_b32 s47, 0x00020000
    s_mov_b32 s50, 268435456
    s_mov_b32 s51, 0x00020000
    v_lshlrev_b32 v4, 2, v0
    v_add_u32 v4, 155648, v4
    v_mov_b32 v5, 0
    ds_write_b32 v4, v5
    s_mul_i32 s61, s59, 28672
    s_and_b32 s80, s53, 3
    s_lshl_b32 s80, s80, 1
    s_lshl_b32 s81, s80, 5
    v_lshlrev_b32 v21, 2, v0
    v_xor_b32 v21, s81, v21
    v_lshrrev_b32 v157, 4, v0
    v_lshlrev_b32 v157, 3, v157
    v_and_b32 v158, 31, v0
    v_lshlrev_b32 v158, 1, v158
    s_waitcnt lgkmcnt(0)
    s_load_dword s52, s[48:49], 0
    s_mov_b64 s[20:21], s[64:65]
    s_mov_b64 s[24:25], s[68:69]
    s_mov_b64 s[28:29], s[70:71]
    s_mov_b64 s[32:33], s[72:73]
    s_mov_b64 s[36:37], s[74:75]
    s_mov_b64 s[40:41], s[76:77]
    s_mov_b64 s[44:45], s[78:79]
    v_lshlrev_b32 v5, 4, v0
    v_lshrrev_b32 v29, 3, v0
    v_and_b32 v30, 7, v0
    v_bfe_u32 v24, v0, 4, 1
    v_lshlrev_b32 v24, 2, v24
    v_xor_b32 v30, v30, v24
    v_lshlrev_b32 v30, 4, v30
    s_mov_b32 s68, 3584
    v_mul_lo_u32 v6, v29, s68
    v_add_u32 v6, v6, v30
    v_add_u32 v7, 27648, v6
    s_mov_b32 s68, 4096
    v_mul_lo_u32 v24, v29, s68
    v_add_u32 v24, v24, v30
    v_add_u32 v25, 31744, v24
    s_mov_b32 s68, 1024
    v_mul_lo_u32 v26, v29, s68
    v_add_u32 v26, v26, v30
    v_add_u32 v27, 7168, v26
    v_xor_b32 v7, 32, v7
    v_and_b32 v159, 32, v0
    v_xor_b32 v24, v159, v24
    v_xor_b32 v25, v159, v25
    v_lshrrev_b32 v23, 4, v0
    v_and_b32 v22, 7, v0
    v_xor_b32 v22, v22, v23
    v_lshlrev_b32 v22, 4, v22
    v_lshl_add_u32 v22, v29, 10, v22
    v_xor_b32 v23, 64, v22
    v_add_u32 v23, 7168, v23
    s_lshl_b32 s67, s59, 17
    s_lshl_b32 s68, s54, 7
    s_add_u32 s73, s67, s68
    s_lshl_b32 s68, s80, 14
    s_add_u32 s67, s73, s68
    s_lshl_b32 s66, s53, 16
    s_lshl_b32 s68, s59, 8
    s_add_u32 s66, s66, s68
    s_and_b32 s68, s80, 4
    s_lshl_b32 s68, s68, 5
    s_add_u32 s66, s66, s68
    v_lshrrev_b32 v30, 5, v0
    v_lshrrev_b32 v20, 4, v0
    v_and_b32 v19, 15, v0
    v_bfe_u32 v18, v0, 4, 1
    v_bfe_u32 v29, v0, 2, 2
    v_lshrrev_b32 v31, 1, v29
    v_lshlrev_b32 v31, 6, v31
    v_lshl_add_u32 v31, v29, 7, v31
    v_lshl_add_u32 v31, v18, 5, v31
    v_and_b32 v29, 3, v0
    v_lshl_add_u32 v31, v29, 3, v31
    v_add_u32 v31, s61, v31
    s_and_b32 s70, s59, 1
    s_lshr_b32 s71, s59, 1
    s_lshl_b32 s68, s70, 6
    s_lshl_b32 s69, s71, 6
    v_lshl_add_u32 v1, v20, 10, v31
    v_xor_b32 v1, s68, v1
    v_xor_b32 v2, 32, v1
    v_xor_b32 v3, 64, v1
    v_xor_b32 v4, 96, v1
    v_lshl_add_u32 v8, v20, 9, v31
    v_xor_b32 v8, s69, v8
    v_lshl_add_u32 v248, v18, 9, v31
    v_lshl_add_u32 v248, v30, 11, v248
    v_xor_b32 v248, s68, v248
    v_xor_b32 v249, 32, v248
    v_xor_b32 v254, 64, v248
    v_xor_b32 v17, 96, v248
    v_and_b32 v253, 1, v0
    v_lshlrev_b32 v253, 16, v253
    v_and_b32 v244, 2, v0
    v_lshl_add_u32 v253, v244, 12, v253
    v_lshlrev_b32 v28, 4, v19
    s_lshl_b32 s68, s71, 9
    v_lshl_add_u32 v244, v20, 13, v28
    v_add_u32 v244, s68, v244
    v_xor_b32 v245, 512, v244
    v_lshl_add_u32 v28, v18, 9, v28
    v_lshl_add_u32 v28, v30, 13, v28
    s_lshl_b32 s68, s70, 11
    v_add_u32 v246, s68, v5
    v_xor_b32 v247, 2048, v246
    s_xor_b32 s68, s59, 1
    s_mul_i32 s68, s68, 28672
    v_add_u32 v250, s68, v5
    s_xor_b32 s68, s59, 2
    s_mul_i32 s68, s68, 28672
    v_add_u32 v251, s68, v5
    s_xor_b32 s68, s59, 3
    s_mul_i32 s68, s68, 28672
    v_add_u32 v252, s68, v5
    v_lshlrev_b32 v10, 2, v29
    v_add_u32 v10, 155648, v10
    s_lshl_b32 s68, s59, 2
    s_add_u32 s68, s68, 155648
    v_mov_b32 v11, s68
    s_lshl_b32 s68, s59, 1
    s_lshr_b32 s68, 0x06, s68
    s_and_b32 s68, s68, 3
    s_mul_i32 s68, s68, 10240
    s_add_u32 s68, s68, 122880
    v_add_u32 v13, s68, v5
    s_add_u32 s68, s68, 2048
    v_lshlrev_b32 v14, 3, v0
    v_add_u32 v14, s68, v14
    s_add_u32 s68, s68, 508
    v_mul_u32_u24 v12, 2560, v29
    v_add_u32 v12, s68, v12
    v_add_u32 v15, s61, v5
    v_lshrrev_b32 v255, 2, v0
    v_lshlrev_b32 v255, 10, v255
    v_bfe_u32 v31, v0, 3, 2
    v_xor_b32 v31, v31, v29
    v_lshl_add_u32 v255, v31, 4, v255
    v_bfe_u32 v31, v0, 1, 2
    v_xor_b32 v31, v31, v30
    v_lshlrev_b32 v31, 4, v31
    v_lshl_add_u32 v31, v18, 3, v31
    v_lshl_add_u32 v16, v19, 6, v31
    v_add_u32 v16, s61, v16
    v_and_b32 v31, 31, v0
    s_mov_b32 s62, 8
    v_bfe_u32 v29, v0, 1, 3
    v_xor_b32 v29, v29, v30
    s_and_b32 s68, s80, 3
    s_lshl_b32 s68, s68, 1
    v_xor_b32 v29, s68, v29
    v_lshlrev_b32 v29, 4, v29
    v_lshl_add_u32 v152, v31, 7, v29
    v_add_u32 v152, s61, v152
    v_xor_b32 v153, 32, v152
    v_xor_b32 v154, 64, v152
    v_xor_b32 v155, 96, v152
    s_add_u32 s68, s61, 26624
    v_lshlrev_b32 v156, 4, v30
    v_add_u32 v156, s68, v156
    s_lshl_b32 s81, s59, 13
    s_add_u32 s81, s81, 122880
    v_mov_b64 v[176:177], 0
    v_mov_b64 v[178:179], 0
    v_mov_b64 v[180:181], 0
    v_mov_b64 v[182:183], 0
    s_waitcnt lgkmcnt(0)
    s_mul_i32 s52, s52, 0x9E3779B1
    s_add_u32 s52, s52, 0x7F4A7C15
    s_mul_i32 s70, s59, 1835008
    s_lshl_b32 s68, s56, 7
    s_add_u32 s70, s70, s68
    s_lshl_b32 s72, s59, 20
    s_lshl_b32 s68, s53, 7
    s_add_u32 s72, s72, s68
    s_lshl_b32 s63, s56, 1
    s_xor_b32 s63, s63, s57
    s_and_b32 s63, s63, 7
    s_lshl_b32 s100, s53, 1
    s_xor_b32 s100, s100, s54
    s_and_b32 s100, s100, 7
    s_lshl_b32 s101, s59, 19
    s_lshl_b32 s68, s57, 10
    s_add_u32 s101, s101, s68
    s_add_u32 s101, s101, 1048576
    s_and_b32 s68, s63, 6
    s_lshl_b32 s68, s68, 14
    s_add_u32 s101, s101, s68
    s_and_b32 s68, s63, 1
    s_lshl_b32 s68, s68, 11
    s_add_u32 s0, s61, s68
    s_sub_u32 s1, s61, s68
    s_and_b32 s68, s100, 1
    s_lshl_b32 s68, s68, 11
    s_add_u32 s76, s61, s68
    s_sub_u32 s77, s61, s68
    s_lshl_b32 s68, s59, 9
    s_add_u32 s68, s68, 156160
    v_lshlrev_b32 v188, 3, v0
    v_add_u32 v189, s68, v188
    v_add_u32 v188, 156160, v188
    v_and_b32 v190, 31, v0
    v_lshlrev_b32 v190, 2, v190
    v_add_u32 v190, 155904, v190
    v_lshlrev_b32 v222, 7, v0
    s_xor_b32 s68, s63, 0
    s_mul_i32 s68, s68, 57344
    s_add_u32 s12, s68, s70
    s_xor_b32 s68, s63, 1
    s_mul_i32 s68, s68, 57344
    s_add_u32 s13, s68, s70
    s_xor_b32 s68, s63, 2
    s_mul_i32 s68, s68, 57344
    s_add_u32 s14, s68, s70
    s_xor_b32 s68, s63, 3
    s_mul_i32 s68, s68, 57344
    s_add_u32 s15, s68, s70
    s_xor_b32 s68, s63, 4
    s_mul_i32 s68, s68, 57344
    s_add_u32 s16, s68, s70
    s_xor_b32 s68, s63, 5
    s_mul_i32 s68, s68, 57344
    s_add_u32 s17, s68, s70
    s_xor_b32 s68, s63, 6
    s_mul_i32 s68, s68, 57344
    s_add_u32 s18, s68, s70
    s_xor_b32 s68, s63, 7
    s_mul_i32 s68, s68, 57344
    s_add_u32 s19, s68, s70
    v_mov_b64 v[48:49], 0
    v_mov_b64 v[50:51], 0
    v_mov_b64 v[52:53], 0
    v_mov_b64 v[54:55], 0
    v_mov_b64 v[56:57], 0
    v_mov_b64 v[58:59], 0
    v_mov_b64 v[60:61], 0
    v_mov_b64 v[62:63], 0
    v_mov_b64 v[64:65], 0
    v_mov_b64 v[66:67], 0
    v_mov_b64 v[68:69], 0
    v_mov_b64 v[70:71], 0
    v_mov_b64 v[72:73], 0
    v_mov_b64 v[74:75], 0
    v_mov_b64 v[76:77], 0
    v_mov_b64 v[78:79], 0
    v_mov_b64 v[80:81], 0
    v_mov_b64 v[82:83], 0
    v_mov_b64 v[84:85], 0
    v_mov_b64 v[86:87], 0
    v_mov_b64 v[88:89], 0
    v_mov_b64 v[90:91], 0
    v_mov_b64 v[92:93], 0
    v_mov_b64 v[94:95], 0
    s_barrier
    s_xor_b32 s69, s67, 0
    s_add_u32 m0, s61, 16384
    s_nop 0
    buffer_load_dwordx4 v26, s[8:11], s69 offen lds
    buffer_load_dwordx4 v27, s[8:11], s69 offen offset:1024 lds
    s_add_u32 m0, s61, 0
    s_xor_b32 s68, s66, 0
    buffer_load_dwordx4 v22, s[4:7], s68 offen lds
    buffer_load_dwordx4 v23, s[4:7], s68 offen offset:1024 lds
    s_add_u32 m0, s61, 2048
    s_xor_b32 s68, s66, 16384
    buffer_load_dwordx4 v22, s[4:7], s68 offen lds
    buffer_load_dwordx4 v23, s[4:7], s68 offen offset:1024 lds
    s_barrier
    s_add_u32 m0, s61, 4096
    s_xor_b32 s68, s66, 32768
    buffer_load_dwordx4 v22, s[4:7], s68 offen lds
    buffer_load_dwordx4 v23, s[4:7], s68 offen offset:1024 lds
    s_add_u32 m0, s61, 6144
    s_xor_b32 s68, s66, 49152
    buffer_load_dwordx4 v22, s[4:7], s68 offen lds
    buffer_load_dwordx4 v23, s[4:7], s68 offen offset:1024 lds
    s_xor_b32 s69, s67, 16384
    s_add_u32 m0, s61, 18432
    s_nop 0
    buffer_load_dwordx4 v26, s[8:11], s69 offen lds
    buffer_load_dwordx4 v27, s[8:11], s69 offen offset:1024 lds
    s_xor_b32 s69, s67, 32768
    s_add_u32 m0, s61, 20480
    s_nop 0
    buffer_load_dwordx4 v26, s[8:11], s69 offen lds
    buffer_load_dwordx4 v27, s[8:11], s69 offen offset:1024 lds
    s_xor_b32 s69, s67, 49152
    s_add_u32 m0, s61, 22528
    s_nop 0
    buffer_load_dwordx4 v26, s[8:11], s69 offen lds
    buffer_load_dwordx4 v27, s[8:11], s69 offen offset:1024 lds
    s_barrier
    s_add_u32 m0, s61, 8192
    s_xor_b32 s68, s66, 128
    buffer_load_dwordx4 v22, s[4:7], s68 offen lds
    buffer_load_dwordx4 v23, s[4:7], s68 offen offset:1024 lds
    s_add_u32 m0, s61, 10240
    s_xor_b32 s68, s66, 16512
    buffer_load_dwordx4 v22, s[4:7], s68 offen lds
    buffer_load_dwordx4 v23, s[4:7], s68 offen offset:1024 lds
    s_add_u32 m0, s61, 12288
    s_xor_b32 s68, s66, 32896
    buffer_load_dwordx4 v22, s[4:7], s68 offen lds
    buffer_load_dwordx4 v23, s[4:7], s68 offen offset:1024 lds
    s_add_u32 m0, s61, 14336
    s_xor_b32 s68, s66, 49280
    buffer_load_dwordx4 v22, s[4:7], s68 offen lds
    buffer_load_dwordx4 v23, s[4:7], s68 offen offset:1024 lds
    s_barrier
    s_add_u32 m0, s61, 26624
    s_lshl_b32 s68, s59, 8
    buffer_load_dword v21, s[40:43], s68 offen lds
    s_lshl_b32 s68, s53, 1
    s_lshr_b32 s69, s59, 1
    s_add_u32 s68, s68, s69
    s_lshl_b32 s68, s68, 6
    buffer_load_ushort v224, v158, s[36:39], s68 offen
    s_and_b32 s68, s59, 1
    s_lshl_b32 s68, s68, 6
    s_lshl_b32 s69, s56, 7
    s_add_u32 s68, s68, s69
    buffer_load_dwordx2 v[226:227], v157, s[28:31], s68 offen offset:0
    buffer_load_dwordx2 v[228:229], v157, s[28:31], s68 offen offset:32
    s_xor_b32 s69, s67, 65536
    s_add_u32 m0, s81, 0
    s_nop 0
    buffer_load_dwordx4 v26, s[8:11], s69 offen lds
    buffer_load_dwordx4 v27, s[8:11], s69 offen offset:1024 lds
    s_waitcnt vmcnt(14)
    s_barrier
    s_xor_b32 s69, s67, 81920
    s_add_u32 m0, s81, 2048
    s_nop 0
    buffer_load_dwordx4 v26, s[8:11], s69 offen lds
    buffer_load_dwordx4 v27, s[8:11], s69 offen offset:1024 lds
    s_xor_b32 s69, s67, 98304
    s_add_u32 m0, s81, 4096
    s_nop 0
    buffer_load_dwordx4 v26, s[8:11], s69 offen lds
    buffer_load_dwordx4 v27, s[8:11], s69 offen offset:1024 lds
    s_xor_b32 s69, s67, 114688
    s_add_u32 m0, s81, 6144
    s_nop 0
    buffer_load_dwordx4 v26, s[8:11], s69 offen lds
    buffer_load_dwordx4 v27, s[8:11], s69 offen offset:1024 lds
    s_waitcnt vmcnt(8)
    ds_read_b128 v[96:99], v152 offset:0
    ds_read_b128 v[100:103], v152 offset:4096
    ds_read_b128 v[128:131], v156 offset:0
    ds_read_b128 v[104:107], v153 offset:0
    ds_read_b128 v[108:111], v153 offset:4096
    ds_read_b128 v[132:135], v156 offset:32
    ds_read_b128 v[112:115], v154 offset:0
    ds_read_b128 v[116:119], v154 offset:4096
    ds_read_b128 v[136:139], v156 offset:64
    ds_read_b128 v[120:123], v155 offset:0
    ds_read_b128 v[124:127], v155 offset:4096
    ds_read_b128 v[140:143], v156 offset:96
    s_waitcnt lgkmcnt(9)
    v_dot2c_f32_bf16 v176, v128, v96
    v_dot2c_f32_bf16 v178, v129, v97
    v_dot2c_f32_bf16 v180, v130, v98
    v_dot2c_f32_bf16 v182, v131, v99
    v_dot2c_f32_bf16 v177, v128, v100
    v_dot2c_f32_bf16 v179, v129, v101
    v_dot2c_f32_bf16 v181, v130, v102
    v_dot2c_f32_bf16 v183, v131, v103
    s_waitcnt lgkmcnt(6)
    v_dot2c_f32_bf16 v176, v132, v104
    v_dot2c_f32_bf16 v178, v133, v105
    v_dot2c_f32_bf16 v180, v134, v106
    v_dot2c_f32_bf16 v182, v135, v107
    v_dot2c_f32_bf16 v177, v132, v108
    v_dot2c_f32_bf16 v179, v133, v109
    v_dot2c_f32_bf16 v181, v134, v110
    v_dot2c_f32_bf16 v183, v135, v111
    s_waitcnt lgkmcnt(3)
    v_dot2c_f32_bf16 v176, v136, v112
    v_dot2c_f32_bf16 v178, v137, v113
    v_dot2c_f32_bf16 v180, v138, v114
    v_dot2c_f32_bf16 v182, v139, v115
    v_dot2c_f32_bf16 v177, v136, v116
    v_dot2c_f32_bf16 v179, v137, v117
    v_dot2c_f32_bf16 v181, v138, v118
    v_dot2c_f32_bf16 v183, v139, v119
    s_waitcnt lgkmcnt(0)
    v_dot2c_f32_bf16 v176, v140, v120
    v_dot2c_f32_bf16 v178, v141, v121
    v_dot2c_f32_bf16 v180, v142, v122
    v_dot2c_f32_bf16 v182, v143, v123
    v_dot2c_f32_bf16 v177, v140, v124
    v_dot2c_f32_bf16 v179, v141, v125
    v_dot2c_f32_bf16 v181, v142, v126
    v_dot2c_f32_bf16 v183, v143, v127
    ds_read_b128 v[128:131], v156 offset:128
    ds_read_b128 v[132:135], v156 offset:160
    ds_read_b128 v[136:139], v156 offset:192
    ds_read_b128 v[140:143], v156 offset:224
    s_waitcnt vmcnt(4)
    s_barrier
    s_waitcnt vmcnt(0) lgkmcnt(0)
    s_barrier
    s_cmp_ge_u32 s58, 28
    s_cbranch_scc1 L_nh_33
    s_add_u32 m0, s0, 20480
    s_nop 0
    buffer_load_dwordx4 v6, s[24:27], s12 offen lds
    buffer_load_dwordx4 v7, s[24:27], s12 offen offset:1024 lds
    s_add_u32 m0, s1, 22528
    s_nop 0
    buffer_load_dwordx4 v6, s[24:27], s13 offen lds
    buffer_load_dwordx4 v7, s[24:27], s13 offen offset:1024 lds
L_nh_33:
    ds_read_b128 v[96:99], v152 offset:8192
    ds_read_b128 v[100:103], v152 offset:12288
    ds_read_b128 v[104:107], v153 offset:8192
    ds_read_b128 v[108:111], v153 offset:12288
    ds_read_b128 v[112:115], v154 offset:8192
    ds_read_b128 v[116:119], v154 offset:12288
    ds_read_b128 v[120:123], v155 offset:8192
    ds_read_b128 v[124:127], v155 offset:12288
    s_waitcnt lgkmcnt(6)
    v_dot2c_f32_bf16 v176, v128, v96
    v_dot2c_f32_bf16 v178, v129, v97
    v_dot2c_f32_bf16 v180, v130, v98
    v_dot2c_f32_bf16 v182, v131, v99
    v_dot2c_f32_bf16 v177, v128, v100
    v_dot2c_f32_bf16 v179, v129, v101
    v_dot2c_f32_bf16 v181, v130, v102
    v_dot2c_f32_bf16 v183, v131, v103
    s_waitcnt lgkmcnt(4)
    v_dot2c_f32_bf16 v176, v132, v104
    v_dot2c_f32_bf16 v178, v133, v105
    v_dot2c_f32_bf16 v180, v134, v106
    v_dot2c_f32_bf16 v182, v135, v107
    v_dot2c_f32_bf16 v177, v132, v108
    v_dot2c_f32_bf16 v179, v133, v109
    v_dot2c_f32_bf16 v181, v134, v110
    v_dot2c_f32_bf16 v183, v135, v111
    s_waitcnt lgkmcnt(2)
    v_dot2c_f32_bf16 v176, v136, v112
    v_dot2c_f32_bf16 v178, v137, v113
    v_dot2c_f32_bf16 v180, v138, v114
    v_dot2c_f32_bf16 v182, v139, v115
    v_dot2c_f32_bf16 v177, v136, v116
    v_dot2c_f32_bf16 v179, v137, v117
    v_dot2c_f32_bf16 v181, v138, v118
    v_dot2c_f32_bf16 v183, v139, v119
    s_waitcnt lgkmcnt(0)
    v_dot2c_f32_bf16 v176, v140, v120
    v_dot2c_f32_bf16 v178, v141, v121
    v_dot2c_f32_bf16 v180, v142, v122
    v_dot2c_f32_bf16 v182, v143, v123
    v_dot2c_f32_bf16 v177, v140, v124
    v_dot2c_f32_bf16 v179, v141, v125
    v_dot2c_f32_bf16 v181, v142, v126
    v_dot2c_f32_bf16 v183, v143, v127
    s_nop 2
    v_pk_add_f32 v[176:177], v[176:177], v[178:179]
    v_pk_add_f32 v[180:181], v[180:181], v[182:183]
    v_pk_add_f32 v[176:177], v[176:177], v[180:181]
    v_mov_b32 v178, v176
    v_mov_b32 v179, v177
    s_nop 1
    v_permlane32_swap_b32 v176, v178
    v_permlane32_swap_b32 v177, v179
    v_pk_add_f32 v[176:177], v[176:177], v[178:179]
    ds_write_b64 v189, v[176:177]
    v_xor_b32 v26, v159, v26
    v_xor_b32 v27, v159, v27
    s_mov_b32 s66, s101
    s_waitcnt lgkmcnt(0)
    s_barrier
    ds_read_b64 v[180:181], v188 offset:0
    ds_read_b64 v[182:183], v188 offset:512
    ds_read_b64 v[184:185], v188 offset:1024
    ds_read_b64 v[186:187], v188 offset:1536
    s_setprio 3
    s_waitcnt lgkmcnt(0)
    v_pk_add_f32 v[180:181], v[180:181], v[182:183]
    v_pk_add_f32 v[184:185], v[184:185], v[186:187]
    v_pk_add_f32 v[180:181], v[180:181], v[184:185]
    v_mul_f32 v180, 0x3fb8aa3b, v180
    v_mul_f32 v181, 0x3fb8aa3b, v181
    v_mov_b32 v182, 0x42ac0000
    v_med3_f32 v180, v180, -v182, v182
    v_med3_f32 v181, v181, -v182, v182
    v_exp_f32 v18, v180
    v_exp_f32 v19, v181
    s_bitcmp1_b32 s59, 0
    v_add_f32 v180, 1.0, v18
    v_add_f32 v181, 1.0, v19
    v_rcp_f32 v20, v180
    v_rcp_f32 v21, v181
    s_cselect_b64 vcc, -1, 0
    v_cndmask_b32 v31, v18, v19, vcc
    s_bitcmp1_b32 s59, 1
    s_cselect_b64 vcc, -1, 0
    v_cndmask_b32 v20, v20, v21, vcc
    v_lshlrev_b32 v22, 16, v224
    v_mul_f32 v22, v22, v20
    v_mov_b32 v21, v20
    v_mov_b32 v23, v22
    s_nop 1
    v_permlane16_swap_b32 v20, v21
    v_permlane16_swap_b32 v22, v23
    s_cmp_lg_u32 s59, 0
    s_cbranch_scc1 L_nog
    ds_write_b32 v190, v18
    ds_write_b32 v190, v19 offset:128
L_nog:
    v_lshlrev_b32 v32, 16, v226
    v_and_b32 v33, 0xffff0000, v226
    v_lshlrev_b32 v34, 16, v227
    v_and_b32 v35, 0xffff0000, v227
    v_lshlrev_b32 v36, 16, v228
    v_and_b32 v37, 0xffff0000, v228
    v_lshlrev_b32 v38, 16, v229
    v_and_b32 v39, 0xffff0000, v229
    v_lshlrev_b32 v40, 16, v226
    v_and_b32 v41, 0xffff0000, v226
    v_lshlrev_b32 v42, 16, v227
    v_and_b32 v43, 0xffff0000, v227
    v_lshlrev_b32 v44, 16, v228
    v_and_b32 v45, 0xffff0000, v228
    v_lshlrev_b32 v46, 16, v229
    v_and_b32 v47, 0xffff0000, v229
    s_sub_u32 s62, 2, s59
    s_and_b32 s62, s62, 3
    s_add_u32 s29, s62, 1
    s_add_u32 s29, s29, s52
    s_and_b32 s30, s62, 1
    s_lshl_b32 s68, s53, 1
    s_add_u32 s30, s30, s68
    s_lshl_b32 s30, s30, 3
    s_add_u32 s30, s30, s54
    s_lshl_b32 s30, s30, 2
    s_lshr_b32 s68, s62, 1
    s_add_u32 s30, s30, s68
    s_lshl_b32 s30, s30, 11
    s_add_u32 s30, s30, 5242880
    s_movk_i32 s31, 10240
    s_cmp_eq_u32 s59, 0
    s_cselect_b32 s31, -20480, s31
    s_lshl_b32 s68, s62, 2
    s_add_u32 s68, s68, 155680
    v_mov_b32 v19, s68
    s_xor_b32 s68, s100, 0
    s_lshl_b32 s68, s68, 16
    s_add_u32 s4, s68, s72
    s_xor_b32 s68, s100, 1
    s_lshl_b32 s68, s68, 16
    s_add_u32 s5, s68, s72
    s_xor_b32 s68, s100, 2
    s_lshl_b32 s68, s68, 16
    s_add_u32 s6, s68, s72
    s_xor_b32 s68, s100, 3
    s_lshl_b32 s68, s68, 16
    s_add_u32 s7, s68, s72
    s_xor_b32 s68, s100, 4
    s_lshl_b32 s68, s68, 16
    s_add_u32 s8, s68, s72
    s_xor_b32 s68, s100, 5
    s_lshl_b32 s68, s68, 16
    s_add_u32 s9, s68, s72
    s_xor_b32 s68, s100, 6
    s_lshl_b32 s68, s68, 16
    s_add_u32 s10, s68, s72
    s_xor_b32 s68, s100, 7
    s_lshl_b32 s68, s68, 16
    s_add_u32 s11, s68, s72
    s_and_b32 s28, s100, 4
    s_sub_u32 s28, 8, s28
    s_lshl_b32 s28, s28, 16
    s_sub_u32 s39, 14, s59
    s_lshl_b32 s39, s39, 18
    s_sub_u32 s68, s56, 16
    s_mul_i32 s69, s68, 43
    s_lshr_b32 s69, s69, 7
    s_mul_i32 s70, s69, 3
    s_sub_u32 s70, s68, s70
    s_add_u32 s70, s70, 4
    s_lshr_b32 s68, s56, 2
    s_and_b32 s71, s56, 3
    s_cmp_lt_u32 s56, 16
    s_cselect_b32 s69, s68, s69
    s_cselect_b32 s70, s71, s70
    s_lshl_b32 s68, s69, 3
    s_add_u32 s68, s68, s70
    s_mul_i32 s69, s69, 7
    s_add_u32 s70, s70, s69
    s_lshl_b32 s68, s68, 1
    s_and_b32 s69, s59, 1
    s_add_u32 s68, s68, s69
    s_lshl_b32 s68, s68, 3
    s_add_u32 s68, s68, s57
    s_lshl_b32 s68, s68, 1
    s_lshr_b32 s69, s59, 1
    s_add_u32 s68, s68, s69
    s_lshl_b32 s68, s68, 11
    s_add_u32 s36, s68, 3145728
    s_add_u32 s37, s36, 1024
    s_mul_i32 s68, s57, 28
    s_add_u32 s68, s68, s70
    s_lshl_b32 s68, s68, 2
    s_add_u32 s68, s68, s59
    s_lshl_b32 s68, s68, 7
    s_add_u32 s38, s68, 327680
    s_lshr_b32 s69, s59, 1
    s_lshl_b32 s68, s53, 1
    s_add_u32 s68, s68, s69
    s_lshl_b32 s67, s68, 15
    s_lshl_b32 s40, s68, 16
    s_add_u32 s40, s40, 5242880
    s_lshl_b32 s68, s59, 14
    s_add_u32 s80, s40, s68
    s_lshl_b32 s68, s54, 7
    s_add_u32 s67, s67, s68
    s_and_b32 s68, s59, 1
    s_lshl_b32 s68, s68, 6
    s_add_u32 s67, s67, s68
    s_lshr_b32 s68, s2, 4
    s_lshl_b32 s69, s68, 2
    s_add_u32 s69, s69, 3
    s_add_u32 s70, s68, 12
    s_cmp_lt_u32 s68, 4
    s_cselect_b32 s69, s69, s70
    s_lshl_b32 s69, s69, 5
    s_and_b32 s68, s2, 15
    s_lshl_b32 s68, s68, 1
    s_add_u32 s69, s69, s68
    s_add_u32 s69, s69, s59
    s_lshl_b32 s41, s69, 13
    s_mov_b32 s42, 0
    s_cmp_ge_u32 s58, 28
    s_cbranch_scc1 L_no_g1
    s_setprio 0
    s_waitcnt vmcnt(2)
    s_xor_b32 s68, s66, 0
    buffer_load_dwordx4 v[96:99], v244, s[48:51], s68 offen sc1
    buffer_load_dwordx4 v[100:103], v244, s[48:51], s68 offen offset:256 sc1
    s_waitcnt vmcnt(2)
    s_xor_b32 s68, s66, 0
    buffer_load_dwordx4 v[104:107], v245, s[48:51], s68 offen sc1
    buffer_load_dwordx4 v[108:111], v245, s[48:51], s68 offen offset:256 sc1
    s_waitcnt vmcnt(2)
    s_xor_b32 s68, s66, 32768
    buffer_load_dwordx4 v[112:115], v244, s[48:51], s68 offen sc1
    buffer_load_dwordx4 v[116:119], v244, s[48:51], s68 offen offset:256 sc1
    s_waitcnt vmcnt(2)
    s_xor_b32 s68, s66, 32768
    buffer_load_dwordx4 v[120:123], v245, s[48:51], s68 offen sc1
    buffer_load_dwordx4 v[124:127], v245, s[48:51], s68 offen offset:256 sc1
    ds_read_b64_tr_b16 v[160:161], v1 offset:20480
    ds_read_b64_tr_b16 v[162:163], v1 offset:20992
    ds_read_b64_tr_b16 v[164:165], v2 offset:20480
    ds_read_b64_tr_b16 v[166:167], v2 offset:20992
    s_waitcnt lgkmcnt(0)
    v_mfma_f32_16x16x32_bf16 v[32:35], v[160:163], v[96:99], v[32:35]
    v_mfma_f32_16x16x32_bf16 v[40:43], v[160:163], v[100:103], v[40:43]
    ds_read_b64_tr_b16 v[168:169], v3 offset:20480
    ds_read_b64_tr_b16 v[170:171], v3 offset:20992
    ds_read_b64_tr_b16 v[172:173], v4 offset:20480
    ds_read_b64_tr_b16 v[174:175], v4 offset:20992
    v_mfma_f32_16x16x32_bf16 v[64:67], v[160:163], v[104:107], v[64:67]
    v_mfma_f32_16x16x32_bf16 v[72:75], v[160:163], v[108:111], v[72:75]
    s_waitcnt vmcnt(2)
    s_xor_b32 s68, s66, 65536
    buffer_load_dwordx4 v[128:131], v244, s[48:51], s68 offen sc1
    buffer_load_dwordx4 v[132:135], v244, s[48:51], s68 offen offset:256 sc1
    s_add_u32 m0, s0, 24576
    v_mfma_f32_16x16x32_bf16 v[36:39], v[164:167], v[96:99], v[36:39]
    v_mfma_f32_16x16x32_bf16 v[44:47], v[164:167], v[100:103], v[44:47]
    s_waitcnt vmcnt(2)
    buffer_load_dwordx4 v6, s[24:27], s14 offen lds
    buffer_load_dwordx4 v7, s[24:27], s14 offen offset:1024 lds
    s_add_u32 m0, s1, 26624
    v_mfma_f32_16x16x32_bf16 v[68:71], v[164:167], v[104:107], v[68:71]
    v_mfma_f32_16x16x32_bf16 v[76:79], v[164:167], v[108:111], v[76:79]
    s_waitcnt vmcnt(2)
    buffer_load_dwordx4 v6, s[24:27], s15 offen lds
    buffer_load_dwordx4 v7, s[24:27], s15 offen offset:1024 lds
    s_waitcnt vmcnt(0) lgkmcnt(0)
    v_mfma_f32_16x16x32_bf16 v[48:51], v[168:171], v[96:99], v[48:51]
    v_mfma_f32_16x16x32_bf16 v[56:59], v[168:171], v[100:103], v[56:59]
    ds_read_b64_tr_b16 v[160:161], v1 offset:24576
    ds_read_b64_tr_b16 v[162:163], v1 offset:25088
    ds_read_b64_tr_b16 v[164:165], v2 offset:24576
    ds_read_b64_tr_b16 v[166:167], v2 offset:25088
    v_mfma_f32_16x16x32_bf16 v[80:83], v[168:171], v[104:107], v[80:83]
    v_mfma_f32_16x16x32_bf16 v[88:91], v[168:171], v[108:111], v[88:91]
    s_xor_b32 s68, s66, 65536
    buffer_load_dwordx4 v[136:139], v245, s[48:51], s68 offen sc1
    buffer_load_dwordx4 v[140:143], v245, s[48:51], s68 offen offset:256 sc1
    s_add_u32 m0, s0, 0
    v_mfma_f32_16x16x32_bf16 v[52:55], v[172:175], v[96:99], v[52:55]
    v_mfma_f32_16x16x32_bf16 v[60:63], v[172:175], v[100:103], v[60:63]
    buffer_load_dwordx4 v6, s[24:27], s16 offen lds
    buffer_load_dwordx4 v7, s[24:27], s16 offen offset:1024 lds
    s_add_u32 m0, s1, 2048
    v_mfma_f32_16x16x32_bf16 v[84:87], v[172:175], v[104:107], v[84:87]
    v_mfma_f32_16x16x32_bf16 v[92:95], v[172:175], v[108:111], v[92:95]
    s_waitcnt vmcnt(2)
    buffer_load_dwordx4 v6, s[24:27], s17 offen lds
    buffer_load_dwordx4 v7, s[24:27], s17 offen offset:1024 lds
    s_waitcnt lgkmcnt(0)
    v_mfma_f32_16x16x32_bf16 v[32:35], v[160:163], v[112:115], v[32:35]
    v_mfma_f32_16x16x32_bf16 v[40:43], v[160:163], v[116:119], v[40:43]
    ds_read_b64_tr_b16 v[168:169], v3 offset:24576
    ds_read_b64_tr_b16 v[170:171], v3 offset:25088
    ds_read_b64_tr_b16 v[172:173], v4 offset:24576
    ds_read_b64_tr_b16 v[174:175], v4 offset:25088
    v_mfma_f32_16x16x32_bf16 v[64:67], v[160:163], v[120:123], v[64:67]
    v_mfma_f32_16x16x32_bf16 v[72:75], v[160:163], v[124:127], v[72:75]
    s_waitcnt vmcnt(2)
    s_xor_b32 s68, s66, 98304
    buffer_load_dwordx4 v[144:147], v244, s[48:51], s68 offen sc1
    buffer_load_dwordx4 v[148:151], v244, s[48:51], s68 offen offset:256 sc1
    s_add_u32 m0, s0, 4096
    v_mfma_f32_16x16x32_bf16 v[36:39], v[164:167], v[112:115], v[36:39]
    v_mfma_f32_16x16x32_bf16 v[44:47], v[164:167], v[116:119], v[44:47]
    s_waitcnt vmcnt(2)
    buffer_load_dwordx4 v6, s[24:27], s18 offen lds
    buffer_load_dwordx4 v7, s[24:27], s18 offen offset:1024 lds
    v_mfma_f32_16x16x32_bf16 v[68:71], v[164:167], v[120:123], v[68:71]
    v_mfma_f32_16x16x32_bf16 v[76:79], v[164:167], v[124:127], v[76:79]
    s_waitcnt lgkmcnt(0)
    v_mfma_f32_16x16x32_bf16 v[48:51], v[168:171], v[112:115], v[48:51]
    v_mfma_f32_16x16x32_bf16 v[56:59], v[168:171], v[116:119], v[56:59]
    ds_read_b64_tr_b16 v[160:161], v1 offset:0
    ds_read_b64_tr_b16 v[162:163], v1 offset:512
    ds_read_b64_tr_b16 v[164:165], v2 offset:0
    ds_read_b64_tr_b16 v[166:167], v2 offset:512
    ds_read_b32 v30, v12
    v_mfma_f32_16x16x32_bf16 v[80:83], v[168:171], v[120:123], v[80:83]
    v_mfma_f32_16x16x32_bf16 v[88:91], v[168:171], v[124:127], v[88:91]
    s_waitcnt vmcnt(2)
    s_xor_b32 s68, s66, 98304
    buffer_load_dwordx4 v[152:155], v245, s[48:51], s68 offen sc1
    buffer_load_dwordx4 v[156:159], v245, s[48:51], s68 offen offset:256 sc1
    s_add_u32 m0, s1, 6144
    v_mfma_f32_16x16x32_bf16 v[52:55], v[172:175], v[112:115], v[52:55]
    v_mfma_f32_16x16x32_bf16 v[60:63], v[172:175], v[116:119], v[60:63]
    s_waitcnt vmcnt(2)
    buffer_load_dwordx4 v6, s[24:27], s19 offen lds
    buffer_load_dwordx4 v7, s[24:27], s19 offen offset:1024 lds
    v_mfma_f32_16x16x32_bf16 v[84:87], v[172:175], v[120:123], v[84:87]
    v_mfma_f32_16x16x32_bf16 v[92:95], v[172:175], v[124:127], v[92:95]
    s_waitcnt lgkmcnt(0)
    s_setprio 3
    v_cmp_ne_u32 vcc, s29, v30
    s_setprio 0
    v_mfma_f32_16x16x32_bf16 v[32:35], v[160:163], v[128:131], v[32:35]
    v_mfma_f32_16x16x32_bf16 v[40:43], v[160:163], v[132:135], v[40:43]
    ds_read_b64_tr_b16 v[168:169], v3 offset:0
    ds_read_b64_tr_b16 v[170:171], v3 offset:512
    ds_read_b64_tr_b16 v[172:173], v4 offset:0
    ds_read_b64_tr_b16 v[174:175], v4 offset:512
    v_mfma_f32_16x16x32_bf16 v[64:67], v[160:163], v[136:139], v[64:67]
    v_mfma_f32_16x16x32_bf16 v[72:75], v[160:163], v[140:143], v[72:75]
    s_xor_b32 s68, s66, 131072
    buffer_load_dwordx4 v[96:99], v244, s[48:51], s68 offen sc1
    buffer_load_dwordx4 v[100:103], v244, s[48:51], s68 offen offset:256 sc1
    s_add_u32 s24, s24, 458752
    s_addc_u32 s25, s25, 0
    s_sub_u32 s26, s26, 458752
    s_add_u32 m0, s0, 8192
    v_mfma_f32_16x16x32_bf16 v[36:39], v[164:167], v[128:131], v[36:39]
    v_mfma_f32_16x16x32_bf16 v[44:47], v[164:167], v[132:135], v[44:47]
    buffer_load_dwordx4 v6, s[24:27], s12 offen lds
    buffer_load_dwordx4 v7, s[24:27], s12 offen offset:1024 lds
    s_add_u32 m0, s1, 10240
    v_mfma_f32_16x16x32_bf16 v[68:71], v[164:167], v[136:139], v[68:71]
    v_mfma_f32_16x16x32_bf16 v[76:79], v[164:167], v[140:143], v[76:79]
    buffer_load_dwordx4 v6, s[24:27], s13 offen lds
    buffer_load_dwordx4 v7, s[24:27], s13 offen offset:1024 lds
    s_cbranch_vccz L_fx_34
L_fb_35:
    s_waitcnt vmcnt(6) lgkmcnt(0)
    v_mfma_f32_16x16x32_bf16 v[48:51], v[168:171], v[128:131], v[48:51]
    v_mfma_f32_16x16x32_bf16 v[56:59], v[168:171], v[132:135], v[56:59]
    ds_read_b64_tr_b16 v[160:161], v1 offset:4096
    ds_read_b64_tr_b16 v[162:163], v1 offset:4608
    ds_read_b64_tr_b16 v[164:165], v2 offset:4096
    ds_read_b64_tr_b16 v[166:167], v2 offset:4608
    v_mfma_f32_16x16x32_bf16 v[80:83], v[168:171], v[136:139], v[80:83]
    v_mfma_f32_16x16x32_bf16 v[88:91], v[168:171], v[140:143], v[88:91]
    s_xor_b32 s68, s66, 131072
    buffer_load_dwordx4 v[104:107], v245, s[48:51], s68 offen sc1
    buffer_load_dwordx4 v[108:111], v245, s[48:51], s68 offen offset:256 sc1
    s_add_u32 m0, s0, 12288
    v_mfma_f32_16x16x32_bf16 v[52:55], v[172:175], v[128:131], v[52:55]
    v_mfma_f32_16x16x32_bf16 v[60:63], v[172:175], v[132:135], v[60:63]
    buffer_load_dwordx4 v6, s[24:27], s14 offen lds
    buffer_load_dwordx4 v7, s[24:27], s14 offen offset:1024 lds
    s_add_u32 m0, s1, 14336
    v_mfma_f32_16x16x32_bf16 v[84:87], v[172:175], v[136:139], v[84:87]
    v_mfma_f32_16x16x32_bf16 v[92:95], v[172:175], v[140:143], v[92:95]
    buffer_load_dwordx4 v6, s[24:27], s15 offen lds
    buffer_load_dwordx4 v7, s[24:27], s15 offen offset:1024 lds
    s_waitcnt lgkmcnt(0)
    v_mfma_f32_16x16x32_bf16 v[32:35], v[160:163], v[144:147], v[32:35]
    v_mfma_f32_16x16x32_bf16 v[40:43], v[160:163], v[148:151], v[40:43]
    ds_read_b64_tr_b16 v[168:169], v3 offset:4096
    ds_read_b64_tr_b16 v[170:171], v3 offset:4608
    ds_read_b64_tr_b16 v[172:173], v4 offset:4096
    ds_read_b64_tr_b16 v[174:175], v4 offset:4608
    v_mfma_f32_16x16x32_bf16 v[64:67], v[160:163], v[152:155], v[64:67]
    v_mfma_f32_16x16x32_bf16 v[72:75], v[160:163], v[156:159], v[72:75]
    s_xor_b32 s68, s66, 163840
    buffer_load_dwordx4 v[112:115], v244, s[48:51], s68 offen sc1
    buffer_load_dwordx4 v[116:119], v244, s[48:51], s68 offen offset:256 sc1
    s_add_u32 m0, s0, 16384
    v_mfma_f32_16x16x32_bf16 v[36:39], v[164:167], v[144:147], v[36:39]
    v_mfma_f32_16x16x32_bf16 v[44:47], v[164:167], v[148:151], v[44:47]
    buffer_load_dwordx4 v6, s[24:27], s16 offen lds
    buffer_load_dwordx4 v7, s[24:27], s16 offen offset:1024 lds
    v_mfma_f32_16x16x32_bf16 v[68:71], v[164:167], v[152:155], v[68:71]
    v_mfma_f32_16x16x32_bf16 v[76:79], v[164:167], v[156:159], v[76:79]
    s_waitcnt vmcnt(10) lgkmcnt(0)
    v_mfma_f32_16x16x32_bf16 v[48:51], v[168:171], v[144:147], v[48:51]
    v_mfma_f32_16x16x32_bf16 v[56:59], v[168:171], v[148:151], v[56:59]
    ds_read_b64_tr_b16 v[160:161], v1 offset:8192
    ds_read_b64_tr_b16 v[162:163], v1 offset:8704
    ds_read_b64_tr_b16 v[164:165], v2 offset:8192
    ds_read_b64_tr_b16 v[166:167], v2 offset:8704
    ds_read_b32 v30, v12
    v_mfma_f32_16x16x32_bf16 v[80:83], v[168:171], v[152:155], v[80:83]
    v_mfma_f32_16x16x32_bf16 v[88:91], v[168:171], v[156:159], v[88:91]
    s_xor_b32 s68, s66, 163840
    buffer_load_dwordx4 v[120:123], v245, s[48:51], s68 offen sc1
    buffer_load_dwordx4 v[124:127], v245, s[48:51], s68 offen offset:256 sc1
    s_add_u32 m0, s1, 18432
    v_mfma_f32_16x16x32_bf16 v[52:55], v[172:175], v[144:147], v[52:55]
    v_mfma_f32_16x16x32_bf16 v[60:63], v[172:175], v[148:151], v[60:63]
    buffer_load_dwordx4 v6, s[24:27], s17 offen lds
    buffer_load_dwordx4 v7, s[24:27], s17 offen offset:1024 lds
    v_mfma_f32_16x16x32_bf16 v[84:87], v[172:175], v[152:155], v[84:87]
    v_mfma_f32_16x16x32_bf16 v[92:95], v[172:175], v[156:159], v[92:95]
    s_waitcnt vmcnt(12) lgkmcnt(0)
    s_setprio 3
    v_cmp_ne_u32 vcc, s29, v30
    s_setprio 0
    v_mfma_f32_16x16x32_bf16 v[32:35], v[160:163], v[96:99], v[32:35]
    v_mfma_f32_16x16x32_bf16 v[40:43], v[160:163], v[100:103], v[40:43]
    ds_read_b64_tr_b16 v[168:169], v3 offset:8192
    ds_read_b64_tr_b16 v[170:171], v3 offset:8704
    ds_read_b64_tr_b16 v[172:173], v4 offset:8192
    ds_read_b64_tr_b16 v[174:175], v4 offset:8704
    v_mfma_f32_16x16x32_bf16 v[64:67], v[160:163], v[104:107], v[64:67]
    v_mfma_f32_16x16x32_bf16 v[72:75], v[160:163], v[108:111], v[72:75]
    s_xor_b32 s68, s66, 196608
    buffer_load_dwordx4 v[128:131], v244, s[48:51], s68 offen sc1
    buffer_load_dwordx4 v[132:135], v244, s[48:51], s68 offen offset:256 sc1
    s_add_u32 m0, s0, 20480
    v_mfma_f32_16x16x32_bf16 v[36:39], v[164:167], v[96:99], v[36:39]
    v_mfma_f32_16x16x32_bf16 v[44:47], v[164:167], v[100:103], v[44:47]
    buffer_load_dwordx4 v6, s[24:27], s18 offen lds
    buffer_load_dwordx4 v7, s[24:27], s18 offen offset:1024 lds
    v_mfma_f32_16x16x32_bf16 v[68:71], v[164:167], v[104:107], v[68:71]
    v_mfma_f32_16x16x32_bf16 v[76:79], v[164:167], v[108:111], v[76:79]
    s_cbranch_vccz L_fx_36
L_fb_37:
    s_waitcnt vmcnt(12) lgkmcnt(0)
    v_mfma_f32_16x16x32_bf16 v[48:51], v[168:171], v[96:99], v[48:51]
    v_mfma_f32_16x16x32_bf16 v[56:59], v[168:171], v[100:103], v[56:59]
    ds_read_b64_tr_b16 v[160:161], v1 offset:12288
    ds_read_b64_tr_b16 v[162:163], v1 offset:12800
    ds_read_b64_tr_b16 v[164:165], v2 offset:12288
    ds_read_b64_tr_b16 v[166:167], v2 offset:12800
    v_mfma_f32_16x16x32_bf16 v[80:83], v[168:171], v[104:107], v[80:83]
    v_mfma_f32_16x16x32_bf16 v[88:91], v[168:171], v[108:111], v[88:91]
    s_xor_b32 s68, s66, 196608
    buffer_load_dwordx4 v[136:139], v245, s[48:51], s68 offen sc1
    buffer_load_dwordx4 v[140:143], v245, s[48:51], s68 offen offset:256 sc1
    s_add_u32 m0, s1, 22528
    v_mfma_f32_16x16x32_bf16 v[52:55], v[172:175], v[96:99], v[52:55]
    v_mfma_f32_16x16x32_bf16 v[60:63], v[172:175], v[100:103], v[60:63]
    buffer_load_dwordx4 v6, s[24:27], s19 offen lds
    buffer_load_dwordx4 v7, s[24:27], s19 offen offset:1024 lds
    v_mfma_f32_16x16x32_bf16 v[84:87], v[172:175], v[104:107], v[84:87]
    v_mfma_f32_16x16x32_bf16 v[92:95], v[172:175], v[108:111], v[92:95]
    s_waitcnt vmcnt(10) lgkmcnt(0)
    v_mfma_f32_16x16x32_bf16 v[32:35], v[160:163], v[112:115], v[32:35]
    v_mfma_f32_16x16x32_bf16 v[40:43], v[160:163], v[116:119], v[40:43]
    ds_read_b64_tr_b16 v[168:169], v3 offset:12288
    ds_read_b64_tr_b16 v[170:171], v3 offset:12800
    ds_read_b64_tr_b16 v[172:173], v4 offset:12288
    ds_read_b64_tr_b16 v[174:175], v4 offset:12800
    v_mfma_f32_16x16x32_bf16 v[64:67], v[160:163], v[120:123], v[64:67]
    v_mfma_f32_16x16x32_bf16 v[72:75], v[160:163], v[124:127], v[72:75]
    s_xor_b32 s68, s66, 229376
    buffer_load_dwordx4 v[144:147], v244, s[48:51], s68 offen sc1
    buffer_load_dwordx4 v[148:151], v244, s[48:51], s68 offen offset:256 sc1
    s_add_u32 s24, s24, 458752
    s_addc_u32 s25, s25, 0
    s_sub_u32 s26, s26, 458752
    s_add_u32 m0, s0, 24576
    v_mfma_f32_16x16x32_bf16 v[36:39], v[164:167], v[112:115], v[36:39]
    v_mfma_f32_16x16x32_bf16 v[44:47], v[164:167], v[116:119], v[44:47]
    buffer_load_dwordx4 v6, s[24:27], s12 offen lds
    buffer_load_dwordx4 v7, s[24:27], s12 offen offset:1024 lds
    v_mfma_f32_16x16x32_bf16 v[68:71], v[164:167], v[120:123], v[68:71]
    v_mfma_f32_16x16x32_bf16 v[76:79], v[164:167], v[124:127], v[76:79]
    s_waitcnt vmcnt(12) lgkmcnt(0)
    v_mfma_f32_16x16x32_bf16 v[48:51], v[168:171], v[112:115], v[48:51]
    v_mfma_f32_16x16x32_bf16 v[56:59], v[168:171], v[116:119], v[56:59]
    ds_read_b64_tr_b16 v[160:161], v1 offset:16384
    ds_read_b64_tr_b16 v[162:163], v1 offset:16896
    ds_read_b64_tr_b16 v[164:165], v2 offset:16384
    ds_read_b64_tr_b16 v[166:167], v2 offset:16896
    ds_read_b32 v30, v12
    v_mfma_f32_16x16x32_bf16 v[80:83], v[168:171], v[120:123], v[80:83]
    v_mfma_f32_16x16x32_bf16 v[88:91], v[168:171], v[124:127], v[88:91]
    s_xor_b32 s68, s66, 229376
    buffer_load_dwordx4 v[152:155], v245, s[48:51], s68 offen sc1
    buffer_load_dwordx4 v[156:159], v245, s[48:51], s68 offen offset:256 sc1
    s_add_u32 m0, s1, 26624
    v_mfma_f32_16x16x32_bf16 v[52:55], v[172:175], v[112:115], v[52:55]
    v_mfma_f32_16x16x32_bf16 v[60:63], v[172:175], v[116:119], v[60:63]
    buffer_load_dwordx4 v6, s[24:27], s13 offen lds
    buffer_load_dwordx4 v7, s[24:27], s13 offen offset:1024 lds
    v_mfma_f32_16x16x32_bf16 v[84:87], v[172:175], v[120:123], v[84:87]
    v_mfma_f32_16x16x32_bf16 v[92:95], v[172:175], v[124:127], v[92:95]
    s_waitcnt vmcnt(10) lgkmcnt(0)
    s_setprio 3
    v_cmp_ne_u32 vcc, s29, v30
    s_setprio 0
    v_mfma_f32_16x16x32_bf16 v[32:35], v[160:163], v[128:131], v[32:35]
    v_mfma_f32_16x16x32_bf16 v[40:43], v[160:163], v[132:135], v[40:43]
    ds_read_b64_tr_b16 v[168:169], v3 offset:16384
    ds_read_b64_tr_b16 v[170:171], v3 offset:16896
    ds_read_b64_tr_b16 v[172:173], v4 offset:16384
    ds_read_b64_tr_b16 v[174:175], v4 offset:16896
    v_mfma_f32_16x16x32_bf16 v[64:67], v[160:163], v[136:139], v[64:67]
    v_mfma_f32_16x16x32_bf16 v[72:75], v[160:163], v[140:143], v[72:75]
    s_xor_b32 s68, s66, 262144
    buffer_load_dwordx4 v[96:99], v244, s[48:51], s68 offen sc1
    buffer_load_dwordx4 v[100:103], v244, s[48:51], s68 offen offset:256 sc1
    s_add_u32 m0, s0, 0
    v_mfma_f32_16x16x32_bf16 v[36:39], v[164:167], v[128:131], v[36:39]
    v_mfma_f32_16x16x32_bf16 v[44:47], v[164:167], v[132:135], v[44:47]
    buffer_load_dwordx4 v6, s[24:27], s14 offen lds
    buffer_load_dwordx4 v7, s[24:27], s14 offen offset:1024 lds
    v_mfma_f32_16x16x32_bf16 v[68:71], v[164:167], v[136:139], v[68:71]
    v_mfma_f32_16x16x32_bf16 v[76:79], v[164:167], v[140:143], v[76:79]
    s_cbranch_vccz L_fx_38
L_fb_39:
    s_waitcnt vmcnt(12) lgkmcnt(0)
    v_mfma_f32_16x16x32_bf16 v[48:51], v[168:171], v[128:131], v[48:51]
    v_mfma_f32_16x16x32_bf16 v[56:59], v[168:171], v[132:135], v[56:59]
    ds_read_b64_tr_b16 v[160:161], v1 offset:20480
    ds_read_b64_tr_b16 v[162:163], v1 offset:20992
    ds_read_b64_tr_b16 v[164:165], v2 offset:20480
    ds_read_b64_tr_b16 v[166:167], v2 offset:20992
    v_mfma_f32_16x16x32_bf16 v[80:83], v[168:171], v[136:139], v[80:83]
    v_mfma_f32_16x16x32_bf16 v[88:91], v[168:171], v[140:143], v[88:91]
    s_xor_b32 s68, s66, 262144
    buffer_load_dwordx4 v[104:107], v245, s[48:51], s68 offen sc1
    buffer_load_dwordx4 v[108:111], v245, s[48:51], s68 offen offset:256 sc1
    s_add_u32 m0, s1, 2048
    v_mfma_f32_16x16x32_bf16 v[52:55], v[172:175], v[128:131], v[52:55]
    v_mfma_f32_16x16x32_bf16 v[60:63], v[172:175], v[132:135], v[60:63]
    buffer_load_dwordx4 v6, s[24:27], s15 offen lds
    buffer_load_dwordx4 v7, s[24:27], s15 offen offset:1024 lds
    v_mfma_f32_16x16x32_bf16 v[84:87], v[172:175], v[136:139], v[84:87]
    v_mfma_f32_16x16x32_bf16 v[92:95], v[172:175], v[140:143], v[92:95]
    s_waitcnt vmcnt(10) lgkmcnt(0)
    v_mfma_f32_16x16x32_bf16 v[32:35], v[160:163], v[144:147], v[32:35]
    v_mfma_f32_16x16x32_bf16 v[40:43], v[160:163], v[148:151], v[40:43]
    ds_read_b64_tr_b16 v[168:169], v3 offset:20480
    ds_read_b64_tr_b16 v[170:171], v3 offset:20992
    ds_read_b64_tr_b16 v[172:173], v4 offset:20480
    ds_read_b64_tr_b16 v[174:175], v4 offset:20992
    v_mfma_f32_16x16x32_bf16 v[64:67], v[160:163], v[152:155], v[64:67]
    v_mfma_f32_16x16x32_bf16 v[72:75], v[160:163], v[156:159], v[72:75]
    s_xor_b32 s68, s66, 294912
    buffer_load_dwordx4 v[112:115], v244, s[48:51], s68 offen sc1
    buffer_load_dwordx4 v[116:119], v244, s[48:51], s68 offen offset:256 sc1
    s_add_u32 m0, s0, 4096
    v_mfma_f32_16x16x32_bf16 v[36:39], v[164:167], v[144:147], v[36:39]
    v_mfma_f32_16x16x32_bf16 v[44:47], v[164:167], v[148:151], v[44:47]
    buffer_load_dwordx4 v6, s[24:27], s16 offen lds
    buffer_load_dwordx4 v7, s[24:27], s16 offen offset:1024 lds
    v_mfma_f32_16x16x32_bf16 v[68:71], v[164:167], v[152:155], v[68:71]
    v_mfma_f32_16x16x32_bf16 v[76:79], v[164:167], v[156:159], v[76:79]
    s_waitcnt vmcnt(12) lgkmcnt(0)
    v_mfma_f32_16x16x32_bf16 v[48:51], v[168:171], v[144:147], v[48:51]
    v_mfma_f32_16x16x32_bf16 v[56:59], v[168:171], v[148:151], v[56:59]
    ds_read_b64_tr_b16 v[160:161], v1 offset:24576
    ds_read_b64_tr_b16 v[162:163], v1 offset:25088
    ds_read_b64_tr_b16 v[164:165], v2 offset:24576
    ds_read_b64_tr_b16 v[166:167], v2 offset:25088
    ds_read_b32 v30, v12
    v_mfma_f32_16x16x32_bf16 v[80:83], v[168:171], v[152:155], v[80:83]
    v_mfma_f32_16x16x32_bf16 v[88:91], v[168:171], v[156:159], v[88:91]
    s_xor_b32 s68, s66, 294912
    buffer_load_dwordx4 v[120:123], v245, s[48:51], s68 offen sc1
    buffer_load_dwordx4 v[124:127], v245, s[48:51], s68 offen offset:256 sc1
    s_add_u32 m0, s1, 6144
    v_mfma_f32_16x16x32_bf16 v[52:55], v[172:175], v[144:147], v[52:55]
    v_mfma_f32_16x16x32_bf16 v[60:63], v[172:175], v[148:151], v[60:63]
    buffer_load_dwordx4 v6, s[24:27], s17 offen lds
    buffer_load_dwordx4 v7, s[24:27], s17 offen offset:1024 lds
    v_mfma_f32_16x16x32_bf16 v[84:87], v[172:175], v[152:155], v[84:87]
    v_mfma_f32_16x16x32_bf16 v[92:95], v[172:175], v[156:159], v[92:95]
    s_waitcnt vmcnt(10) lgkmcnt(0)
    s_setprio 3
    v_cmp_ne_u32 vcc, s29, v30
    s_setprio 0
    v_mfma_f32_16x16x32_bf16 v[32:35], v[160:163], v[96:99], v[32:35]
    v_mfma_f32_16x16x32_bf16 v[40:43], v[160:163], v[100:103], v[40:43]
    ds_read_b64_tr_b16 v[168:169], v3 offset:24576
    ds_read_b64_tr_b16 v[170:171], v3 offset:25088
    ds_read_b64_tr_b16 v[172:173], v4 offset:24576
    ds_read_b64_tr_b16 v[174:175], v4 offset:25088
    v_mfma_f32_16x16x32_bf16 v[64:67], v[160:163], v[104:107], v[64:67]
    v_mfma_f32_16x16x32_bf16 v[72:75], v[160:163], v[108:111], v[72:75]
    s_xor_b32 s68, s66, 327680
    buffer_load_dwordx4 v[128:131], v244, s[48:51], s68 offen sc1
    buffer_load_dwordx4 v[132:135], v244, s[48:51], s68 offen offset:256 sc1
    s_add_u32 m0, s0, 8192
    v_mfma_f32_16x16x32_bf16 v[36:39], v[164:167], v[96:99], v[36:39]
    v_mfma_f32_16x16x32_bf16 v[44:47], v[164:167], v[100:103], v[44:47]
    buffer_load_dwordx4 v6, s[24:27], s18 offen lds
    buffer_load_dwordx4 v7, s[24:27], s18 offen offset:1024 lds
    v_mfma_f32_16x16x32_bf16 v[68:71], v[164:167], v[104:107], v[68:71]
    v_mfma_f32_16x16x32_bf16 v[76:79], v[164:167], v[108:111], v[76:79]
    s_cbranch_vccz L_fx_40
L_fb_41:
    s_waitcnt vmcnt(12) lgkmcnt(0)
    v_mfma_f32_16x16x32_bf16 v[48:51], v[168:171], v[96:99], v[48:51]
    v_mfma_f32_16x16x32_bf16 v[56:59], v[168:171], v[100:103], v[56:59]
    ds_read_b64_tr_b16 v[160:161], v1 offset:0
    ds_read_b64_tr_b16 v[162:163], v1 offset:512
    ds_read_b64_tr_b16 v[164:165], v2 offset:0
    ds_read_b64_tr_b16 v[166:167], v2 offset:512
    v_mfma_f32_16x16x32_bf16 v[80:83], v[168:171], v[104:107], v[80:83]
    v_mfma_f32_16x16x32_bf16 v[88:91], v[168:171], v[108:111], v[88:91]
    s_xor_b32 s68, s66, 327680
    buffer_load_dwordx4 v[136:139], v245, s[48:51], s68 offen sc1
    buffer_load_dwordx4 v[140:143], v245, s[48:51], s68 offen offset:256 sc1
    s_add_u32 m0, s1, 10240
    v_mfma_f32_16x16x32_bf16 v[52:55], v[172:175], v[96:99], v[52:55]
    v_mfma_f32_16x16x32_bf16 v[60:63], v[172:175], v[100:103], v[60:63]
    buffer_load_dwordx4 v6, s[24:27], s19 offen lds
    buffer_load_dwordx4 v7, s[24:27], s19 offen offset:1024 lds
    v_mfma_f32_16x16x32_bf16 v[84:87], v[172:175], v[104:107], v[84:87]
    v_mfma_f32_16x16x32_bf16 v[92:95], v[172:175], v[108:111], v[92:95]
    s_waitcnt vmcnt(10) lgkmcnt(0)
    v_mfma_f32_16x16x32_bf16 v[32:35], v[160:163], v[112:115], v[32:35]
    v_mfma_f32_16x16x32_bf16 v[40:43], v[160:163], v[116:119], v[40:43]
    ds_read_b64_tr_b16 v[168:169], v3 offset:0
    ds_read_b64_tr_b16 v[170:171], v3 offset:512
    ds_read_b64_tr_b16 v[172:173], v4 offset:0
    ds_read_b64_tr_b16 v[174:175], v4 offset:512
    v_mfma_f32_16x16x32_bf16 v[64:67], v[160:163], v[120:123], v[64:67]
    v_mfma_f32_16x16x32_bf16 v[72:75], v[160:163], v[124:127], v[72:75]
    s_xor_b32 s68, s66, 360448
    buffer_load_dwordx4 v[144:147], v244, s[48:51], s68 offen sc1
    buffer_load_dwordx4 v[148:151], v244, s[48:51], s68 offen offset:256 sc1
    s_add_u32 s24, s24, 458752
    s_addc_u32 s25, s25, 0
    s_sub_u32 s26, s26, 458752
    s_add_u32 m0, s0, 12288
    v_mfma_f32_16x16x32_bf16 v[36:39], v[164:167], v[112:115], v[36:39]
    v_mfma_f32_16x16x32_bf16 v[44:47], v[164:167], v[116:119], v[44:47]
    buffer_load_dwordx4 v6, s[24:27], s12 offen lds
    buffer_load_dwordx4 v7, s[24:27], s12 offen offset:1024 lds
    v_mfma_f32_16x16x32_bf16 v[68:71], v[164:167], v[120:123], v[68:71]
    v_mfma_f32_16x16x32_bf16 v[76:79], v[164:167], v[124:127], v[76:79]
    s_waitcnt vmcnt(12) lgkmcnt(0)
    v_mfma_f32_16x16x32_bf16 v[48:51], v[168:171], v[112:115], v[48:51]
    v_mfma_f32_16x16x32_bf16 v[56:59], v[168:171], v[116:119], v[56:59]
    ds_read_b64_tr_b16 v[160:161], v1 offset:4096
    ds_read_b64_tr_b16 v[162:163], v1 offset:4608
    ds_read_b64_tr_b16 v[164:165], v2 offset:4096
    ds_read_b64_tr_b16 v[166:167], v2 offset:4608
    ds_read_b32 v30, v12
    v_mfma_f32_16x16x32_bf16 v[80:83], v[168:171], v[120:123], v[80:83]
    v_mfma_f32_16x16x32_bf16 v[88:91], v[168:171], v[124:127], v[88:91]
    s_xor_b32 s68, s66, 360448
    buffer_load_dwordx4 v[152:155], v245, s[48:51], s68 offen sc1
    buffer_load_dwordx4 v[156:159], v245, s[48:51], s68 offen offset:256 sc1
    s_add_u32 m0, s1, 14336
    v_mfma_f32_16x16x32_bf16 v[52:55], v[172:175], v[112:115], v[52:55]
    v_mfma_f32_16x16x32_bf16 v[60:63], v[172:175], v[116:119], v[60:63]
    buffer_load_dwordx4 v6, s[24:27], s13 offen lds
    buffer_load_dwordx4 v7, s[24:27], s13 offen offset:1024 lds
    v_mfma_f32_16x16x32_bf16 v[84:87], v[172:175], v[120:123], v[84:87]
    v_mfma_f32_16x16x32_bf16 v[92:95], v[172:175], v[124:127], v[92:95]
    s_waitcnt vmcnt(10) lgkmcnt(0)
    s_setprio 3
    v_cmp_ne_u32 vcc, s29, v30
    s_setprio 0
    v_mfma_f32_16x16x32_bf16 v[32:35], v[160:163], v[128:131], v[32:35]
    v_mfma_f32_16x16x32_bf16 v[40:43], v[160:163], v[132:135], v[40:43]
    ds_read_b64_tr_b16 v[168:169], v3 offset:4096
    ds_read_b64_tr_b16 v[170:171], v3 offset:4608
    ds_read_b64_tr_b16 v[172:173], v4 offset:4096
    ds_read_b64_tr_b16 v[174:175], v4 offset:4608
    v_mfma_f32_16x16x32_bf16 v[64:67], v[160:163], v[136:139], v[64:67]
    v_mfma_f32_16x16x32_bf16 v[72:75], v[160:163], v[140:143], v[72:75]
    s_xor_b32 s68, s101, 393216
    buffer_load_dwordx4 v[96:99], v244, s[48:51], s68 offen sc1
    buffer_load_dwordx4 v[100:103], v244, s[48:51], s68 offen offset:256 sc1
    s_add_u32 m0, s0, 16384
    v_mfma_f32_16x16x32_bf16 v[36:39], v[164:167], v[128:131], v[36:39]
    v_mfma_f32_16x16x32_bf16 v[44:47], v[164:167], v[132:135], v[44:47]
    buffer_load_dwordx4 v6, s[24:27], s14 offen lds
    buffer_load_dwordx4 v7, s[24:27], s14 offen offset:1024 lds
    v_mfma_f32_16x16x32_bf16 v[68:71], v[164:167], v[136:139], v[68:71]
    v_mfma_f32_16x16x32_bf16 v[76:79], v[164:167], v[140:143], v[76:79]
    s_cbranch_vccz L_fx_42
L_fb_43:
    s_waitcnt vmcnt(12) lgkmcnt(0)
    v_mfma_f32_16x16x32_bf16 v[48:51], v[168:171], v[128:131], v[48:51]
    v_mfma_f32_16x16x32_bf16 v[56:59], v[168:171], v[132:135], v[56:59]
    ds_read_b64_tr_b16 v[160:161], v1 offset:8192
    ds_read_b64_tr_b16 v[162:163], v1 offset:8704
    ds_read_b64_tr_b16 v[164:165], v2 offset:8192
    ds_read_b64_tr_b16 v[166:167], v2 offset:8704
    v_mfma_f32_16x16x32_bf16 v[80:83], v[168:171], v[136:139], v[80:83]
    v_mfma_f32_16x16x32_bf16 v[88:91], v[168:171], v[140:143], v[88:91]
    s_xor_b32 s68, s101, 393216
    buffer_load_dwordx4 v[104:107], v245, s[48:51], s68 offen sc1
    buffer_load_dwordx4 v[108:111], v245, s[48:51], s68 offen offset:256 sc1
    s_add_u32 m0, s1, 18432
    v_mfma_f32_16x16x32_bf16 v[52:55], v[172:175], v[128:131], v[52:55]
    v_mfma_f32_16x16x32_bf16 v[60:63], v[172:175], v[132:135], v[60:63]
    buffer_load_dwordx4 v6, s[24:27], s15 offen lds
    buffer_load_dwordx4 v7, s[24:27], s15 offen offset:1024 lds
    v_mfma_f32_16x16x32_bf16 v[84:87], v[172:175], v[136:139], v[84:87]
    v_mfma_f32_16x16x32_bf16 v[92:95], v[172:175], v[140:143], v[92:95]
    s_waitcnt vmcnt(10) lgkmcnt(0)
    v_mfma_f32_16x16x32_bf16 v[32:35], v[160:163], v[144:147], v[32:35]
    v_mfma_f32_16x16x32_bf16 v[40:43], v[160:163], v[148:151], v[40:43]
    ds_read_b64_tr_b16 v[168:169], v3 offset:8192
    ds_read_b64_tr_b16 v[170:171], v3 offset:8704
    ds_read_b64_tr_b16 v[172:173], v4 offset:8192
    ds_read_b64_tr_b16 v[174:175], v4 offset:8704
    v_mfma_f32_16x16x32_bf16 v[64:67], v[160:163], v[152:155], v[64:67]
    v_mfma_f32_16x16x32_bf16 v[72:75], v[160:163], v[156:159], v[72:75]
    s_xor_b32 s68, s101, 425984
    buffer_load_dwordx4 v[112:115], v244, s[48:51], s68 offen sc1
    buffer_load_dwordx4 v[116:119], v244, s[48:51], s68 offen offset:256 sc1
    s_add_u32 m0, s0, 20480
    v_mfma_f32_16x16x32_bf16 v[36:39], v[164:167], v[144:147], v[36:39]
    v_mfma_f32_16x16x32_bf16 v[44:47], v[164:167], v[148:151], v[44:47]
    buffer_load_dwordx4 v6, s[24:27], s16 offen lds
    buffer_load_dwordx4 v7, s[24:27], s16 offen offset:1024 lds
    v_mfma_f32_16x16x32_bf16 v[68:71], v[164:167], v[152:155], v[68:71]
    v_mfma_f32_16x16x32_bf16 v[76:79], v[164:167], v[156:159], v[76:79]
    s_waitcnt vmcnt(12) lgkmcnt(0)
    v_mfma_f32_16x16x32_bf16 v[48:51], v[168:171], v[144:147], v[48:51]
    v_mfma_f32_16x16x32_bf16 v[56:59], v[168:171], v[148:151], v[56:59]
    ds_read_b64_tr_b16 v[160:161], v1 offset:12288
    ds_read_b64_tr_b16 v[162:163], v1 offset:12800
    ds_read_b64_tr_b16 v[164:165], v2 offset:12288
    ds_read_b64_tr_b16 v[166:167], v2 offset:12800
    ds_read_b32 v30, v12
    v_mfma_f32_16x16x32_bf16 v[80:83], v[168:171], v[152:155], v[80:83]
    v_mfma_f32_16x16x32_bf16 v[88:91], v[168:171], v[156:159], v[88:91]
    s_xor_b32 s68, s101, 425984
    buffer_load_dwordx4 v[120:123], v245, s[48:51], s68 offen sc1
    buffer_load_dwordx4 v[124:127], v245, s[48:51], s68 offen offset:256 sc1
    s_add_u32 m0, s1, 22528
    v_mfma_f32_16x16x32_bf16 v[52:55], v[172:175], v[144:147], v[52:55]
    v_mfma_f32_16x16x32_bf16 v[60:63], v[172:175], v[148:151], v[60:63]
    buffer_load_dwordx4 v6, s[24:27], s17 offen lds
    buffer_load_dwordx4 v7, s[24:27], s17 offen offset:1024 lds
    v_mfma_f32_16x16x32_bf16 v[84:87], v[172:175], v[152:155], v[84:87]
    v_mfma_f32_16x16x32_bf16 v[92:95], v[172:175], v[156:159], v[92:95]
    s_waitcnt vmcnt(10) lgkmcnt(0)
    s_setprio 3
    v_cmp_ne_u32 vcc, s29, v30
    s_setprio 0
    v_mfma_f32_16x16x32_bf16 v[32:35], v[160:163], v[96:99], v[32:35]
    v_mfma_f32_16x16x32_bf16 v[40:43], v[160:163], v[100:103], v[40:43]
    ds_read_b64_tr_b16 v[168:169], v3 offset:12288
    ds_read_b64_tr_b16 v[170:171], v3 offset:12800
    ds_read_b64_tr_b16 v[172:173], v4 offset:12288
    ds_read_b64_tr_b16 v[174:175], v4 offset:12800
    v_mfma_f32_16x16x32_bf16 v[64:67], v[160:163], v[104:107], v[64:67]
    v_mfma_f32_16x16x32_bf16 v[72:75], v[160:163], v[108:111], v[72:75]
    s_xor_b32 s68, s101, 458752
    buffer_load_dwordx4 v[128:131], v244, s[48:51], s68 offen sc1
    buffer_load_dwordx4 v[132:135], v244, s[48:51], s68 offen offset:256 sc1
    s_add_u32 m0, s0, 24576
    v_mfma_f32_16x16x32_bf16 v[36:39], v[164:167], v[96:99], v[36:39]
    v_mfma_f32_16x16x32_bf16 v[44:47], v[164:167], v[100:103], v[44:47]
    buffer_load_dwordx4 v6, s[24:27], s18 offen lds
    buffer_load_dwordx4 v7, s[24:27], s18 offen offset:1024 lds
    v_mfma_f32_16x16x32_bf16 v[68:71], v[164:167], v[104:107], v[68:71]
    v_mfma_f32_16x16x32_bf16 v[76:79], v[164:167], v[108:111], v[76:79]
    s_cbranch_vccz L_fx_44
L_fb_45:
    s_waitcnt vmcnt(12) lgkmcnt(0)
    v_mfma_f32_16x16x32_bf16 v[48:51], v[168:171], v[96:99], v[48:51]
    v_mfma_f32_16x16x32_bf16 v[56:59], v[168:171], v[100:103], v[56:59]
    ds_read_b64_tr_b16 v[160:161], v1 offset:16384
    ds_read_b64_tr_b16 v[162:163], v1 offset:16896
    ds_read_b64_tr_b16 v[164:165], v2 offset:16384
    ds_read_b64_tr_b16 v[166:167], v2 offset:16896
    v_mfma_f32_16x16x32_bf16 v[80:83], v[168:171], v[104:107], v[80:83]
    v_mfma_f32_16x16x32_bf16 v[88:91], v[168:171], v[108:111], v[88:91]
    s_xor_b32 s68, s101, 458752
    buffer_load_dwordx4 v[136:139], v245, s[48:51], s68 offen sc1
    buffer_load_dwordx4 v[140:143], v245, s[48:51], s68 offen offset:256 sc1
    s_add_u32 m0, s1, 26624
    v_mfma_f32_16x16x32_bf16 v[52:55], v[172:175], v[96:99], v[52:55]
    v_mfma_f32_16x16x32_bf16 v[60:63], v[172:175], v[100:103], v[60:63]
    buffer_load_dwordx4 v6, s[24:27], s19 offen lds
    buffer_load_dwordx4 v7, s[24:27], s19 offen offset:1024 lds
    v_mfma_f32_16x16x32_bf16 v[84:87], v[172:175], v[104:107], v[84:87]
    v_mfma_f32_16x16x32_bf16 v[92:95], v[172:175], v[108:111], v[92:95]
    s_waitcnt vmcnt(10) lgkmcnt(0)
    v_mfma_f32_16x16x32_bf16 v[32:35], v[160:163], v[112:115], v[32:35]
    v_mfma_f32_16x16x32_bf16 v[40:43], v[160:163], v[116:119], v[40:43]
    ds_read_b64_tr_b16 v[168:169], v3 offset:16384
    ds_read_b64_tr_b16 v[170:171], v3 offset:16896
    ds_read_b64_tr_b16 v[172:173], v4 offset:16384
    ds_read_b64_tr_b16 v[174:175], v4 offset:16896
    v_mfma_f32_16x16x32_bf16 v[64:67], v[160:163], v[120:123], v[64:67]
    v_mfma_f32_16x16x32_bf16 v[72:75], v[160:163], v[124:127], v[72:75]
    s_xor_b32 s68, s101, 491520
    buffer_load_dwordx4 v[144:147], v244, s[48:51], s68 offen sc1
    buffer_load_dwordx4 v[148:151], v244, s[48:51], s68 offen offset:256 sc1
    s_add_u32 s69, s73, 0
    s_add_u32 m0, s61, 12288
    v_mfma_f32_16x16x32_bf16 v[36:39], v[164:167], v[112:115], v[36:39]
    v_mfma_f32_16x16x32_bf16 v[44:47], v[164:167], v[116:119], v[44:47]
    buffer_load_dwordx4 v26, s[20:23], s69 offen lds
    buffer_load_dwordx4 v27, s[20:23], s69 offen offset:1024 lds
    v_mfma_f32_16x16x32_bf16 v[68:71], v[164:167], v[120:123], v[68:71]
    v_mfma_f32_16x16x32_bf16 v[76:79], v[164:167], v[124:127], v[76:79]
    s_waitcnt vmcnt(12) lgkmcnt(0)
    v_mfma_f32_16x16x32_bf16 v[48:51], v[168:171], v[112:115], v[48:51]
    v_mfma_f32_16x16x32_bf16 v[56:59], v[168:171], v[116:119], v[56:59]
    ds_read_b64_tr_b16 v[160:161], v1 offset:20480
    ds_read_b64_tr_b16 v[162:163], v1 offset:20992
    ds_read_b64_tr_b16 v[164:165], v2 offset:20480
    ds_read_b64_tr_b16 v[166:167], v2 offset:20992
    ds_read_b32 v30, v12
    v_mfma_f32_16x16x32_bf16 v[80:83], v[168:171], v[120:123], v[80:83]
    v_mfma_f32_16x16x32_bf16 v[88:91], v[168:171], v[124:127], v[88:91]
    s_xor_b32 s68, s101, 491520
    buffer_load_dwordx4 v[152:155], v245, s[48:51], s68 offen sc1
    buffer_load_dwordx4 v[156:159], v245, s[48:51], s68 offen offset:256 sc1
    s_add_u32 s69, s73, 65536
    s_add_u32 m0, s61, 14336
    v_mfma_f32_16x16x32_bf16 v[52:55], v[172:175], v[112:115], v[52:55]
    v_mfma_f32_16x16x32_bf16 v[60:63], v[172:175], v[116:119], v[60:63]
    buffer_load_dwordx4 v26, s[20:23], s69 offen lds
    buffer_load_dwordx4 v27, s[20:23], s69 offen offset:1024 lds
    v_mfma_f32_16x16x32_bf16 v[84:87], v[172:175], v[120:123], v[84:87]
    v_mfma_f32_16x16x32_bf16 v[92:95], v[172:175], v[124:127], v[92:95]
    s_waitcnt vmcnt(10) lgkmcnt(0)
    s_setprio 3
    v_cmp_ne_u32 vcc, s29, v30
    s_setprio 0
    v_mfma_f32_16x16x32_bf16 v[32:35], v[160:163], v[128:131], v[32:35]
    v_mfma_f32_16x16x32_bf16 v[40:43], v[160:163], v[132:135], v[40:43]
    ds_read_b64_tr_b16 v[168:169], v3 offset:20480
    ds_read_b64_tr_b16 v[170:171], v3 offset:20992
    ds_read_b64_tr_b16 v[172:173], v4 offset:20480
    ds_read_b64_tr_b16 v[174:175], v4 offset:20992
    v_mfma_f32_16x16x32_bf16 v[64:67], v[160:163], v[136:139], v[64:67]
    v_mfma_f32_16x16x32_bf16 v[72:75], v[160:163], v[140:143], v[72:75]
    s_xor_b32 s68, s80, 0
    buffer_load_dwordx4 v[96:99], v28, s[48:51], s68 offen offset:0 sc1
    buffer_load_dwordx4 v[100:103], v28, s[48:51], s68 offen offset:1024 sc1
    s_xor_b32 s68, s80, 0
    buffer_load_dwordx4 v[104:107], v28, s[48:51], s68 offen offset:256 sc1
    buffer_load_dwordx4 v[108:111], v28, s[48:51], s68 offen offset:1280 sc1
    v_mfma_f32_16x16x32_bf16 v[36:39], v[164:167], v[128:131], v[36:39]
    v_mfma_f32_16x16x32_bf16 v[44:47], v[164:167], v[132:135], v[44:47]
    v_mfma_f32_16x16x32_bf16 v[68:71], v[164:167], v[136:139], v[68:71]
    v_mfma_f32_16x16x32_bf16 v[76:79], v[164:167], v[140:143], v[76:79]
    s_cbranch_vccz L_fx_46
L_fb_47:
    s_waitcnt vmcnt(12) lgkmcnt(0)
    v_mfma_f32_16x16x32_bf16 v[48:51], v[168:171], v[128:131], v[48:51]
    v_mfma_f32_16x16x32_bf16 v[56:59], v[168:171], v[132:135], v[56:59]
    ds_read_b64_tr_b16 v[160:161], v1 offset:24576
    ds_read_b64_tr_b16 v[162:163], v1 offset:25088
    ds_read_b64_tr_b16 v[164:165], v2 offset:24576
    ds_read_b64_tr_b16 v[166:167], v2 offset:25088
    v_mfma_f32_16x16x32_bf16 v[80:83], v[168:171], v[136:139], v[80:83]
    v_mfma_f32_16x16x32_bf16 v[88:91], v[168:171], v[140:143], v[88:91]
    s_xor_b32 s68, s80, 65536
    buffer_load_dwordx4 v[112:115], v28, s[48:51], s68 offen offset:0 sc1
    buffer_load_dwordx4 v[116:119], v28, s[48:51], s68 offen offset:1024 sc1
    s_xor_b32 s68, s80, 65536
    buffer_load_dwordx4 v[120:123], v28, s[48:51], s68 offen offset:256 sc1
    buffer_load_dwordx4 v[124:127], v28, s[48:51], s68 offen offset:1280 sc1
    v_mfma_f32_16x16x32_bf16 v[52:55], v[172:175], v[128:131], v[52:55]
    v_mfma_f32_16x16x32_bf16 v[60:63], v[172:175], v[132:135], v[60:63]
    v_mfma_f32_16x16x32_bf16 v[84:87], v[172:175], v[136:139], v[84:87]
    v_mfma_f32_16x16x32_bf16 v[92:95], v[172:175], v[140:143], v[92:95]
    s_waitcnt vmcnt(10)
    ds_read_b64_tr_b16 v[168:169], v3 offset:24576
    ds_read_b64_tr_b16 v[170:171], v3 offset:25088
    ds_read_b64_tr_b16 v[172:173], v4 offset:24576
    ds_read_b64_tr_b16 v[174:175], v4 offset:25088
    s_cmp_ge_u32 s59, 2
    s_cbranch_scc1 L_pa_48
    buffer_load_dword v223, v222, s[32:35], s41 offen
L_pa_48:
    s_waitcnt lgkmcnt(0)
    s_setprio 3
    v_mfma_f32_16x16x32_bf16 v[48:51], v[168:171], v[144:147], v[48:51]
    v_mfma_f32_16x16x32_bf16 v[56:59], v[168:171], v[148:151], v[56:59]
    v_mfma_f32_16x16x32_bf16 v[52:55], v[172:175], v[144:147], v[52:55]
    v_mfma_f32_16x16x32_bf16 v[60:63], v[172:175], v[148:151], v[60:63]
    v_mfma_f32_16x16x32_bf16 v[64:67], v[160:163], v[152:155], v[64:67]
    v_mfma_f32_16x16x32_bf16 v[72:75], v[160:163], v[156:159], v[72:75]
    v_mfma_f32_16x16x32_bf16 v[68:71], v[164:167], v[152:155], v[68:71]
    v_mfma_f32_16x16x32_bf16 v[76:79], v[164:167], v[156:159], v[76:79]
    s_nop 3
    ds_write_b128 v15, v[48:51] offset:16384
    ds_write_b128 v15, v[52:55] offset:17408
    ds_write_b128 v15, v[56:59] offset:18432
    ds_write_b128 v15, v[60:63] offset:19456
    v_mfma_f32_16x16x32_bf16 v[80:83], v[168:171], v[152:155], v[80:83]
    v_mfma_f32_16x16x32_bf16 v[88:91], v[168:171], v[156:159], v[88:91]
    v_mfma_f32_16x16x32_bf16 v[84:87], v[172:175], v[152:155], v[84:87]
    v_mfma_f32_16x16x32_bf16 v[92:95], v[172:175], v[156:159], v[92:95]
    ds_write_b128 v15, v[64:67] offset:20480
    ds_write_b128 v15, v[68:71] offset:21504
    ds_write_b128 v15, v[72:75] offset:22528
    ds_write_b128 v15, v[76:79] offset:23552
    v_mfma_f32_16x16x32_bf16 v[32:35], v[160:163], v[144:147], v[32:35]
    v_mfma_f32_16x16x32_bf16 v[40:43], v[160:163], v[148:151], v[40:43]
    v_mfma_f32_16x16x32_bf16 v[36:39], v[164:167], v[144:147], v[36:39]
    v_mfma_f32_16x16x32_bf16 v[44:47], v[164:167], v[148:151], v[44:47]
    s_setprio 3
    v_mov_b32 v29, 5
    ds_write_b128 v15, v[80:83] offset:24576
    ds_write_b128 v15, v[84:87] offset:25600
    ds_write_b128 v15, v[88:91] offset:26624
    ds_write_b128 v15, v[92:95] offset:27648
    ds_write_b32 v11, v29
L_lw_49:
    ds_read_b32 v29, v10 offset:0
    s_waitcnt lgkmcnt(0)
    v_cmp_le_u32 vcc, 5, v29
    s_cmp_eq_u64 vcc, -1
    s_cbranch_scc1 L_lwe_50
    s_sub_u32 s60, s60, 1
    s_cbranch_scc1 L_bail
    s_sleep 0
    s_branch L_lw_49
L_lwe_50:
    ds_read_b128 v[48:51], v250 offset:16384
    ds_read_b128 v[52:55], v250 offset:17408
    ds_read_b128 v[56:59], v250 offset:18432
    ds_read_b128 v[60:63], v250 offset:19456
    ds_read_b128 v[64:67], v251 offset:20480
    ds_read_b128 v[68:71], v251 offset:21504
    ds_read_b128 v[72:75], v251 offset:22528
    ds_read_b128 v[76:79], v251 offset:23552
    ds_read_b128 v[80:83], v252 offset:24576
    ds_read_b128 v[84:87], v252 offset:25600
    ds_read_b128 v[88:91], v252 offset:26624
    ds_read_b128 v[92:95], v252 offset:27648
    s_add_u32 m0, s76, 0
    s_nop 0
    buffer_load_dwordx4 v24, s[32:35], s4 offen lds
    buffer_load_dwordx4 v25, s[32:35], s4 offen offset:1024 lds
    s_add_u32 m0, s77, 2048
    s_nop 0
    buffer_load_dwordx4 v24, s[32:35], s5 offen lds
    buffer_load_dwordx4 v25, s[32:35], s5 offen offset:1024 lds
    s_waitcnt lgkmcnt(8)
    v_pk_add_f32 v[32:33], v[32:33], v[48:49]
    v_pk_add_f32 v[34:35], v[34:35], v[50:51]
    v_pk_add_f32 v[36:37], v[36:37], v[52:53]
    v_pk_add_f32 v[38:39], v[38:39], v[54:55]
    v_pk_add_f32 v[40:41], v[40:41], v[56:57]
    v_pk_add_f32 v[42:43], v[42:43], v[58:59]
    v_pk_add_f32 v[44:45], v[44:45], v[60:61]
    v_pk_add_f32 v[46:47], v[46:47], v[62:63]
    s_waitcnt lgkmcnt(4)
    v_pk_add_f32 v[32:33], v[32:33], v[64:65]
    v_pk_add_f32 v[34:35], v[34:35], v[66:67]
    v_pk_add_f32 v[36:37], v[36:37], v[68:69]
    v_pk_add_f32 v[38:39], v[38:39], v[70:71]
    v_pk_add_f32 v[40:41], v[40:41], v[72:73]
    v_pk_add_f32 v[42:43], v[42:43], v[74:75]
    v_pk_add_f32 v[44:45], v[44:45], v[76:77]
    v_pk_add_f32 v[46:47], v[46:47], v[78:79]
    s_waitcnt lgkmcnt(0)
    v_pk_add_f32 v[32:33], v[32:33], v[80:81]
    v_pk_add_f32 v[34:35], v[34:35], v[82:83]
    v_pk_add_f32 v[36:37], v[36:37], v[84:85]
    v_pk_add_f32 v[38:39], v[38:39], v[86:87]
    v_pk_add_f32 v[40:41], v[40:41], v[88:89]
    v_pk_add_f32 v[42:43], v[42:43], v[90:91]
    v_pk_add_f32 v[44:45], v[44:45], v[92:93]
    v_pk_add_f32 v[46:47], v[46:47], v[94:95]
    v_mov_b32 v29, 6
    ds_write_b32 v11, v29
    s_mov_b32 s74, 0xbdd2d3e8
    v_mov_b32 v80, 0xc0135761
    v_pk_mul_f32 v[48:49], v[32:33], v[32:33]
    v_pk_mul_f32 v[50:51], v[34:35], v[34:35]
    v_pk_mul_f32 v[52:53], v[36:37], v[36:37]
    v_pk_mul_f32 v[54:55], v[38:39], v[38:39]
    v_pk_mul_f32 v[56:57], v[40:41], v[40:41]
    v_pk_mul_f32 v[58:59], v[42:43], v[42:43]
    v_pk_mul_f32 v[60:61], v[44:45], v[44:45]
    v_pk_mul_f32 v[62:63], v[46:47], v[46:47]
    v_pk_fma_f32 v[48:49], v[48:49], s[74:75], v[80:81] op_sel_hi:[1,0,0]
    v_pk_fma_f32 v[50:51], v[50:51], s[74:75], v[80:81] op_sel_hi:[1,0,0]
    v_pk_fma_f32 v[52:53], v[52:53], s[74:75], v[80:81] op_sel_hi:[1,0,0]
    v_pk_fma_f32 v[54:55], v[54:55], s[74:75], v[80:81] op_sel_hi:[1,0,0]
    s_add_u32 m0, s76, 4096
    v_pk_fma_f32 v[56:57], v[56:57], s[74:75], v[80:81] op_sel_hi:[1,0,0]
    buffer_load_dwordx4 v24, s[32:35], s6 offen lds
    buffer_load_dwordx4 v25, s[32:35], s6 offen offset:1024 lds
    v_pk_fma_f32 v[58:59], v[58:59], s[74:75], v[80:81] op_sel_hi:[1,0,0]
    v_pk_fma_f32 v[60:61], v[60:61], s[74:75], v[80:81] op_sel_hi:[1,0,0]
    v_pk_fma_f32 v[62:63], v[62:63], s[74:75], v[80:81] op_sel_hi:[1,0,0]
    v_pk_mul_f32 v[48:49], v[48:49], v[32:33]
    v_pk_mul_f32 v[50:51], v[50:51], v[34:35]
    v_pk_mul_f32 v[52:53], v[52:53], v[36:37]
    v_pk_mul_f32 v[54:55], v[54:55], v[38:39]
    v_pk_mul_f32 v[56:57], v[56:57], v[40:41]
    v_pk_mul_f32 v[58:59], v[58:59], v[42:43]
    v_pk_mul_f32 v[60:61], v[60:61], v[44:45]
    v_pk_mul_f32 v[62:63], v[62:63], v[46:47]
    v_exp_f32 v48, v48
    v_exp_f32 v49, v49
    v_exp_f32 v50, v50
    v_exp_f32 v51, v51
    v_exp_f32 v52, v52
    v_exp_f32 v53, v53
    v_exp_f32 v54, v54
    v_exp_f32 v55, v55
    s_add_u32 m0, s77, 6144
    v_exp_f32 v56, v56
    buffer_load_dwordx4 v24, s[32:35], s7 offen lds
    buffer_load_dwordx4 v25, s[32:35], s7 offen offset:1024 lds
    v_exp_f32 v57, v57
    v_exp_f32 v58, v58
    v_exp_f32 v59, v59
    v_exp_f32 v60, v60
    v_exp_f32 v61, v61
    v_exp_f32 v62, v62
    v_exp_f32 v63, v63
    v_pk_add_f32 v[48:49], v[48:49], 1.0 op_sel_hi:[1,0]
    v_pk_add_f32 v[50:51], v[50:51], 1.0 op_sel_hi:[1,0]
    v_pk_add_f32 v[52:53], v[52:53], 1.0 op_sel_hi:[1,0]
    v_pk_add_f32 v[54:55], v[54:55], 1.0 op_sel_hi:[1,0]
    v_pk_add_f32 v[56:57], v[56:57], 1.0 op_sel_hi:[1,0]
    v_pk_add_f32 v[58:59], v[58:59], 1.0 op_sel_hi:[1,0]
    v_pk_add_f32 v[60:61], v[60:61], 1.0 op_sel_hi:[1,0]
    v_pk_add_f32 v[62:63], v[62:63], 1.0 op_sel_hi:[1,0]
    v_rcp_f32 v48, v48
    v_rcp_f32 v49, v49
    v_rcp_f32 v50, v50
    v_rcp_f32 v51, v51
    v_rcp_f32 v52, v52
    v_rcp_f32 v53, v53
    v_rcp_f32 v54, v54
    v_rcp_f32 v55, v55
    v_rcp_f32 v56, v56
    v_rcp_f32 v57, v57
    v_rcp_f32 v58, v58
    v_rcp_f32 v59, v59
    v_rcp_f32 v60, v60
    v_rcp_f32 v61, v61
    v_rcp_f32 v62, v62
    v_rcp_f32 v63, v63
    v_pk_mul_f32 v[48:49], v[48:49], v[32:33]
    v_pk_mul_f32 v[50:51], v[50:51], v[34:35]
    v_pk_mul_f32 v[52:53], v[52:53], v[36:37]
    v_pk_mul_f32 v[54:55], v[54:55], v[38:39]
    v_pk_mul_f32 v[56:57], v[56:57], v[40:41]
    v_pk_mul_f32 v[58:59], v[58:59], v[42:43]
    v_pk_mul_f32 v[60:61], v[60:61], v[44:45]
    v_pk_mul_f32 v[62:63], v[62:63], v[46:47]
    v_cvt_pk_bf16_f32 v212, v48, v49
    v_cvt_pk_bf16_f32 v213, v50, v51
    v_cvt_pk_bf16_f32 v214, v52, v53
    v_cvt_pk_bf16_f32 v215, v54, v55
    v_cvt_pk_bf16_f32 v216, v56, v57
    v_cvt_pk_bf16_f32 v217, v58, v59
    v_cvt_pk_bf16_f32 v218, v60, v61
    v_cvt_pk_bf16_f32 v219, v62, v63
    buffer_store_dwordx4 v[212:215], v5, s[48:51], s36 offen sc1
    buffer_store_dwordx4 v[216:219], v5, s[48:51], s37 offen sc1
    v_mov_b32 v220, s52
    s_add_u32 m0, s76, 8192
    s_nop 0
    buffer_load_dwordx4 v24, s[32:35], s8 offen lds
    buffer_load_dwordx4 v25, s[32:35], s8 offen offset:1024 lds
    s_add_u32 m0, s77, 10240
    s_nop 0
    buffer_load_dwordx4 v24, s[32:35], s9 offen lds
    buffer_load_dwordx4 v25, s[32:35], s9 offen offset:1024 lds
    s_waitcnt vmcnt(14)
    ds_read_b64_tr_b16 v[160:161], v248 offset:12288
    ds_read_b64_tr_b16 v[162:163], v248 offset:13312
    ds_read_b64_tr_b16 v[164:165], v249 offset:12288
    ds_read_b64_tr_b16 v[166:167], v249 offset:13312
    s_lshl_b32 s68, s54, 2
    s_add_u32 s68, s68, s59
    s_mul_i32 s68, s68, 3584
    s_add_u32 s78, s68, 327680
    v_min_u32 v9, 27, v0
    v_lshlrev_b32 v9, 7, v9
    s_lshl_b32 s66, s59, 19
    s_lshl_b32 s68, s54, 12
    s_add_u32 s66, s66, s68
    s_add_u32 s66, s66, 3145728
    v_mov_b32 v1, v8
    v_xor_b32 v2, 32, v8
    v_xor_b32 v3, 64, v8
    v_xor_b32 v4, 96, v8
    s_and_b32 s68, s100, 2
    s_lshl_b32 s68, s68, 14
    s_add_u32 s101, s66, s68
    s_and_b32 s68, s100, 6
    s_lshl_b32 s68, s68, 14
    s_add_u32 s66, s66, s68
    s_mul_i32 s79, s52, 8
    v_add_u32 v29, v96, v102
    v_add3_u32 v29, v104, v110, v29
    v_add3_u32 v29, v112, v118, v29
    v_add3_u32 v29, v120, v126, v29
    v_cmp_ne_u32 vcc, s79, v29
    s_cbranch_vccnz L_opx_54
L_ope_52:
    s_setprio 0
    s_waitcnt lgkmcnt(0)
    v_mfma_f32_16x16x32_bf16 v[32:35], v[160:163], v[98:101], 0
    v_mfma_f32_16x16x32_bf16 v[40:43], v[160:163], v[106:109], 0
    ds_read_b64_tr_b16 v[168:169], v254 offset:12288
    ds_read_b64_tr_b16 v[170:171], v254 offset:13312
    ds_read_b64_tr_b16 v[172:173], v17 offset:12288
    ds_read_b64_tr_b16 v[174:175], v17 offset:13312
    v_mfma_f32_16x16x32_bf16 v[64:67], v[160:163], v[114:117], 0
    v_mfma_f32_16x16x32_bf16 v[72:75], v[160:163], v[122:125], 0
    v_mfma_f32_16x16x32_bf16 v[36:39], v[164:167], v[98:101], 0
    v_mfma_f32_16x16x32_bf16 v[44:47], v[164:167], v[106:109], 0
    v_mfma_f32_16x16x32_bf16 v[68:71], v[164:167], v[114:117], 0
    v_mfma_f32_16x16x32_bf16 v[76:79], v[164:167], v[122:125], 0
    s_waitcnt vmcnt(4)
    s_mov_b64 exec, 0xff
    buffer_store_dwordx4 v[220:223], v5, s[48:51], s38 offen sc1
    s_mov_b64 exec, -1
    ds_read_b32 v30, v10
    s_waitcnt lgkmcnt(0)
    v_mfma_f32_16x16x32_bf16 v[48:51], v[168:171], v[98:101], 0
    v_mfma_f32_16x16x32_bf16 v[56:59], v[168:171], v[106:109], 0
    v_mfma_f32_16x16x32_bf16 v[80:83], v[168:171], v[114:117], 0
    v_mfma_f32_16x16x32_bf16 v[88:91], v[168:171], v[122:125], 0
    v_mfma_f32_16x16x32_bf16 v[52:55], v[172:175], v[98:101], 0
    v_mfma_f32_16x16x32_bf16 v[60:63], v[172:175], v[106:109], 0
    v_mfma_f32_16x16x32_bf16 v[84:87], v[172:175], v[114:117], 0
    v_mfma_f32_16x16x32_bf16 v[92:95], v[172:175], v[122:125], 0
    s_add_u32 m0, s76, 12288
    s_nop 0
    buffer_load_dwordx4 v24, s[32:35], s10 offen lds
    buffer_load_dwordx4 v25, s[32:35], s10 offen offset:1024 lds
    s_add_u32 m0, s77, 14336
    s_nop 0
    buffer_load_dwordx4 v24, s[32:35], s11 offen lds
    buffer_load_dwordx4 v25, s[32:35], s11 offen offset:1024 lds
    s_setprio 3
    v_cmp_gt_u32 vcc, 6, v30
    s_cbranch_vccnz L_ph6
L_ph6_ok:
    s_add_u32 s32, s32, 524288
    s_addc_u32 s33, s33, 0
    s_sub_u32 s34, s34, 524288
    s_add_u32 m0, s76, 16384
    s_nop 0
    buffer_load_dwordx4 v24, s[32:35], s4 offen lds
    buffer_load_dwordx4 v25, s[32:35], s4 offen offset:1024 lds
    s_add_u32 m0, s77, 18432
    s_nop 0
    buffer_load_dwordx4 v24, s[32:35], s5 offen lds
    buffer_load_dwordx4 v25, s[32:35], s5 offen offset:1024 lds
    s_mov_b64 exec, 0xff
    buffer_load_dword v29, v9, s[48:51], s78 offen sc1
    s_mov_b64 exec, -1
    s_add_u32 m0, s76, 20480
    s_nop 0
    buffer_load_dwordx4 v24, s[32:35], s6 offen lds
    buffer_load_dwordx4 v25, s[32:35], s6 offen offset:1024 lds
    s_add_u32 m0, s77, 22528
    s_nop 0
    buffer_load_dwordx4 v24, s[32:35], s7 offen lds
    buffer_load_dwordx4 v25, s[32:35], s7 offen offset:1024 lds
    s_cmp_ge_u32 s62, 7
    s_cbranch_scc1 L_sv_62
    s_call_b64 s[64:65], L_service
L_sv_62:
    s_waitcnt vmcnt(4)
L_g2:
    s_mov_b64 exec, 0xff
    s_branch L_gwc_65
L_gw_63:
    s_mov_b64 exec, s[82:83]
    buffer_load_dword v29, v9, s[48:51], s78 offen sc1
    s_waitcnt vmcnt(0)
L_gwc_65:
    v_cmp_ne_u32 s[82:83], s52, v29
    s_mov_b64 exec, -1
    s_cmp_eq_u64 s[82:83], 0
    s_cbranch_scc1 L_gwe_64
    s_sub_u32 s60, s60, 1
    s_cbranch_scc1 L_bail
    s_cmp_ge_u32 s62, 7
    s_cbranch_scc1 L_sv_66
    s_call_b64 s[64:65], L_service
L_sv_66:
    s_sleep 2
    s_branch L_gw_63
L_gwe_64:
    s_mov_b64 s[82:83], 0xfffff00
    s_setprio 0
    s_xor_b32 s68, s66, 0
    buffer_load_dwordx4 v[96:99], v246, s[48:51], s68 offen sc1
    buffer_load_dwordx4 v[100:103], v246, s[48:51], s68 offen offset:1024 sc1
    s_xor_b32 s68, s66, 0
    buffer_load_dwordx4 v[104:107], v247, s[48:51], s68 offen sc1
    buffer_load_dwordx4 v[108:111], v247, s[48:51], s68 offen offset:1024 sc1
    s_xor_b32 s68, s66, 32768
    buffer_load_dwordx4 v[112:115], v246, s[48:51], s68 offen sc1
    buffer_load_dwordx4 v[116:119], v246, s[48:51], s68 offen offset:1024 sc1
    s_xor_b32 s68, s66, 32768
    buffer_load_dwordx4 v[120:123], v247, s[48:51], s68 offen sc1
    buffer_load_dwordx4 v[124:127], v247, s[48:51], s68 offen offset:1024 sc1
    ds_read_b64_tr_b16 v[160:161], v1 offset:0
    ds_read_b64_tr_b16 v[162:163], v1 offset:2048
    ds_read_b64_tr_b16 v[164:165], v2 offset:0
    ds_read_b64_tr_b16 v[166:167], v2 offset:2048
    s_waitcnt vmcnt(4) lgkmcnt(0)
    v_mfma_f32_16x16x32_bf16 v[32:35], v[96:99], v[160:163], v[32:35]
    v_mfma_f32_16x16x32_bf16 v[36:39], v[100:103], v[160:163], v[36:39]
    ds_read_b64_tr_b16 v[168:169], v3 offset:0
    ds_read_b64_tr_b16 v[170:171], v3 offset:2048
    ds_read_b64_tr_b16 v[172:173], v4 offset:0
    ds_read_b64_tr_b16 v[174:175], v4 offset:2048
    v_mfma_f32_16x16x32_bf16 v[48:51], v[104:107], v[160:163], v[48:51]
    v_mfma_f32_16x16x32_bf16 v[52:55], v[108:111], v[160:163], v[52:55]
    s_xor_b32 s68, s66, 65536
    buffer_load_dwordx4 v[128:131], v246, s[48:51], s68 offen sc1
    buffer_load_dwordx4 v[132:135], v246, s[48:51], s68 offen offset:1024 sc1
    s_add_u32 m0, s76, 24576
    v_mfma_f32_16x16x32_bf16 v[40:43], v[96:99], v[164:167], v[40:43]
    v_mfma_f32_16x16x32_bf16 v[44:47], v[100:103], v[164:167], v[44:47]
    buffer_load_dwordx4 v24, s[32:35], s8 offen lds
    buffer_load_dwordx4 v25, s[32:35], s8 offen offset:1024 lds
    v_mfma_f32_16x16x32_bf16 v[56:59], v[104:107], v[164:167], v[56:59]
    v_mfma_f32_16x16x32_bf16 v[60:63], v[108:111], v[164:167], v[60:63]
    s_waitcnt lgkmcnt(0)
    v_mfma_f32_16x16x32_bf16 v[64:67], v[96:99], v[168:171], v[64:67]
    v_mfma_f32_16x16x32_bf16 v[68:71], v[100:103], v[168:171], v[68:71]
    ds_read_b64_tr_b16 v[160:161], v1 offset:4096
    ds_read_b64_tr_b16 v[162:163], v1 offset:6144
    ds_read_b64_tr_b16 v[164:165], v2 offset:4096
    ds_read_b64_tr_b16 v[166:167], v2 offset:6144
    v_mfma_f32_16x16x32_bf16 v[80:83], v[104:107], v[168:171], v[80:83]
    v_mfma_f32_16x16x32_bf16 v[84:87], v[108:111], v[168:171], v[84:87]
    s_cmp_eq_u64 s[82:83], 0
    s_cbranch_scc1 L_rp_67
    s_mov_b64 exec, s[82:83]
    buffer_load_dword v29, v9, s[48:51], s78 offen sc1
    s_mov_b64 exec, -1
L_rp_67:
    s_xor_b32 s68, s66, 65536
    buffer_load_dwordx4 v[136:139], v247, s[48:51], s68 offen sc1
    buffer_load_dwordx4 v[140:143], v247, s[48:51], s68 offen offset:1024 sc1
    s_add_u32 m0, s77, 26624
    v_mfma_f32_16x16x32_bf16 v[72:75], v[96:99], v[172:175], v[72:75]
    v_mfma_f32_16x16x32_bf16 v[76:79], v[100:103], v[172:175], v[76:79]
    buffer_load_dwordx4 v24, s[32:35], s9 offen lds
    buffer_load_dwordx4 v25, s[32:35], s9 offen offset:1024 lds
    v_mfma_f32_16x16x32_bf16 v[88:91], v[104:107], v[172:175], v[88:91]
    v_mfma_f32_16x16x32_bf16 v[92:95], v[108:111], v[172:175], v[92:95]
    s_waitcnt vmcnt(8) lgkmcnt(0)
    v_mfma_f32_16x16x32_bf16 v[32:35], v[112:115], v[160:163], v[32:35]
    v_mfma_f32_16x16x32_bf16 v[36:39], v[116:119], v[160:163], v[36:39]
    ds_read_b64_tr_b16 v[168:169], v3 offset:4096
    ds_read_b64_tr_b16 v[170:171], v3 offset:6144
    ds_read_b64_tr_b16 v[172:173], v4 offset:4096
    ds_read_b64_tr_b16 v[174:175], v4 offset:6144
    v_mfma_f32_16x16x32_bf16 v[48:51], v[120:123], v[160:163], v[48:51]
    v_mfma_f32_16x16x32_bf16 v[52:55], v[124:127], v[160:163], v[52:55]
    s_xor_b32 s68, s66, 98304
    buffer_load_dwordx4 v[144:147], v246, s[48:51], s68 offen sc1
    buffer_load_dwordx4 v[148:151], v246, s[48:51], s68 offen offset:1024 sc1
    s_add_u32 m0, s76, 0
    v_mfma_f32_16x16x32_bf16 v[40:43], v[112:115], v[164:167], v[40:43]
    v_mfma_f32_16x16x32_bf16 v[44:47], v[116:119], v[164:167], v[44:47]
    buffer_load_dwordx4 v24, s[32:35], s10 offen lds
    buffer_load_dwordx4 v25, s[32:35], s10 offen offset:1024 lds
    v_mfma_f32_16x16x32_bf16 v[56:59], v[120:123], v[164:167], v[56:59]
    v_mfma_f32_16x16x32_bf16 v[60:63], v[124:127], v[164:167], v[60:63]
    s_waitcnt lgkmcnt(0)
    v_mfma_f32_16x16x32_bf16 v[64:67], v[112:115], v[168:171], v[64:67]
    v_mfma_f32_16x16x32_bf16 v[68:71], v[116:119], v[168:171], v[68:71]
    ds_read_b64_tr_b16 v[160:161], v1 offset:8192
    ds_read_b64_tr_b16 v[162:163], v1 offset:10240
    ds_read_b64_tr_b16 v[164:165], v2 offset:8192
    ds_read_b64_tr_b16 v[166:167], v2 offset:10240
    ds_read_b32 v30, v12
    v_mfma_f32_16x16x32_bf16 v[80:83], v[120:123], v[168:171], v[80:83]
    v_mfma_f32_16x16x32_bf16 v[84:87], v[124:127], v[168:171], v[84:87]
    s_xor_b32 s68, s66, 98304
    buffer_load_dwordx4 v[152:155], v247, s[48:51], s68 offen sc1
    buffer_load_dwordx4 v[156:159], v247, s[48:51], s68 offen offset:1024 sc1
    s_add_u32 m0, s77, 2048
    v_mfma_f32_16x16x32_bf16 v[72:75], v[112:115], v[172:175], v[72:75]
    v_mfma_f32_16x16x32_bf16 v[76:79], v[116:119], v[172:175], v[76:79]
    buffer_load_dwordx4 v24, s[32:35], s11 offen lds
    buffer_load_dwordx4 v25, s[32:35], s11 offen offset:1024 lds
    v_mfma_f32_16x16x32_bf16 v[88:91], v[120:123], v[172:175], v[88:91]
    v_mfma_f32_16x16x32_bf16 v[92:95], v[124:127], v[172:175], v[92:95]
    s_waitcnt vmcnt(10) lgkmcnt(0)
    s_setprio 3
    v_cmp_ne_u32 vcc, s29, v30
    s_setprio 0
    v_mfma_f32_16x16x32_bf16 v[32:35], v[128:131], v[160:163], v[32:35]
    v_mfma_f32_16x16x32_bf16 v[36:39], v[132:135], v[160:163], v[36:39]
    ds_read_b64_tr_b16 v[168:169], v3 offset:8192
    ds_read_b64_tr_b16 v[170:171], v3 offset:10240
    ds_read_b64_tr_b16 v[172:173], v4 offset:8192
    ds_read_b64_tr_b16 v[174:175], v4 offset:10240
    v_mfma_f32_16x16x32_bf16 v[48:51], v[136:139], v[160:163], v[48:51]
    v_mfma_f32_16x16x32_bf16 v[52:55], v[140:143], v[160:163], v[52:55]
    s_cmp_eq_u64 s[82:83], 0
    s_cbranch_scc0 L_ux_68
L_ub_69:
    s_xor_b32 s68, s66, 131072
    buffer_load_dwordx4 v[96:99], v246, s[48:51], s68 offen sc1
    buffer_load_dwordx4 v[100:103], v246, s[48:51], s68 offen offset:1024 sc1
    s_add_u32 s69, s73, 16384
    s_add_u32 m0, s61, 4096
    v_mfma_f32_16x16x32_bf16 v[40:43], v[128:131], v[164:167], v[40:43]
    v_mfma_f32_16x16x32_bf16 v[44:47], v[132:135], v[164:167], v[44:47]
    buffer_load_dwordx4 v26, s[20:23], s69 offen lds
    buffer_load_dwordx4 v27, s[20:23], s69 offen offset:1024 lds
    v_mfma_f32_16x16x32_bf16 v[56:59], v[136:139], v[164:167], v[56:59]
    v_mfma_f32_16x16x32_bf16 v[60:63], v[140:143], v[164:167], v[60:63]
    s_cbranch_vccz L_fx_70
L_fb_71:
    s_waitcnt lgkmcnt(0)
    v_mfma_f32_16x16x32_bf16 v[64:67], v[128:131], v[168:171], v[64:67]
    v_mfma_f32_16x16x32_bf16 v[68:71], v[132:135], v[168:171], v[68:71]
    ds_read_b64_tr_b16 v[160:161], v1 offset:12288
    ds_read_b64_tr_b16 v[162:163], v1 offset:14336
    ds_read_b64_tr_b16 v[164:165], v2 offset:12288
    ds_read_b64_tr_b16 v[166:167], v2 offset:14336
    v_mfma_f32_16x16x32_bf16 v[80:83], v[136:139], v[168:171], v[80:83]
    v_mfma_f32_16x16x32_bf16 v[84:87], v[140:143], v[168:171], v[84:87]
    s_xor_b32 s68, s66, 131072
    buffer_load_dwordx4 v[104:107], v247, s[48:51], s68 offen sc1
    buffer_load_dwordx4 v[108:111], v247, s[48:51], s68 offen offset:1024 sc1
    s_add_u32 s69, s73, 81920
    s_add_u32 m0, s61, 6144
    v_mfma_f32_16x16x32_bf16 v[72:75], v[128:131], v[172:175], v[72:75]
    v_mfma_f32_16x16x32_bf16 v[76:79], v[132:135], v[172:175], v[76:79]
    buffer_load_dwordx4 v26, s[20:23], s69 offen lds
    buffer_load_dwordx4 v27, s[20:23], s69 offen offset:1024 lds
    v_mfma_f32_16x16x32_bf16 v[88:91], v[136:139], v[172:175], v[88:91]
    v_mfma_f32_16x16x32_bf16 v[92:95], v[140:143], v[172:175], v[92:95]
    s_waitcnt vmcnt(10) lgkmcnt(0)
    v_mfma_f32_16x16x32_bf16 v[32:35], v[144:147], v[160:163], v[32:35]
    v_mfma_f32_16x16x32_bf16 v[36:39], v[148:151], v[160:163], v[36:39]
    ds_read_b64_tr_b16 v[168:169], v3 offset:12288
    ds_read_b64_tr_b16 v[170:171], v3 offset:14336
    ds_read_b64_tr_b16 v[172:173], v4 offset:12288
    ds_read_b64_tr_b16 v[174:175], v4 offset:14336
    v_mfma_f32_16x16x32_bf16 v[48:51], v[152:155], v[160:163], v[48:51]
    v_mfma_f32_16x16x32_bf16 v[52:55], v[156:159], v[160:163], v[52:55]
    s_xor_b32 s68, s66, 163840
    buffer_load_dwordx4 v[112:115], v246, s[48:51], s68 offen sc1
    buffer_load_dwordx4 v[116:119], v246, s[48:51], s68 offen offset:1024 sc1
    s_add_u32 s32, s32, s39
    s_addc_u32 s33, s33, 0
    s_sub_u32 s34, s34, s39
    s_add_u32 m0, s76, 8192
    v_mfma_f32_16x16x32_bf16 v[40:43], v[144:147], v[164:167], v[40:43]
    v_mfma_f32_16x16x32_bf16 v[44:47], v[148:151], v[164:167], v[44:47]
    buffer_load_dwordx4 v24, s[32:35], s4 offen lds
    buffer_load_dwordx4 v25, s[32:35], s4 offen offset:1024 lds
    v_mfma_f32_16x16x32_bf16 v[56:59], v[152:155], v[164:167], v[56:59]
    v_mfma_f32_16x16x32_bf16 v[60:63], v[156:159], v[164:167], v[60:63]
    s_waitcnt lgkmcnt(0)
    v_mfma_f32_16x16x32_bf16 v[64:67], v[144:147], v[168:171], v[64:67]
    v_mfma_f32_16x16x32_bf16 v[68:71], v[148:151], v[168:171], v[68:71]
    ds_read_b64_tr_b16 v[160:161], v1 offset:16384
    ds_read_b64_tr_b16 v[162:163], v1 offset:18432
    ds_read_b64_tr_b16 v[164:165], v2 offset:16384
    ds_read_b64_tr_b16 v[166:167], v2 offset:18432
    ds_read_b32 v30, v12
    v_mfma_f32_16x16x32_bf16 v[80:83], v[152:155], v[168:171], v[80:83]
    v_mfma_f32_16x16x32_bf16 v[84:87], v[156:159], v[168:171], v[84:87]
    s_xor_b32 s68, s66, 163840
    buffer_load_dwordx4 v[120:123], v247, s[48:51], s68 offen sc1
    buffer_load_dwordx4 v[124:127], v247, s[48:51], s68 offen offset:1024 sc1
    s_add_u32 m0, s77, 10240
    v_mfma_f32_16x16x32_bf16 v[72:75], v[144:147], v[172:175], v[72:75]
    v_mfma_f32_16x16x32_bf16 v[76:79], v[148:151], v[172:175], v[76:79]
    buffer_load_dwordx4 v24, s[32:35], s5 offen lds
    buffer_load_dwordx4 v25, s[32:35], s5 offen offset:1024 lds
    v_mfma_f32_16x16x32_bf16 v[88:91], v[152:155], v[172:175], v[88:91]
    v_mfma_f32_16x16x32_bf16 v[92:95], v[156:159], v[172:175], v[92:95]
    s_waitcnt vmcnt(10) lgkmcnt(0)
    s_setprio 3
    v_cmp_ne_u32 vcc, s29, v30
    s_setprio 0
    v_mfma_f32_16x16x32_bf16 v[32:35], v[96:99], v[160:163], v[32:35]
    v_mfma_f32_16x16x32_bf16 v[36:39], v[100:103], v[160:163], v[36:39]
    ds_read_b64_tr_b16 v[168:169], v3 offset:16384
    ds_read_b64_tr_b16 v[170:171], v3 offset:18432
    ds_read_b64_tr_b16 v[172:173], v4 offset:16384
    ds_read_b64_tr_b16 v[174:175], v4 offset:18432
    v_mfma_f32_16x16x32_bf16 v[48:51], v[104:107], v[160:163], v[48:51]
    v_mfma_f32_16x16x32_bf16 v[52:55], v[108:111], v[160:163], v[52:55]
    s_xor_b32 s68, s66, 196608
    buffer_load_dwordx4 v[128:131], v246, s[48:51], s68 offen sc1
    buffer_load_dwordx4 v[132:135], v246, s[48:51], s68 offen offset:1024 sc1
    s_add_u32 m0, s76, 12288
    v_mfma_f32_16x16x32_bf16 v[40:43], v[96:99], v[164:167], v[40:43]
    v_mfma_f32_16x16x32_bf16 v[44:47], v[100:103], v[164:167], v[44:47]
    buffer_load_dwordx4 v24, s[32:35], s6 offen lds
    buffer_load_dwordx4 v25, s[32:35], s6 offen offset:1024 lds
    v_mfma_f32_16x16x32_bf16 v[56:59], v[104:107], v[164:167], v[56:59]
    v_mfma_f32_16x16x32_bf16 v[60:63], v[108:111], v[164:167], v[60:63]
    s_cbranch_vccz L_fx_72
L_fb_73:
    s_waitcnt lgkmcnt(0)
    v_mfma_f32_16x16x32_bf16 v[64:67], v[96:99], v[168:171], v[64:67]
    v_mfma_f32_16x16x32_bf16 v[68:71], v[100:103], v[168:171], v[68:71]
    ds_read_b64_tr_b16 v[160:161], v1 offset:20480
    ds_read_b64_tr_b16 v[162:163], v1 offset:22528
    ds_read_b64_tr_b16 v[164:165], v2 offset:20480
    ds_read_b64_tr_b16 v[166:167], v2 offset:22528
    v_mfma_f32_16x16x32_bf16 v[80:83], v[104:107], v[168:171], v[80:83]
    v_mfma_f32_16x16x32_bf16 v[84:87], v[108:111], v[168:171], v[84:87]
    s_xor_b32 s68, s66, 196608
    buffer_load_dwordx4 v[136:139], v247, s[48:51], s68 offen sc1
    buffer_load_dwordx4 v[140:143], v247, s[48:51], s68 offen offset:1024 sc1
    s_xor_b32 s68, s80, 2048
    buffer_load_dwordx4 v[212:215], v28, s[48:51], s68 offen offset:0 sc1
    buffer_load_dwordx4 v[216:219], v28, s[48:51], s68 offen offset:1024 sc1
    s_add_u32 m0, s77, 14336
    v_mfma_f32_16x16x32_bf16 v[72:75], v[96:99], v[172:175], v[72:75]
    v_mfma_f32_16x16x32_bf16 v[76:79], v[100:103], v[172:175], v[76:79]
    buffer_load_dwordx4 v24, s[32:35], s7 offen lds
    buffer_load_dwordx4 v25, s[32:35], s7 offen offset:1024 lds
    v_mfma_f32_16x16x32_bf16 v[88:91], v[104:107], v[172:175], v[88:91]
    v_mfma_f32_16x16x32_bf16 v[92:95], v[108:111], v[172:175], v[92:95]
    s_waitcnt vmcnt(12) lgkmcnt(0)
    v_mfma_f32_16x16x32_bf16 v[32:35], v[112:115], v[160:163], v[32:35]
    v_mfma_f32_16x16x32_bf16 v[36:39], v[116:119], v[160:163], v[36:39]
    ds_read_b64_tr_b16 v[168:169], v3 offset:20480
    ds_read_b64_tr_b16 v[170:171], v3 offset:22528
    ds_read_b64_tr_b16 v[172:173], v4 offset:20480
    ds_read_b64_tr_b16 v[174:175], v4 offset:22528
    v_mfma_f32_16x16x32_bf16 v[48:51], v[120:123], v[160:163], v[48:51]
    v_mfma_f32_16x16x32_bf16 v[52:55], v[124:127], v[160:163], v[52:55]
    s_xor_b32 s68, s66, 229376
    buffer_load_dwordx4 v[144:147], v246, s[48:51], s68 offen sc1
    buffer_load_dwordx4 v[148:151], v246, s[48:51], s68 offen offset:1024 sc1
    s_xor_b32 s68, s80, 2048
    buffer_load_dwordx4 v[220:223], v28, s[48:51], s68 offen offset:256 sc1
    buffer_load_dwordx4 v[224:227], v28, s[48:51], s68 offen offset:1280 sc1
    s_add_u32 m0, s76, 16384
    v_mfma_f32_16x16x32_bf16 v[40:43], v[112:115], v[164:167], v[40:43]
    v_mfma_f32_16x16x32_bf16 v[44:47], v[116:119], v[164:167], v[44:47]
    buffer_load_dwordx4 v24, s[32:35], s8 offen lds
    buffer_load_dwordx4 v25, s[32:35], s8 offen offset:1024 lds
    v_mfma_f32_16x16x32_bf16 v[56:59], v[120:123], v[164:167], v[56:59]
    v_mfma_f32_16x16x32_bf16 v[60:63], v[124:127], v[164:167], v[60:63]
    s_waitcnt lgkmcnt(0)
    v_mfma_f32_16x16x32_bf16 v[64:67], v[112:115], v[168:171], v[64:67]
    v_mfma_f32_16x16x32_bf16 v[68:71], v[116:119], v[168:171], v[68:71]
    ds_read_b64_tr_b16 v[160:161], v1 offset:24576
    ds_read_b64_tr_b16 v[162:163], v1 offset:26624
    ds_read_b64_tr_b16 v[164:165], v2 offset:24576
    ds_read_b64_tr_b16 v[166:167], v2 offset:26624
    ds_read_b32 v30, v12
    v_mfma_f32_16x16x32_bf16 v[80:83], v[120:123], v[168:171], v[80:83]
    v_mfma_f32_16x16x32_bf16 v[84:87], v[124:127], v[168:171], v[84:87]
    s_xor_b32 s68, s66, 229376
    buffer_load_dwordx4 v[152:155], v247, s[48:51], s68 offen sc1
    buffer_load_dwordx4 v[156:159], v247, s[48:51], s68 offen offset:1024 sc1
    s_xor_b32 s68, s80, 67584
    buffer_load_dwordx4 v[228:231], v28, s[48:51], s68 offen offset:0 sc1
    buffer_load_dwordx4 v[232:235], v28, s[48:51], s68 offen offset:1024 sc1
    s_add_u32 m0, s77, 18432
    v_mfma_f32_16x16x32_bf16 v[72:75], v[112:115], v[172:175], v[72:75]
    v_mfma_f32_16x16x32_bf16 v[76:79], v[116:119], v[172:175], v[76:79]
    buffer_load_dwordx4 v24, s[32:35], s9 offen lds
    buffer_load_dwordx4 v25, s[32:35], s9 offen offset:1024 lds
    v_mfma_f32_16x16x32_bf16 v[88:91], v[120:123], v[172:175], v[88:91]
    v_mfma_f32_16x16x32_bf16 v[92:95], v[124:127], v[172:175], v[92:95]
    s_waitcnt vmcnt(16) lgkmcnt(0)
    s_setprio 3
    v_cmp_ne_u32 vcc, s29, v30
    s_setprio 0
    v_mfma_f32_16x16x32_bf16 v[32:35], v[128:131], v[160:163], v[32:35]
    v_mfma_f32_16x16x32_bf16 v[36:39], v[132:135], v[160:163], v[36:39]
    ds_read_b64_tr_b16 v[168:169], v3 offset:24576
    ds_read_b64_tr_b16 v[170:171], v3 offset:26624
    ds_read_b64_tr_b16 v[172:173], v4 offset:24576
    ds_read_b64_tr_b16 v[174:175], v4 offset:26624
    v_mfma_f32_16x16x32_bf16 v[48:51], v[136:139], v[160:163], v[48:51]
    v_mfma_f32_16x16x32_bf16 v[52:55], v[140:143], v[160:163], v[52:55]
    s_xor_b32 s68, s66, 262144
    buffer_load_dwordx4 v[96:99], v246, s[48:51], s68 offen sc1
    buffer_load_dwordx4 v[100:103], v246, s[48:51], s68 offen offset:1024 sc1
    s_xor_b32 s68, s80, 67584
    buffer_load_dwordx4 v[236:239], v28, s[48:51], s68 offen offset:256 sc1
    buffer_load_dwordx4 v[240:243], v28, s[48:51], s68 offen offset:1280 sc1
    s_add_u32 m0, s76, 20480
    v_mfma_f32_16x16x32_bf16 v[40:43], v[128:131], v[164:167], v[40:43]
    v_mfma_f32_16x16x32_bf16 v[44:47], v[132:135], v[164:167], v[44:47]
    buffer_load_dwordx4 v24, s[32:35], s10 offen lds
    buffer_load_dwordx4 v25, s[32:35], s10 offen offset:1024 lds
    v_mfma_f32_16x16x32_bf16 v[56:59], v[136:139], v[164:167], v[56:59]
    v_mfma_f32_16x16x32_bf16 v[60:63], v[140:143], v[164:167], v[60:63]
    s_cbranch_vccz L_fx_74
L_fb_75:
    s_waitcnt lgkmcnt(0)
    v_mfma_f32_16x16x32_bf16 v[64:67], v[128:131], v[168:171], v[64:67]
    v_mfma_f32_16x16x32_bf16 v[68:71], v[132:135], v[168:171], v[68:71]
    ds_read_b64_tr_b16 v[160:161], v1 offset:0
    ds_read_b64_tr_b16 v[162:163], v1 offset:2048
    ds_read_b64_tr_b16 v[164:165], v2 offset:0
    ds_read_b64_tr_b16 v[166:167], v2 offset:2048
    v_mfma_f32_16x16x32_bf16 v[80:83], v[136:139], v[168:171], v[80:83]
    v_mfma_f32_16x16x32_bf16 v[84:87], v[140:143], v[168:171], v[84:87]
    s_xor_b32 s68, s66, 262144
    buffer_load_dwordx4 v[104:107], v247, s[48:51], s68 offen sc1
    buffer_load_dwordx4 v[108:111], v247, s[48:51], s68 offen offset:1024 sc1
    s_add_u32 m0, s77, 22528
    v_mfma_f32_16x16x32_bf16 v[72:75], v[128:131], v[172:175], v[72:75]
    v_mfma_f32_16x16x32_bf16 v[76:79], v[132:135], v[172:175], v[76:79]
    buffer_load_dwordx4 v24, s[32:35], s11 offen lds
    buffer_load_dwordx4 v25, s[32:35], s11 offen offset:1024 lds
    v_mfma_f32_16x16x32_bf16 v[88:91], v[136:139], v[172:175], v[88:91]
    v_mfma_f32_16x16x32_bf16 v[92:95], v[140:143], v[172:175], v[92:95]
    s_waitcnt vmcnt(14) lgkmcnt(0)
    v_mfma_f32_16x16x32_bf16 v[32:35], v[144:147], v[160:163], v[32:35]
    v_mfma_f32_16x16x32_bf16 v[36:39], v[148:151], v[160:163], v[36:39]
    ds_read_b64_tr_b16 v[168:169], v3 offset:0
    ds_read_b64_tr_b16 v[170:171], v3 offset:2048
    ds_read_b64_tr_b16 v[172:173], v4 offset:0
    ds_read_b64_tr_b16 v[174:175], v4 offset:2048
    v_mfma_f32_16x16x32_bf16 v[48:51], v[152:155], v[160:163], v[48:51]
    v_mfma_f32_16x16x32_bf16 v[52:55], v[156:159], v[160:163], v[52:55]
    s_xor_b32 s68, s66, 294912
    buffer_load_dwordx4 v[112:115], v246, s[48:51], s68 offen sc1
    buffer_load_dwordx4 v[116:119], v246, s[48:51], s68 offen offset:1024 sc1
    s_add_u32 s32, s32, s28
    s_addc_u32 s33, s33, 0
    s_sub_u32 s34, s34, s28
    s_add_u32 m0, s76, 24576
    v_mfma_f32_16x16x32_bf16 v[40:43], v[144:147], v[164:167], v[40:43]
    v_mfma_f32_16x16x32_bf16 v[44:47], v[148:151], v[164:167], v[44:47]
    buffer_load_dwordx4 v24, s[32:35], s4 offen lds
    buffer_load_dwordx4 v25, s[32:35], s4 offen offset:1024 lds
    v_mfma_f32_16x16x32_bf16 v[56:59], v[152:155], v[164:167], v[56:59]
    v_mfma_f32_16x16x32_bf16 v[60:63], v[156:159], v[164:167], v[60:63]
    s_waitcnt lgkmcnt(0)
    v_mfma_f32_16x16x32_bf16 v[64:67], v[144:147], v[168:171], v[64:67]
    v_mfma_f32_16x16x32_bf16 v[68:71], v[148:151], v[168:171], v[68:71]
    ds_read_b64_tr_b16 v[160:161], v248 offset:4096
    ds_read_b64_tr_b16 v[162:163], v248 offset:5120
    ds_read_b64_tr_b16 v[164:165], v249 offset:4096
    ds_read_b64_tr_b16 v[166:167], v249 offset:5120
    v_mfma_f32_16x16x32_bf16 v[80:83], v[152:155], v[168:171], v[80:83]
    v_mfma_f32_16x16x32_bf16 v[84:87], v[156:159], v[168:171], v[84:87]
    s_xor_b32 s68, s66, 294912
    buffer_load_dwordx4 v[120:123], v247, s[48:51], s68 offen sc1
    buffer_load_dwordx4 v[124:127], v247, s[48:51], s68 offen offset:1024 sc1
    s_add_u32 m0, s77, 26624
    v_mfma_f32_16x16x32_bf16 v[72:75], v[144:147], v[172:175], v[72:75]
    v_mfma_f32_16x16x32_bf16 v[76:79], v[148:151], v[172:175], v[76:79]
    buffer_load_dwordx4 v24, s[32:35], s5 offen lds
    buffer_load_dwordx4 v25, s[32:35], s5 offen offset:1024 lds
    v_mfma_f32_16x16x32_bf16 v[88:91], v[152:155], v[172:175], v[88:91]
    v_mfma_f32_16x16x32_bf16 v[92:95], v[156:159], v[172:175], v[92:95]
    s_waitcnt vmcnt(14)
    s_setprio 3
    s_mul_i32 s79, s52, 8
    v_add_u32 v29, v212, v218
    v_add3_u32 v29, v220, v226, v29
    v_add3_u32 v29, v228, v234, v29
    v_add3_u32 v29, v236, v242, v29
    v_cmp_ne_u32 vcc, s79, v29
    s_cbranch_vccnz L_opx_79
L_ope_77:
    s_setprio 0
    s_waitcnt lgkmcnt(0)
    v_mfma_f32_16x16x32_bf16 v[32:35], v[160:163], v[214:217], v[32:35]
    v_mfma_f32_16x16x32_bf16 v[40:43], v[160:163], v[222:225], v[40:43]
    ds_read_b64_tr_b16 v[168:169], v254 offset:4096
    ds_read_b64_tr_b16 v[170:171], v254 offset:5120
    ds_read_b64_tr_b16 v[172:173], v17 offset:4096
    ds_read_b64_tr_b16 v[174:175], v17 offset:5120
    v_mfma_f32_16x16x32_bf16 v[64:67], v[160:163], v[230:233], v[64:67]
    v_mfma_f32_16x16x32_bf16 v[72:75], v[160:163], v[238:241], v[72:75]
    s_add_u32 m0, s76, 0
    v_mfma_f32_16x16x32_bf16 v[36:39], v[164:167], v[214:217], v[36:39]
    v_mfma_f32_16x16x32_bf16 v[44:47], v[164:167], v[222:225], v[44:47]
    buffer_load_dwordx4 v24, s[32:35], s6 offen lds
    buffer_load_dwordx4 v25, s[32:35], s6 offen offset:1024 lds
    v_mfma_f32_16x16x32_bf16 v[68:71], v[164:167], v[230:233], v[68:71]
    v_mfma_f32_16x16x32_bf16 v[76:79], v[164:167], v[238:241], v[76:79]
    s_waitcnt lgkmcnt(0)
    v_mfma_f32_16x16x32_bf16 v[48:51], v[168:171], v[214:217], v[48:51]
    v_mfma_f32_16x16x32_bf16 v[56:59], v[168:171], v[222:225], v[56:59]
    ds_read_b64_tr_b16 v[160:161], v1 offset:8192
    ds_read_b64_tr_b16 v[162:163], v1 offset:10240
    ds_read_b64_tr_b16 v[164:165], v2 offset:8192
    ds_read_b64_tr_b16 v[166:167], v2 offset:10240
    v_mfma_f32_16x16x32_bf16 v[80:83], v[168:171], v[230:233], v[80:83]
    v_mfma_f32_16x16x32_bf16 v[88:91], v[168:171], v[238:241], v[88:91]
    s_add_u32 m0, s77, 2048
    v_mfma_f32_16x16x32_bf16 v[52:55], v[172:175], v[214:217], v[52:55]
    v_mfma_f32_16x16x32_bf16 v[60:63], v[172:175], v[222:225], v[60:63]
    buffer_load_dwordx4 v24, s[32:35], s7 offen lds
    buffer_load_dwordx4 v25, s[32:35], s7 offen offset:1024 lds
    v_mfma_f32_16x16x32_bf16 v[84:87], v[172:175], v[230:233], v[84:87]
    v_mfma_f32_16x16x32_bf16 v[92:95], v[172:175], v[238:241], v[92:95]
    s_waitcnt vmcnt(14) lgkmcnt(0)
    v_mfma_f32_16x16x32_bf16 v[32:35], v[96:99], v[160:163], v[32:35]
    v_mfma_f32_16x16x32_bf16 v[36:39], v[100:103], v[160:163], v[36:39]
    ds_read_b64_tr_b16 v[168:169], v3 offset:8192
    ds_read_b64_tr_b16 v[170:171], v3 offset:10240
    ds_read_b64_tr_b16 v[172:173], v4 offset:8192
    ds_read_b64_tr_b16 v[174:175], v4 offset:10240
    v_mfma_f32_16x16x32_bf16 v[48:51], v[104:107], v[160:163], v[48:51]
    v_mfma_f32_16x16x32_bf16 v[52:55], v[108:111], v[160:163], v[52:55]
    s_xor_b32 s68, s66, 327680
    buffer_load_dwordx4 v[128:131], v246, s[48:51], s68 offen sc1
    buffer_load_dwordx4 v[132:135], v246, s[48:51], s68 offen offset:1024 sc1
    s_xor_b32 s68, s66, 327680
    buffer_load_dwordx4 v[136:139], v247, s[48:51], s68 offen sc1
    buffer_load_dwordx4 v[140:143], v247, s[48:51], s68 offen offset:1024 sc1
    s_xor_b32 s68, s80, 4096
    buffer_load_dwordx4 v[212:215], v28, s[48:51], s68 offen offset:0 sc1
    buffer_load_dwordx4 v[216:219], v28, s[48:51], s68 offen offset:1024 sc1
    s_add_u32 s69, s73, 32768
    s_add_u32 m0, s61, 4096
    v_mfma_f32_16x16x32_bf16 v[40:43], v[96:99], v[164:167], v[40:43]
    v_mfma_f32_16x16x32_bf16 v[44:47], v[100:103], v[164:167], v[44:47]
    buffer_load_dwordx4 v26, s[20:23], s69 offen lds
    buffer_load_dwordx4 v27, s[20:23], s69 offen offset:1024 lds
    s_add_u32 s69, s73, 98304
    s_add_u32 m0, s61, 6144
    v_mfma_f32_16x16x32_bf16 v[56:59], v[104:107], v[164:167], v[56:59]
    v_mfma_f32_16x16x32_bf16 v[60:63], v[108:111], v[164:167], v[60:63]
    buffer_load_dwordx4 v26, s[20:23], s69 offen lds
    buffer_load_dwordx4 v27, s[20:23], s69 offen offset:1024 lds
    s_waitcnt lgkmcnt(0)
    v_mfma_f32_16x16x32_bf16 v[64:67], v[96:99], v[168:171], v[64:67]
    v_mfma_f32_16x16x32_bf16 v[68:71], v[100:103], v[168:171], v[68:71]
    ds_read_b64_tr_b16 v[160:161], v1 offset:12288
    ds_read_b64_tr_b16 v[162:163], v1 offset:14336
    ds_read_b64_tr_b16 v[164:165], v2 offset:12288
    ds_read_b64_tr_b16 v[166:167], v2 offset:14336
    ds_read_b32 v30, v12
    v_mfma_f32_16x16x32_bf16 v[80:83], v[104:107], v[168:171], v[80:83]
    v_mfma_f32_16x16x32_bf16 v[84:87], v[108:111], v[168:171], v[84:87]
    s_xor_b32 s68, s66, 360448
    buffer_load_dwordx4 v[144:147], v246, s[48:51], s68 offen sc1
    buffer_load_dwordx4 v[148:151], v246, s[48:51], s68 offen offset:1024 sc1
    s_xor_b32 s68, s66, 360448
    buffer_load_dwordx4 v[152:155], v247, s[48:51], s68 offen sc1
    buffer_load_dwordx4 v[156:159], v247, s[48:51], s68 offen offset:1024 sc1
    s_xor_b32 s68, s80, 4096
    buffer_load_dwordx4 v[220:223], v28, s[48:51], s68 offen offset:256 sc1
    buffer_load_dwordx4 v[224:227], v28, s[48:51], s68 offen offset:1280 sc1
    s_add_u32 s69, s73, 49152
    s_add_u32 m0, s61, 8192
    v_mfma_f32_16x16x32_bf16 v[72:75], v[96:99], v[172:175], v[72:75]
    v_mfma_f32_16x16x32_bf16 v[76:79], v[100:103], v[172:175], v[76:79]
    buffer_load_dwordx4 v26, s[20:23], s69 offen lds
    buffer_load_dwordx4 v27, s[20:23], s69 offen offset:1024 lds
    v_mfma_f32_16x16x32_bf16 v[88:91], v[104:107], v[172:175], v[88:91]
    v_mfma_f32_16x16x32_bf16 v[92:95], v[108:111], v[172:175], v[92:95]
    s_waitcnt vmcnt(24) lgkmcnt(0)
    s_setprio 3
    v_cmp_ne_u32 vcc, s29, v30
    s_setprio 0
    v_mfma_f32_16x16x32_bf16 v[32:35], v[112:115], v[160:163], v[32:35]
    v_mfma_f32_16x16x32_bf16 v[36:39], v[116:119], v[160:163], v[36:39]
    ds_read_b64_tr_b16 v[168:169], v3 offset:12288
    ds_read_b64_tr_b16 v[170:171], v3 offset:14336
    ds_read_b64_tr_b16 v[172:173], v4 offset:12288
    ds_read_b64_tr_b16 v[174:175], v4 offset:14336
    v_mfma_f32_16x16x32_bf16 v[48:51], v[120:123], v[160:163], v[48:51]
    v_mfma_f32_16x16x32_bf16 v[52:55], v[124:127], v[160:163], v[52:55]
    s_xor_b32 s68, s101, 393216
    buffer_load_dwordx4 v[96:99], v246, s[48:51], s68 offen sc1
    buffer_load_dwordx4 v[100:103], v246, s[48:51], s68 offen offset:1024 sc1
    s_xor_b32 s68, s80, 69632
    buffer_load_dwordx4 v[228:231], v28, s[48:51], s68 offen offset:0 sc1
    buffer_load_dwordx4 v[232:235], v28, s[48:51], s68 offen offset:1024 sc1
    s_add_u32 s69, s73, 114688
    s_add_u32 m0, s61, 10240
    v_mfma_f32_16x16x32_bf16 v[40:43], v[112:115], v[164:167], v[40:43]
    v_mfma_f32_16x16x32_bf16 v[44:47], v[116:119], v[164:167], v[44:47]
    buffer_load_dwordx4 v26, s[20:23], s69 offen lds
    buffer_load_dwordx4 v27, s[20:23], s69 offen offset:1024 lds
    v_mfma_f32_16x16x32_bf16 v[56:59], v[120:123], v[164:167], v[56:59]
    v_mfma_f32_16x16x32_bf16 v[60:63], v[124:127], v[164:167], v[60:63]
    s_cbranch_vccz L_fx_87
L_fb_88:
    s_waitcnt lgkmcnt(0)
    v_mfma_f32_16x16x32_bf16 v[64:67], v[112:115], v[168:171], v[64:67]
    v_mfma_f32_16x16x32_bf16 v[68:71], v[116:119], v[168:171], v[68:71]
    ds_read_b64_tr_b16 v[160:161], v1 offset:16384
    ds_read_b64_tr_b16 v[162:163], v1 offset:18432
    ds_read_b64_tr_b16 v[164:165], v2 offset:16384
    ds_read_b64_tr_b16 v[166:167], v2 offset:18432
    v_mfma_f32_16x16x32_bf16 v[80:83], v[120:123], v[168:171], v[80:83]
    v_mfma_f32_16x16x32_bf16 v[84:87], v[124:127], v[168:171], v[84:87]
    s_xor_b32 s68, s101, 393216
    buffer_load_dwordx4 v[104:107], v247, s[48:51], s68 offen sc1
    buffer_load_dwordx4 v[108:111], v247, s[48:51], s68 offen offset:1024 sc1
    s_xor_b32 s68, s80, 69632
    buffer_load_dwordx4 v[236:239], v28, s[48:51], s68 offen offset:256 sc1
    buffer_load_dwordx4 v[240:243], v28, s[48:51], s68 offen offset:1280 sc1
    v_mfma_f32_16x16x32_bf16 v[72:75], v[112:115], v[172:175], v[72:75]
    v_mfma_f32_16x16x32_bf16 v[76:79], v[116:119], v[172:175], v[76:79]
    v_mfma_f32_16x16x32_bf16 v[88:91], v[120:123], v[172:175], v[88:91]
    v_mfma_f32_16x16x32_bf16 v[92:95], v[124:127], v[172:175], v[92:95]
    s_setprio 3
    s_mov_b64 s[70:71], vcc
    s_mul_i32 s68, s59, 2560
    s_add_u32 s68, s68, 135676
    v_mov_b32 v18, s68
    s_add_u32 s43, s52, 8
L_lw_89:
    ds_read_b32 v29, v18 offset:0
    s_waitcnt lgkmcnt(0)
    v_cmp_eq_u32 vcc, s43, v29
    s_cmp_eq_u64 vcc, -1
    s_cbranch_scc1 L_lwe_90
    s_sub_u32 s60, s60, 1
    s_cbranch_scc1 L_bail
    s_cmp_ge_u32 s62, 7
    s_cbranch_scc1 L_sv_91
    s_call_b64 s[64:65], L_service
L_sv_91:
    s_sleep 3
    s_branch L_lw_89
L_lwe_90:
    s_mov_b64 vcc, -1
    s_setprio 0
    s_waitcnt vmcnt(24) lgkmcnt(0)
    v_mfma_f32_16x16x32_bf16 v[32:35], v[128:131], v[160:163], v[32:35]
    v_mfma_f32_16x16x32_bf16 v[36:39], v[132:135], v[160:163], v[36:39]
    ds_read_b64_tr_b16 v[168:169], v3 offset:16384
    ds_read_b64_tr_b16 v[170:171], v3 offset:18432
    ds_read_b64_tr_b16 v[172:173], v4 offset:16384
    ds_read_b64_tr_b16 v[174:175], v4 offset:18432
    v_mfma_f32_16x16x32_bf16 v[48:51], v[136:139], v[160:163], v[48:51]
    v_mfma_f32_16x16x32_bf16 v[52:55], v[140:143], v[160:163], v[52:55]
    s_xor_b32 s68, s101, 425984
    buffer_load_dwordx4 v[112:115], v246, s[48:51], s68 offen sc1
    buffer_load_dwordx4 v[116:119], v246, s[48:51], s68 offen offset:1024 sc1
    v_mfma_f32_16x16x32_bf16 v[40:43], v[128:131], v[164:167], v[40:43]
    v_mfma_f32_16x16x32_bf16 v[44:47], v[132:135], v[164:167], v[44:47]
    v_mfma_f32_16x16x32_bf16 v[56:59], v[136:139], v[164:167], v[56:59]
    v_mfma_f32_16x16x32_bf16 v[60:63], v[140:143], v[164:167], v[60:63]
    s_waitcnt lgkmcnt(0)
    v_mfma_f32_16x16x32_bf16 v[64:67], v[128:131], v[168:171], v[64:67]
    v_mfma_f32_16x16x32_bf16 v[68:71], v[132:135], v[168:171], v[68:71]
    ds_read_b64_tr_b16 v[160:161], v1 offset:20480
    ds_read_b64_tr_b16 v[162:163], v1 offset:22528
    ds_read_b64_tr_b16 v[164:165], v2 offset:20480
    ds_read_b64_tr_b16 v[166:167], v2 offset:22528
    ds_read_b32 v30, v12
    v_mfma_f32_16x16x32_bf16 v[80:83], v[136:139], v[168:171], v[80:83]
    v_mfma_f32_16x16x32_bf16 v[84:87], v[140:143], v[168:171], v[84:87]
    s_xor_b32 s68, s101, 425984
    buffer_load_dwordx4 v[120:123], v247, s[48:51], s68 offen sc1
    buffer_load_dwordx4 v[124:127], v247, s[48:51], s68 offen offset:1024 sc1
    v_mfma_f32_16x16x32_bf16 v[72:75], v[128:131], v[172:175], v[72:75]
    v_mfma_f32_16x16x32_bf16 v[76:79], v[132:135], v[172:175], v[76:79]
    v_mfma_f32_16x16x32_bf16 v[88:91], v[136:139], v[172:175], v[88:91]
    v_mfma_f32_16x16x32_bf16 v[92:95], v[140:143], v[172:175], v[92:95]
    s_waitcnt vmcnt(18) lgkmcnt(0)
    s_setprio 3
    v_cmp_ne_u32 vcc, s29, v30
    s_setprio 0
    v_mfma_f32_16x16x32_bf16 v[32:35], v[144:147], v[160:163], v[32:35]
    v_mfma_f32_16x16x32_bf16 v[36:39], v[148:151], v[160:163], v[36:39]
    ds_read_b64_tr_b16 v[168:169], v3 offset:20480
    ds_read_b64_tr_b16 v[170:171], v3 offset:22528
    ds_read_b64_tr_b16 v[172:173], v4 offset:20480
    ds_read_b64_tr_b16 v[174:175], v4 offset:22528
    v_mfma_f32_16x16x32_bf16 v[48:51], v[152:155], v[160:163], v[48:51]
    v_mfma_f32_16x16x32_bf16 v[52:55], v[156:159], v[160:163], v[52:55]
    v_mfma_f32_16x16x32_bf16 v[40:43], v[144:147], v[164:167], v[40:43]
    v_mfma_f32_16x16x32_bf16 v[44:47], v[148:151], v[164:167], v[44:47]
    v_mfma_f32_16x16x32_bf16 v[56:59], v[152:155], v[164:167], v[56:59]
    v_mfma_f32_16x16x32_bf16 v[60:63], v[156:159], v[164:167], v[60:63]
    s_cbranch_vccz L_fx_92
L_fb_93:
    s_waitcnt lgkmcnt(0)
    v_mfma_f32_16x16x32_bf16 v[64:67], v[144:147], v[168:171], v[64:67]
    v_mfma_f32_16x16x32_bf16 v[68:71], v[148:151], v[168:171], v[68:71]
    ds_read_b64_tr_b16 v[160:161], v1 offset:24576
    ds_read_b64_tr_b16 v[162:163], v1 offset:26624
    ds_read_b64_tr_b16 v[164:165], v2 offset:24576
    ds_read_b64_tr_b16 v[166:167], v2 offset:26624
    v_mfma_f32_16x16x32_bf16 v[80:83], v[152:155], v[168:171], v[80:83]
    v_mfma_f32_16x16x32_bf16 v[84:87], v[156:159], v[168:171], v[84:87]
    v_mfma_f32_16x16x32_bf16 v[72:75], v[144:147], v[172:175], v[72:75]
    v_mfma_f32_16x16x32_bf16 v[76:79], v[148:151], v[172:175], v[76:79]
    v_mfma_f32_16x16x32_bf16 v[88:91], v[152:155], v[172:175], v[88:91]
    v_mfma_f32_16x16x32_bf16 v[92:95], v[156:159], v[172:175], v[92:95]
    s_waitcnt vmcnt(6) lgkmcnt(0)
    v_mfma_f32_16x16x32_bf16 v[32:35], v[96:99], v[160:163], v[32:35]
    v_mfma_f32_16x16x32_bf16 v[36:39], v[100:103], v[160:163], v[36:39]
    ds_read_b64_tr_b16 v[168:169], v3 offset:24576
    ds_read_b64_tr_b16 v[170:171], v3 offset:26624
    ds_read_b64_tr_b16 v[172:173], v4 offset:24576
    ds_read_b64_tr_b16 v[174:175], v4 offset:26624
    v_mfma_f32_16x16x32_bf16 v[48:51], v[104:107], v[160:163], v[48:51]
    v_mfma_f32_16x16x32_bf16 v[52:55], v[108:111], v[160:163], v[52:55]
    v_mfma_f32_16x16x32_bf16 v[40:43], v[96:99], v[164:167], v[40:43]
    v_mfma_f32_16x16x32_bf16 v[44:47], v[100:103], v[164:167], v[44:47]
    v_mfma_f32_16x16x32_bf16 v[56:59], v[104:107], v[164:167], v[56:59]
    v_mfma_f32_16x16x32_bf16 v[60:63], v[108:111], v[164:167], v[60:63]
    s_waitcnt lgkmcnt(0)
    v_mfma_f32_16x16x32_bf16 v[64:67], v[96:99], v[168:171], v[64:67]
    v_mfma_f32_16x16x32_bf16 v[68:71], v[100:103], v[168:171], v[68:71]
    ds_read_b64_tr_b16 v[160:161], v1 offset:0
    ds_read_b64_tr_b16 v[162:163], v1 offset:2048
    ds_read_b64_tr_b16 v[164:165], v2 offset:0
    ds_read_b64_tr_b16 v[166:167], v2 offset:2048
    ds_read_b32 v30, v12
    v_mfma_f32_16x16x32_bf16 v[80:83], v[104:107], v[168:171], v[80:83]
    v_mfma_f32_16x16x32_bf16 v[84:87], v[108:111], v[168:171], v[84:87]
    v_mfma_f32_16x16x32_bf16 v[72:75], v[96:99], v[172:175], v[72:75]
    v_mfma_f32_16x16x32_bf16 v[76:79], v[100:103], v[172:175], v[76:79]
    v_mfma_f32_16x16x32_bf16 v[88:91], v[104:107], v[172:175], v[88:91]
    v_mfma_f32_16x16x32_bf16 v[92:95], v[108:111], v[172:175], v[92:95]
    s_waitcnt vmcnt(0) lgkmcnt(0)
    s_setprio 3
    v_cmp_ne_u32 vcc, s29, v30
    s_setprio 0
    v_mfma_f32_16x16x32_bf16 v[32:35], v[112:115], v[160:163], v[32:35]
    v_mfma_f32_16x16x32_bf16 v[36:39], v[116:119], v[160:163], v[36:39]
    ds_read_b64_tr_b16 v[168:169], v3 offset:0
    ds_read_b64_tr_b16 v[170:171], v3 offset:2048
    ds_read_b64_tr_b16 v[172:173], v4 offset:0
    ds_read_b64_tr_b16 v[174:175], v4 offset:2048
    v_mfma_f32_16x16x32_bf16 v[48:51], v[120:123], v[160:163], v[48:51]
    v_mfma_f32_16x16x32_bf16 v[52:55], v[124:127], v[160:163], v[52:55]
    s_and_b32 s43, s80, 0xfffeffff
    s_add_u32 s43, s43, 8184
    s_mov_b64 exec, 15
    buffer_load_dword v9, v253, s[48:51], s43 offen sc1
    s_mov_b64 exec, -1
    v_mfma_f32_16x16x32_bf16 v[40:43], v[112:115], v[164:167], v[40:43]
    v_mfma_f32_16x16x32_bf16 v[44:47], v[116:119], v[164:167], v[44:47]
    v_mfma_f32_16x16x32_bf16 v[56:59], v[120:123], v[164:167], v[56:59]
    v_mfma_f32_16x16x32_bf16 v[60:63], v[124:127], v[164:167], v[60:63]
    s_cbranch_vccz L_fx_94
L_fb_95:
    s_waitcnt lgkmcnt(0)
    v_mfma_f32_16x16x32_bf16 v[64:67], v[112:115], v[168:171], v[64:67]
    v_mfma_f32_16x16x32_bf16 v[68:71], v[116:119], v[168:171], v[68:71]
    ds_read_b64_tr_b16 v[160:161], v248 offset:4096
    ds_read_b64_tr_b16 v[162:163], v248 offset:5120
    ds_read_b64_tr_b16 v[164:165], v249 offset:4096
    ds_read_b64_tr_b16 v[166:167], v249 offset:5120
    v_mfma_f32_16x16x32_bf16 v[80:83], v[120:123], v[168:171], v[80:83]
    v_mfma_f32_16x16x32_bf16 v[84:87], v[124:127], v[168:171], v[84:87]
    v_mfma_f32_16x16x32_bf16 v[72:75], v[112:115], v[172:175], v[72:75]
    v_mfma_f32_16x16x32_bf16 v[76:79], v[116:119], v[172:175], v[76:79]
    v_mfma_f32_16x16x32_bf16 v[88:91], v[120:123], v[172:175], v[88:91]
    v_mfma_f32_16x16x32_bf16 v[92:95], v[124:127], v[172:175], v[92:95]
    s_setprio 3
    s_mul_i32 s79, s52, 8
    v_add_u32 v29, v212, v218
    v_add3_u32 v29, v220, v226, v29
    v_add3_u32 v29, v228, v234, v29
    v_add3_u32 v29, v236, v242, v29
    v_cmp_ne_u32 vcc, s79, v29
    s_cbranch_vccnz L_opx_99
L_ope_97:
    s_setprio 0
    s_waitcnt lgkmcnt(0)
    v_mfma_f32_16x16x32_bf16 v[32:35], v[160:163], v[214:217], v[32:35]
    v_mfma_f32_16x16x32_bf16 v[40:43], v[160:163], v[222:225], v[40:43]
    ds_read_b64_tr_b16 v[168:169], v254 offset:4096
    ds_read_b64_tr_b16 v[170:171], v254 offset:5120
    ds_read_b64_tr_b16 v[172:173], v17 offset:4096
    ds_read_b64_tr_b16 v[174:175], v17 offset:5120
    v_mfma_f32_16x16x32_bf16 v[64:67], v[160:163], v[230:233], v[64:67]
    v_mfma_f32_16x16x32_bf16 v[72:75], v[160:163], v[238:241], v[72:75]
    s_waitcnt vmcnt(0)
    s_setprio 3
    v_not_b32 v134, s52
    s_mov_b64 exec, 15
    v_cmp_ne_u32 s[82:83], s52, v9
    s_mov_b64 exec, -1
    s_setprio 0
    s_cmp_lg_u64 s[82:83], 0
    s_cbranch_scc1 L_l3_107
    s_xor_b32 s68, s80, 6144
    buffer_load_dwordx4 v[128:131], v28, s[48:51], s68 offen offset:0 sc1
    buffer_load_dwordx4 v[132:135], v28, s[48:51], s68 offen offset:1024 sc1
    s_xor_b32 s68, s80, 6144
    buffer_load_dwordx4 v[136:139], v28, s[48:51], s68 offen offset:256 sc1
    buffer_load_dwordx4 v[140:143], v28, s[48:51], s68 offen offset:1280 sc1
    s_xor_b32 s68, s80, 71680
    buffer_load_dwordx4 v[144:147], v28, s[48:51], s68 offen offset:0 sc1
    buffer_load_dwordx4 v[148:151], v28, s[48:51], s68 offen offset:1024 sc1
    s_xor_b32 s68, s80, 71680
    buffer_load_dwordx4 v[152:155], v28, s[48:51], s68 offen offset:256 sc1
    buffer_load_dwordx4 v[156:159], v28, s[48:51], s68 offen offset:1280 sc1
L_l3_107:
    v_mfma_f32_16x16x32_bf16 v[36:39], v[164:167], v[214:217], v[36:39]
    v_mfma_f32_16x16x32_bf16 v[44:47], v[164:167], v[222:225], v[44:47]
    v_mfma_f32_16x16x32_bf16 v[68:71], v[164:167], v[230:233], v[68:71]
    v_mfma_f32_16x16x32_bf16 v[76:79], v[164:167], v[238:241], v[76:79]
    s_waitcnt lgkmcnt(0)
    v_mfma_f32_16x16x32_bf16 v[48:51], v[168:171], v[214:217], v[48:51]
    v_mfma_f32_16x16x32_bf16 v[56:59], v[168:171], v[222:225], v[56:59]
    ds_read_b64_tr_b16 v[160:161], v248 offset:8192
    ds_read_b64_tr_b16 v[162:163], v248 offset:9216
    ds_read_b64_tr_b16 v[164:165], v249 offset:8192
    ds_read_b64_tr_b16 v[166:167], v249 offset:9216
    v_mfma_f32_16x16x32_bf16 v[80:83], v[168:171], v[230:233], v[80:83]
    v_mfma_f32_16x16x32_bf16 v[88:91], v[168:171], v[238:241], v[88:91]
    v_mfma_f32_16x16x32_bf16 v[52:55], v[172:175], v[214:217], v[52:55]
    v_mfma_f32_16x16x32_bf16 v[60:63], v[172:175], v[222:225], v[60:63]
    v_mfma_f32_16x16x32_bf16 v[84:87], v[172:175], v[230:233], v[84:87]
    v_mfma_f32_16x16x32_bf16 v[92:95], v[172:175], v[238:241], v[92:95]
    ds_read_b64_tr_b16 v[168:169], v254 offset:8192
    ds_read_b64_tr_b16 v[170:171], v254 offset:9216
    ds_read_b64_tr_b16 v[172:173], v17 offset:8192
    ds_read_b64_tr_b16 v[174:175], v17 offset:9216
    s_setprio 3
    s_mul_i32 s79, s52, 8
    s_waitcnt vmcnt(0)
    v_add_u32 v29, v128, v134
    v_add3_u32 v29, v136, v142, v29
    v_add3_u32 v29, v144, v150, v29
    v_add3_u32 v29, v152, v158, v29
    v_cmp_ne_u32 vcc, s79, v29
    s_cbranch_vccnz L_opx_111
L_ope_109:
    s_waitcnt lgkmcnt(0)
    s_setprio 3
    v_mfma_f32_16x16x32_bf16 v[48:51], v[168:171], v[130:133], v[48:51]
    v_mfma_f32_16x16x32_bf16 v[56:59], v[168:171], v[138:141], v[56:59]
    v_mfma_f32_16x16x32_bf16 v[52:55], v[172:175], v[130:133], v[52:55]
    v_mfma_f32_16x16x32_bf16 v[60:63], v[172:175], v[138:141], v[60:63]
    v_mfma_f32_16x16x32_bf16 v[64:67], v[160:163], v[146:149], v[64:67]
    v_mfma_f32_16x16x32_bf16 v[72:75], v[160:163], v[154:157], v[72:75]
    v_mfma_f32_16x16x32_bf16 v[68:71], v[164:167], v[146:149], v[68:71]
    v_mfma_f32_16x16x32_bf16 v[76:79], v[164:167], v[154:157], v[76:79]
    s_nop 3
    ds_write_b128 v15, v[48:51] offset:16384
    ds_write_b128 v15, v[52:55] offset:17408
    ds_write_b128 v15, v[56:59] offset:18432
    ds_write_b128 v15, v[60:63] offset:19456
    v_mfma_f32_16x16x32_bf16 v[80:83], v[168:171], v[146:149], v[80:83]
    v_mfma_f32_16x16x32_bf16 v[88:91], v[168:171], v[154:157], v[88:91]
    v_mfma_f32_16x16x32_bf16 v[84:87], v[172:175], v[146:149], v[84:87]
    v_mfma_f32_16x16x32_bf16 v[92:95], v[172:175], v[154:157], v[92:95]
    ds_write_b128 v15, v[64:67] offset:20480
    ds_write_b128 v15, v[68:71] offset:21504
    ds_write_b128 v15, v[72:75] offset:22528
    ds_write_b128 v15, v[76:79] offset:23552
    v_mfma_f32_16x16x32_bf16 v[32:35], v[160:163], v[130:133], v[32:35]
    v_mfma_f32_16x16x32_bf16 v[40:43], v[160:163], v[138:141], v[40:43]
    v_mfma_f32_16x16x32_bf16 v[36:39], v[164:167], v[130:133], v[36:39]
    v_mfma_f32_16x16x32_bf16 v[44:47], v[164:167], v[138:141], v[44:47]
    s_setprio 3
    v_mov_b32 v29, 8
    ds_write_b128 v15, v[80:83] offset:24576
    ds_write_b128 v15, v[84:87] offset:25600
    ds_write_b128 v15, v[88:91] offset:26624
    ds_write_b128 v15, v[92:95] offset:27648
    ds_write_b32 v11, v29
L_lw_119:
    ds_read_b32 v29, v10 offset:0
    s_waitcnt lgkmcnt(0)
    v_cmp_le_u32 vcc, 8, v29
    s_cmp_eq_u64 vcc, -1
    s_cbranch_scc1 L_lwe_120
    s_sub_u32 s60, s60, 1
    s_cbranch_scc1 L_bail
    s_cmp_ge_u32 s62, 7
    s_cbranch_scc1 L_sv_121
    s_call_b64 s[64:65], L_service
L_sv_121:
    s_sleep 0
    s_branch L_lw_119
L_lwe_120:
    ds_read_b128 v[48:51], v250 offset:16384
    ds_read_b128 v[52:55], v250 offset:17408
    ds_read_b128 v[56:59], v250 offset:18432
    ds_read_b128 v[60:63], v250 offset:19456
    ds_read_b128 v[64:67], v251 offset:20480
    ds_read_b128 v[68:71], v251 offset:21504
    ds_read_b128 v[72:75], v251 offset:22528
    ds_read_b128 v[76:79], v251 offset:23552
    ds_read_b128 v[80:83], v252 offset:24576
    ds_read_b128 v[84:87], v252 offset:25600
    ds_read_b128 v[88:91], v252 offset:26624
    ds_read_b128 v[92:95], v252 offset:27648
    s_waitcnt lgkmcnt(8)
    v_pk_add_f32 v[32:33], v[32:33], v[48:49]
    v_pk_add_f32 v[34:35], v[34:35], v[50:51]
    v_pk_add_f32 v[36:37], v[36:37], v[52:53]
    v_pk_add_f32 v[38:39], v[38:39], v[54:55]
    v_pk_add_f32 v[40:41], v[40:41], v[56:57]
    v_pk_add_f32 v[42:43], v[42:43], v[58:59]
    v_pk_add_f32 v[44:45], v[44:45], v[60:61]
    v_pk_add_f32 v[46:47], v[46:47], v[62:63]
    s_waitcnt lgkmcnt(4)
    v_pk_add_f32 v[32:33], v[32:33], v[64:65]
    v_pk_add_f32 v[34:35], v[34:35], v[66:67]
    v_pk_add_f32 v[36:37], v[36:37], v[68:69]
    v_pk_add_f32 v[38:39], v[38:39], v[70:71]
    v_pk_add_f32 v[40:41], v[40:41], v[72:73]
    v_pk_add_f32 v[42:43], v[42:43], v[74:75]
    v_pk_add_f32 v[44:45], v[44:45], v[76:77]
    v_pk_add_f32 v[46:47], v[46:47], v[78:79]
    s_waitcnt lgkmcnt(0)
    v_pk_add_f32 v[32:33], v[32:33], v[80:81]
    v_pk_add_f32 v[34:35], v[34:35], v[82:83]
    v_pk_add_f32 v[36:37], v[36:37], v[84:85]
    v_pk_add_f32 v[38:39], v[38:39], v[86:87]
    v_pk_add_f32 v[40:41], v[40:41], v[88:89]
    v_pk_add_f32 v[42:43], v[42:43], v[90:91]
    v_pk_add_f32 v[44:45], v[44:45], v[92:93]
    v_pk_add_f32 v[46:47], v[46:47], v[94:95]
    v_pk_fma_f32 v[32:33], v[32:33], v[20:21], v[22:23] op_sel:[0,0,0] op_sel_hi:[1,0,0]
    v_pk_fma_f32 v[34:35], v[34:35], v[20:21], v[22:23] op_sel:[0,0,0] op_sel_hi:[1,0,0]
    v_pk_fma_f32 v[36:37], v[36:37], v[20:21], v[22:23] op_sel:[0,0,0] op_sel_hi:[1,0,0]
    v_pk_fma_f32 v[38:39], v[38:39], v[20:21], v[22:23] op_sel:[0,0,0] op_sel_hi:[1,0,0]
    v_pk_fma_f32 v[40:41], v[40:41], v[20:21], v[22:23] op_sel:[0,1,1] op_sel_hi:[1,1,1]
    v_pk_fma_f32 v[42:43], v[42:43], v[20:21], v[22:23] op_sel:[0,1,1] op_sel_hi:[1,1,1]
    v_pk_fma_f32 v[44:45], v[44:45], v[20:21], v[22:23] op_sel:[0,1,1] op_sel_hi:[1,1,1]
    v_pk_fma_f32 v[46:47], v[46:47], v[20:21], v[22:23] op_sel:[0,1,1] op_sel_hi:[1,1,1]
    v_xor_b32 v29, 32, v16
    v_cvt_pk_bf16_f32 v48, v32, v33
    v_cvt_pk_bf16_f32 v49, v34, v35
    ds_write_b64 v16, v[48:49] offset:0
    v_cvt_pk_bf16_f32 v50, v36, v37
    v_cvt_pk_bf16_f32 v51, v38, v39
    ds_write_b64 v29, v[50:51] offset:0
    v_cvt_pk_bf16_f32 v52, v40, v41
    v_cvt_pk_bf16_f32 v53, v42, v43
    ds_write_b64 v16, v[52:53] offset:1024
    v_cvt_pk_bf16_f32 v54, v44, v45
    v_cvt_pk_bf16_f32 v55, v46, v47
    ds_write_b64 v29, v[54:55] offset:1024
    ds_read_b128 v[40:43], v15
    ds_read_b128 v[44:47], v15 offset:1024
    s_add_u32 s68, s67, 16384
    s_waitcnt lgkmcnt(1)
    buffer_store_dwordx4 v[40:43], v255, s[44:47], s67 offen
    s_waitcnt lgkmcnt(0)
    buffer_store_dwordx4 v[44:47], v255, s[44:47], s68 offen
L_dl_122:
    s_cmp_ge_u32 s62, 7
    s_cbranch_scc1 L_dle_123
    s_call_b64 s[64:65], L_service
    s_sub_u32 s60, s60, 1
    s_cbranch_scc1 L_bail
    s_sleep 1
    s_branch L_dl_122
L_dle_123:
    s_cmp_lg_u32 s2, 0
    s_cbranch_scc1 L_gemm_end
    s_cmp_lg_u32 s59, 0
    s_cbranch_scc1 L_gemm_end
    v_mov_b32 v29, s52
    s_mov_b64 exec, 1
    buffer_store_dword v29, v5, s[48:51], 0 offen sc1
    s_mov_b64 exec, -1
L_gemm_end:
L_bail:
L_end:
    s_endpgm
L_ph6:
L_lw_124:
    ds_read_b32 v30, v10 offset:0
    s_waitcnt lgkmcnt(0)
    v_cmp_le_u32 vcc, 6, v30
    s_cmp_eq_u64 vcc, -1
    s_cbranch_scc1 L_lwe_125
    s_sub_u32 s60, s60, 1
    s_cbranch_scc1 L_bail
    s_sleep 0
    s_branch L_lw_124
L_lwe_125:
    s_branch L_ph6_ok
L_no_g1:
    v_mov_b32 v9, 155680
L_lw_126:
    ds_read_b32 v29, v9 offset:0
    s_waitcnt lgkmcnt(0)
    v_cmp_le_u32 vcc, 1, v29
    s_cmp_eq_u64 vcc, -1
    s_cbranch_scc1 L_lwe_127
    s_sub_u32 s60, s60, 1
    s_cbranch_scc1 L_bail
    s_cmp_ge_u32 s62, 7
    s_cbranch_scc1 L_sv_128
    s_call_b64 s[64:65], L_service
L_sv_128:
    s_sleep 8
    s_branch L_lw_126
L_lwe_127:
    s_and_b32 s69, s58, 3
    s_lshl_b32 s69, s69, 3
    s_and_b32 s68, s2, 7
    s_add_u32 s81, s69, s68
    s_lshl_b32 s81, s81, 13
    s_mul_i32 s66, s59, 1835008
    s_add_u32 s66, s66, s81
    s_add_u32 s69, s66, 1048576
    buffer_load_dword v223, v222, s[24:27], s69 offen
    s_waitcnt vmcnt(0)
    s_cmp_ge_u32 s62, 7
    s_cbranch_scc1 L_sv_129
    s_call_b64 s[64:65], L_service
L_sv_129:
    s_add_u32 s69, s66, 1310720
    buffer_load_dword v223, v222, s[24:27], s69 offen
    s_waitcnt vmcnt(0)
    s_cmp_ge_u32 s62, 7
    s_cbranch_scc1 L_sv_130
    s_call_b64 s[64:65], L_service
L_sv_130:
    s_add_u32 s69, s66, 1572864
    buffer_load_dword v223, v222, s[24:27], s69 offen
    s_waitcnt vmcnt(0)
    s_cmp_ge_u32 s62, 7
    s_cbranch_scc1 L_sv_131
    s_call_b64 s[64:65], L_service
L_sv_131:
    s_lshl_b32 s66, s59, 20
    s_add_u32 s66, s66, s81
    s_cmp_ge_u32 s59, 2
    s_cbranch_scc1 L_nowo
    s_lshl_b32 s68, s59, 18
    s_add_u32 s69, s68, s81
    buffer_load_dword v223, v222, s[20:23], s69 offen
L_nowo:
    ds_read_b32 v29, v9 offset:12
    s_waitcnt lgkmcnt(0)
    v_cmp_ne_u32 vcc, 0, v29
    s_cbranch_vccnz L_help1_done
    s_add_u32 s69, s66, 0
    buffer_load_dword v223, v222, s[32:35], s69 offen
    s_waitcnt vmcnt(0)
    s_cmp_ge_u32 s62, 7
    s_cbranch_scc1 L_sv_132
    s_call_b64 s[64:65], L_service
L_sv_132:
    ds_read_b32 v29, v9 offset:12
    s_waitcnt lgkmcnt(0)
    v_cmp_ne_u32 vcc, 0, v29
    s_cbranch_vccnz L_help1_done
    s_add_u32 s69, s66, 262144
    buffer_load_dword v223, v222, s[32:35], s69 offen
    s_waitcnt vmcnt(0)
    s_cmp_ge_u32 s62, 7
    s_cbranch_scc1 L_sv_133
    s_call_b64 s[64:65], L_service
L_sv_133:
    ds_read_b32 v29, v9 offset:12
    s_waitcnt lgkmcnt(0)
    v_cmp_ne_u32 vcc, 0, v29
    s_cbranch_vccnz L_help1_done
    s_add_u32 s69, s66, 524288
    buffer_load_dword v223, v222, s[32:35], s69 offen
    s_waitcnt vmcnt(0)
    s_cmp_ge_u32 s62, 7
    s_cbranch_scc1 L_sv_134
    s_call_b64 s[64:65], L_service
L_sv_134:
L_help1_done:
    s_cmp_ge_u32 s59, 2
    s_cbranch_scc1 L_pa_135
    buffer_load_dword v223, v222, s[32:35], s41 offen
L_pa_135:
    s_add_u32 s69, s73, 0
    s_add_u32 m0, s61, 12288
    s_nop 0
    buffer_load_dwordx4 v26, s[20:23], s69 offen lds
    buffer_load_dwordx4 v27, s[20:23], s69 offen offset:1024 lds
    s_add_u32 s69, s73, 65536
    s_add_u32 m0, s61, 14336
    s_nop 0
    buffer_load_dwordx4 v26, s[20:23], s69 offen lds
    buffer_load_dwordx4 v27, s[20:23], s69 offen offset:1024 lds
    s_add_u32 m0, s76, 0
    s_nop 0
    buffer_load_dwordx4 v24, s[32:35], s4 offen lds
    buffer_load_dwordx4 v25, s[32:35], s4 offen offset:1024 lds
    s_add_u32 m0, s77, 2048
    s_nop 0
    buffer_load_dwordx4 v24, s[32:35], s5 offen lds
    buffer_load_dwordx4 v25, s[32:35], s5 offen offset:1024 lds
    s_add_u32 m0, s76, 4096
    s_nop 0
    buffer_load_dwordx4 v24, s[32:35], s6 offen lds
    buffer_load_dwordx4 v25, s[32:35], s6 offen offset:1024 lds
    s_add_u32 m0, s77, 6144
    s_nop 0
    buffer_load_dwordx4 v24, s[32:35], s7 offen lds
    buffer_load_dwordx4 v25, s[32:35], s7 offen offset:1024 lds
    s_add_u32 m0, s76, 8192
    s_nop 0
    buffer_load_dwordx4 v24, s[32:35], s8 offen lds
    buffer_load_dwordx4 v25, s[32:35], s8 offen offset:1024 lds
    s_add_u32 m0, s77, 10240
    s_nop 0
    buffer_load_dwordx4 v24, s[32:35], s9 offen lds
    buffer_load_dwordx4 v25, s[32:35], s9 offen offset:1024 lds
    v_mov_b32 v30, 155684
L_lw_136:
    ds_read_b32 v29, v30 offset:0
    s_waitcnt lgkmcnt(0)
    v_cmp_le_u32 vcc, 1, v29
    s_cmp_eq_u64 vcc, -1
    s_cbranch_scc1 L_lwe_137
    s_sub_u32 s60, s60, 1
    s_cbranch_scc1 L_bail
    s_cmp_ge_u32 s62, 7
    s_cbranch_scc1 L_sv_138
    s_call_b64 s[64:65], L_service
L_sv_138:
    s_sleep 2
    s_branch L_lw_136
L_lwe_137:
    s_mul_i32 s79, s52, 8
    s_and_b32 s43, s80, 0xfffeffff
    s_add_u32 s43, s43, 2040
L_op_139:
    s_mov_b64 s[82:83], 15
L_gw_142:
    s_mov_b64 exec, s[82:83]
    buffer_load_dword v29, v253, s[48:51], s43 offen sc1
    s_waitcnt vmcnt(0)
L_gwc_144:
    v_cmp_ne_u32 s[82:83], s52, v29
    s_mov_b64 exec, -1
    s_cmp_eq_u64 s[82:83], 0
    s_cbranch_scc1 L_gwe_143
    s_sub_u32 s60, s60, 1
    s_cbranch_scc1 L_bail
    s_cmp_ge_u32 s62, 7
    s_cbranch_scc1 L_sv_145
    s_call_b64 s[64:65], L_service
L_sv_145:
    s_sleep 1
    s_branch L_gw_142
L_gwe_143:
    s_xor_b32 s68, s80, 0
    buffer_load_dwordx4 v[96:99], v28, s[48:51], s68 offen offset:0 sc1
    buffer_load_dwordx4 v[100:103], v28, s[48:51], s68 offen offset:1024 sc1
    s_xor_b32 s68, s80, 0
    buffer_load_dwordx4 v[104:107], v28, s[48:51], s68 offen offset:256 sc1
    buffer_load_dwordx4 v[108:111], v28, s[48:51], s68 offen offset:1280 sc1
    s_xor_b32 s68, s80, 65536
    buffer_load_dwordx4 v[112:115], v28, s[48:51], s68 offen offset:0 sc1
    buffer_load_dwordx4 v[116:119], v28, s[48:51], s68 offen offset:1024 sc1
    s_xor_b32 s68, s80, 65536
    buffer_load_dwordx4 v[120:123], v28, s[48:51], s68 offen offset:256 sc1
    buffer_load_dwordx4 v[124:127], v28, s[48:51], s68 offen offset:1280 sc1
    s_waitcnt vmcnt(6)
    v_add_u32 v29, v96, v102
    s_waitcnt vmcnt(4)
    v_add3_u32 v29, v104, v110, v29
    s_waitcnt vmcnt(2)
    v_add3_u32 v29, v112, v118, v29
    s_waitcnt vmcnt(0)
    v_add3_u32 v29, v120, v126, v29
    v_cmp_ne_u32 vcc, s79, v29
    s_cbranch_vccz L_ope_140
    s_sub_u32 s60, s60, 1
    s_cbranch_scc1 L_bail
    s_branch L_op_139
L_ope_140:
    ds_read_b64_tr_b16 v[160:161], v248 offset:12288
    ds_read_b64_tr_b16 v[162:163], v248 offset:13312
    ds_read_b64_tr_b16 v[164:165], v249 offset:12288
    ds_read_b64_tr_b16 v[166:167], v249 offset:13312
    s_setprio 0
    s_waitcnt lgkmcnt(0)
    v_mfma_f32_16x16x32_bf16 v[32:35], v[160:163], v[98:101], 0
    v_mfma_f32_16x16x32_bf16 v[40:43], v[160:163], v[106:109], 0
    ds_read_b64_tr_b16 v[168:169], v254 offset:12288
    ds_read_b64_tr_b16 v[170:171], v254 offset:13312
    ds_read_b64_tr_b16 v[172:173], v17 offset:12288
    ds_read_b64_tr_b16 v[174:175], v17 offset:13312
    v_mfma_f32_16x16x32_bf16 v[64:67], v[160:163], v[114:117], 0
    v_mfma_f32_16x16x32_bf16 v[72:75], v[160:163], v[122:125], 0
    v_mfma_f32_16x16x32_bf16 v[36:39], v[164:167], v[98:101], 0
    v_mfma_f32_16x16x32_bf16 v[44:47], v[164:167], v[106:109], 0
    v_mfma_f32_16x16x32_bf16 v[68:71], v[164:167], v[114:117], 0
    v_mfma_f32_16x16x32_bf16 v[76:79], v[164:167], v[122:125], 0
    s_waitcnt lgkmcnt(0)
    v_mfma_f32_16x16x32_bf16 v[48:51], v[168:171], v[98:101], 0
    v_mfma_f32_16x16x32_bf16 v[56:59], v[168:171], v[106:109], 0
    v_mfma_f32_16x16x32_bf16 v[80:83], v[168:171], v[114:117], 0
    v_mfma_f32_16x16x32_bf16 v[88:91], v[168:171], v[122:125], 0
    v_mfma_f32_16x16x32_bf16 v[52:55], v[172:175], v[98:101], 0
    v_mfma_f32_16x16x32_bf16 v[60:63], v[172:175], v[106:109], 0
    v_mfma_f32_16x16x32_bf16 v[84:87], v[172:175], v[114:117], 0
    v_mfma_f32_16x16x32_bf16 v[92:95], v[172:175], v[122:125], 0
    s_add_u32 m0, s76, 12288
    s_nop 0
    buffer_load_dwordx4 v24, s[32:35], s10 offen lds
    buffer_load_dwordx4 v25, s[32:35], s10 offen offset:1024 lds
    s_add_u32 m0, s77, 14336
    s_nop 0
    buffer_load_dwordx4 v24, s[32:35], s11 offen lds
    buffer_load_dwordx4 v25, s[32:35], s11 offen offset:1024 lds
    s_setprio 3
    s_add_u32 s32, s32, 524288
    s_addc_u32 s33, s33, 0
    s_sub_u32 s34, s34, 524288
    s_add_u32 m0, s76, 16384
    s_nop 0
    buffer_load_dwordx4 v24, s[32:35], s4 offen lds
    buffer_load_dwordx4 v25, s[32:35], s4 offen offset:1024 lds
    s_add_u32 m0, s77, 18432
    s_nop 0
    buffer_load_dwordx4 v24, s[32:35], s5 offen lds
    buffer_load_dwordx4 v25, s[32:35], s5 offen offset:1024 lds
    s_add_u32 m0, s76, 20480
    s_nop 0
    buffer_load_dwordx4 v24, s[32:35], s6 offen lds
    buffer_load_dwordx4 v25, s[32:35], s6 offen offset:1024 lds
    s_add_u32 m0, s77, 22528
    s_nop 0
    buffer_load_dwordx4 v24, s[32:35], s7 offen lds
    buffer_load_dwordx4 v25, s[32:35], s7 offen offset:1024 lds
    v_mov_b32 v30, 155696
L_lw_146:
    ds_read_b32 v29, v30 offset:0
    s_waitcnt lgkmcnt(0)
    v_cmp_le_u32 vcc, 1, v29
    s_cmp_eq_u64 vcc, -1
    s_cbranch_scc1 L_lwe_147
    s_sub_u32 s60, s60, 1
    s_cbranch_scc1 L_bail
    s_cmp_ge_u32 s62, 7
    s_cbranch_scc1 L_sv_148
    s_call_b64 s[64:65], L_service
L_sv_148:
    s_sleep 2
    s_branch L_lw_146
L_lwe_147:
L_help_done:
    s_lshl_b32 s68, s54, 2
    s_add_u32 s68, s68, s59
    s_mul_i32 s68, s68, 3584
    s_add_u32 s78, s68, 327680
    v_min_u32 v9, 27, v0
    v_lshlrev_b32 v9, 7, v9
    s_lshl_b32 s66, s59, 19
    s_lshl_b32 s68, s54, 12
    s_add_u32 s66, s66, s68
    s_add_u32 s66, s66, 3145728
    v_mov_b32 v1, v8
    v_xor_b32 v2, 32, v8
    v_xor_b32 v3, 64, v8
    v_xor_b32 v4, 96, v8
    s_and_b32 s68, s100, 2
    s_lshl_b32 s68, s68, 14
    s_add_u32 s101, s66, s68
    s_and_b32 s68, s100, 6
    s_lshl_b32 s68, s68, 14
    s_add_u32 s66, s66, s68
    s_mov_b64 exec, 0xff
    buffer_load_dword v29, v9, s[48:51], s78 offen sc1
    s_mov_b64 exec, -1
    s_waitcnt vmcnt(0)
    s_branch L_g2
L_opx_54:
    s_waitcnt vmcnt(0)
    s_mov_b64 exec, 0xff
    buffer_store_dwordx4 v[220:223], v5, s[48:51], s38 offen sc1
    s_mov_b64 exec, -1
    v_mov_b32 v30, 155684
L_lw_55:
    ds_read_b32 v29, v30 offset:0
    s_waitcnt lgkmcnt(0)
    v_cmp_le_u32 vcc, 1, v29
    s_cmp_eq_u64 vcc, -1
    s_cbranch_scc1 L_lwe_56
    s_sub_u32 s60, s60, 1
    s_cbranch_scc1 L_bail
    s_cmp_ge_u32 s62, 7
    s_cbranch_scc1 L_sv_57
    s_call_b64 s[64:65], L_service
L_sv_57:
    s_sleep 2
    s_branch L_lw_55
L_lwe_56:
    s_and_b32 s43, s80, 0xfffeffff
    s_add_u32 s43, s43, 2040
L_op_51:
    s_mov_b64 s[82:83], 15
L_gw_58:
    s_mov_b64 exec, s[82:83]
    buffer_load_dword v29, v253, s[48:51], s43 offen sc1
    s_waitcnt vmcnt(0)
L_gwc_60:
    v_cmp_ne_u32 s[82:83], s52, v29
    s_mov_b64 exec, -1
    s_cmp_eq_u64 s[82:83], 0
    s_cbranch_scc1 L_gwe_59
    s_sub_u32 s60, s60, 1
    s_cbranch_scc1 L_bail
    s_cmp_ge_u32 s62, 7
    s_cbranch_scc1 L_sv_61
    s_call_b64 s[64:65], L_service
L_sv_61:
    s_sleep 1
    s_branch L_gw_58
L_gwe_59:
    s_xor_b32 s68, s80, 0
    buffer_load_dwordx4 v[96:99], v28, s[48:51], s68 offen offset:0 sc1
    buffer_load_dwordx4 v[100:103], v28, s[48:51], s68 offen offset:1024 sc1
    s_xor_b32 s68, s80, 0
    buffer_load_dwordx4 v[104:107], v28, s[48:51], s68 offen offset:256 sc1
    buffer_load_dwordx4 v[108:111], v28, s[48:51], s68 offen offset:1280 sc1
    s_xor_b32 s68, s80, 65536
    buffer_load_dwordx4 v[112:115], v28, s[48:51], s68 offen offset:0 sc1
    buffer_load_dwordx4 v[116:119], v28, s[48:51], s68 offen offset:1024 sc1
    s_xor_b32 s68, s80, 65536
    buffer_load_dwordx4 v[120:123], v28, s[48:51], s68 offen offset:256 sc1
    buffer_load_dwordx4 v[124:127], v28, s[48:51], s68 offen offset:1280 sc1
    s_waitcnt vmcnt(6)
    v_add_u32 v29, v96, v102
    s_waitcnt vmcnt(4)
    v_add3_u32 v29, v104, v110, v29
    s_waitcnt vmcnt(2)
    v_add3_u32 v29, v112, v118, v29
    s_waitcnt vmcnt(0)
    v_add3_u32 v29, v120, v126, v29
    v_cmp_ne_u32 vcc, s79, v29
    s_cbranch_vccz L_ope_52
    s_sub_u32 s60, s60, 1
    s_cbranch_scc1 L_bail
    s_branch L_op_51
L_opx_79:
    v_mov_b32 v30, 155692
L_lw_80:
    ds_read_b32 v29, v30 offset:0
    s_waitcnt lgkmcnt(0)
    v_cmp_le_u32 vcc, 1, v29
    s_cmp_eq_u64 vcc, -1
    s_cbranch_scc1 L_lwe_81
    s_sub_u32 s60, s60, 1
    s_cbranch_scc1 L_bail
    s_cmp_ge_u32 s62, 7
    s_cbranch_scc1 L_sv_82
    s_call_b64 s[64:65], L_service
L_sv_82:
    s_sleep 2
    s_branch L_lw_80
L_lwe_81:
    s_and_b32 s43, s80, 0xfffeffff
    s_add_u32 s43, s43, 4088
L_op_76:
    s_mov_b64 s[82:83], 15
L_gw_83:
    s_mov_b64 exec, s[82:83]
    buffer_load_dword v29, v253, s[48:51], s43 offen sc1
    s_waitcnt vmcnt(0)
L_gwc_85:
    v_cmp_ne_u32 s[82:83], s52, v29
    s_mov_b64 exec, -1
    s_cmp_eq_u64 s[82:83], 0
    s_cbranch_scc1 L_gwe_84
    s_sub_u32 s60, s60, 1
    s_cbranch_scc1 L_bail
    s_cmp_ge_u32 s62, 7
    s_cbranch_scc1 L_sv_86
    s_call_b64 s[64:65], L_service
L_sv_86:
    s_sleep 1
    s_branch L_gw_83
L_gwe_84:
    s_xor_b32 s68, s80, 2048
    buffer_load_dwordx4 v[212:215], v28, s[48:51], s68 offen offset:0 sc1
    buffer_load_dwordx4 v[216:219], v28, s[48:51], s68 offen offset:1024 sc1
    s_xor_b32 s68, s80, 2048
    buffer_load_dwordx4 v[220:223], v28, s[48:51], s68 offen offset:256 sc1
    buffer_load_dwordx4 v[224:227], v28, s[48:51], s68 offen offset:1280 sc1
    s_xor_b32 s68, s80, 67584
    buffer_load_dwordx4 v[228:231], v28, s[48:51], s68 offen offset:0 sc1
    buffer_load_dwordx4 v[232:235], v28, s[48:51], s68 offen offset:1024 sc1
    s_xor_b32 s68, s80, 67584
    buffer_load_dwordx4 v[236:239], v28, s[48:51], s68 offen offset:256 sc1
    buffer_load_dwordx4 v[240:243], v28, s[48:51], s68 offen offset:1280 sc1
    s_waitcnt vmcnt(6)
    v_add_u32 v29, v212, v218
    s_waitcnt vmcnt(4)
    v_add3_u32 v29, v220, v226, v29
    s_waitcnt vmcnt(2)
    v_add3_u32 v29, v228, v234, v29
    s_waitcnt vmcnt(0)
    v_add3_u32 v29, v236, v242, v29
    v_cmp_ne_u32 vcc, s79, v29
    s_cbranch_vccz L_ope_77
    s_sub_u32 s60, s60, 1
    s_cbranch_scc1 L_bail
    s_branch L_op_76
L_opx_99:
    v_mov_b32 v30, 155700
L_lw_100:
    ds_read_b32 v29, v30 offset:0
    s_waitcnt lgkmcnt(0)
    v_cmp_le_u32 vcc, 1, v29
    s_cmp_eq_u64 vcc, -1
    s_cbranch_scc1 L_lwe_101
    s_sub_u32 s60, s60, 1
    s_cbranch_scc1 L_bail
    s_cmp_ge_u32 s62, 7
    s_cbranch_scc1 L_sv_102
    s_call_b64 s[64:65], L_service
L_sv_102:
    s_sleep 2
    s_branch L_lw_100
L_lwe_101:
    s_and_b32 s43, s80, 0xfffeffff
    s_add_u32 s43, s43, 6136
L_op_96:
    s_mov_b64 s[82:83], 15
L_gw_103:
    s_mov_b64 exec, s[82:83]
    buffer_load_dword v29, v253, s[48:51], s43 offen sc1
    s_waitcnt vmcnt(0)
L_gwc_105:
    v_cmp_ne_u32 s[82:83], s52, v29
    s_mov_b64 exec, -1
    s_cmp_eq_u64 s[82:83], 0
    s_cbranch_scc1 L_gwe_104
    s_sub_u32 s60, s60, 1
    s_cbranch_scc1 L_bail
    s_cmp_ge_u32 s62, 7
    s_cbranch_scc1 L_sv_106
    s_call_b64 s[64:65], L_service
L_sv_106:
    s_sleep 1
    s_branch L_gw_103
L_gwe_104:
    s_xor_b32 s68, s80, 4096
    buffer_load_dwordx4 v[212:215], v28, s[48:51], s68 offen offset:0 sc1
    buffer_load_dwordx4 v[216:219], v28, s[48:51], s68 offen offset:1024 sc1
    s_xor_b32 s68, s80, 4096
    buffer_load_dwordx4 v[220:223], v28, s[48:51], s68 offen offset:256 sc1
    buffer_load_dwordx4 v[224:227], v28, s[48:51], s68 offen offset:1280 sc1
    s_xor_b32 s68, s80, 69632
    buffer_load_dwordx4 v[228:231], v28, s[48:51], s68 offen offset:0 sc1
    buffer_load_dwordx4 v[232:235], v28, s[48:51], s68 offen offset:1024 sc1
    s_xor_b32 s68, s80, 69632
    buffer_load_dwordx4 v[236:239], v28, s[48:51], s68 offen offset:256 sc1
    buffer_load_dwordx4 v[240:243], v28, s[48:51], s68 offen offset:1280 sc1
    s_waitcnt vmcnt(6)
    v_add_u32 v29, v212, v218
    s_waitcnt vmcnt(4)
    v_add3_u32 v29, v220, v226, v29
    s_waitcnt vmcnt(2)
    v_add3_u32 v29, v228, v234, v29
    s_waitcnt vmcnt(0)
    v_add3_u32 v29, v236, v242, v29
    v_cmp_ne_u32 vcc, s79, v29
    s_cbranch_vccz L_ope_97
    s_sub_u32 s60, s60, 1
    s_cbranch_scc1 L_bail
    s_branch L_op_96
L_opx_111:
    v_mov_b32 v30, 155708
L_lw_112:
    ds_read_b32 v29, v30 offset:0
    s_waitcnt lgkmcnt(0)
    v_cmp_le_u32 vcc, 1, v29
    s_cmp_eq_u64 vcc, -1
    s_cbranch_scc1 L_lwe_113
    s_sub_u32 s60, s60, 1
    s_cbranch_scc1 L_bail
    s_cmp_ge_u32 s62, 7
    s_cbranch_scc1 L_sv_114
    s_call_b64 s[64:65], L_service
L_sv_114:
    s_sleep 2
    s_branch L_lw_112
L_lwe_113:
    s_and_b32 s43, s80, 0xfffeffff
    s_add_u32 s43, s43, 8184
L_op_108:
    s_mov_b64 s[82:83], 15
L_gw_115:
    s_mov_b64 exec, s[82:83]
    buffer_load_dword v29, v253, s[48:51], s43 offen sc1
    s_waitcnt vmcnt(0)
L_gwc_117:
    v_cmp_ne_u32 s[82:83], s52, v29
    s_mov_b64 exec, -1
    s_cmp_eq_u64 s[82:83], 0
    s_cbranch_scc1 L_gwe_116
    s_sub_u32 s60, s60, 1
    s_cbranch_scc1 L_bail
    s_cmp_ge_u32 s62, 7
    s_cbranch_scc1 L_sv_118
    s_call_b64 s[64:65], L_service
L_sv_118:
    s_sleep 1
    s_branch L_gw_115
L_gwe_116:
    s_xor_b32 s68, s80, 6144
    buffer_load_dwordx4 v[128:131], v28, s[48:51], s68 offen offset:0 sc1
    buffer_load_dwordx4 v[132:135], v28, s[48:51], s68 offen offset:1024 sc1
    s_xor_b32 s68, s80, 6144
    buffer_load_dwordx4 v[136:139], v28, s[48:51], s68 offen offset:256 sc1
    buffer_load_dwordx4 v[140:143], v28, s[48:51], s68 offen offset:1280 sc1
    s_xor_b32 s68, s80, 71680
    buffer_load_dwordx4 v[144:147], v28, s[48:51], s68 offen offset:0 sc1
    buffer_load_dwordx4 v[148:151], v28, s[48:51], s68 offen offset:1024 sc1
    s_xor_b32 s68, s80, 71680
    buffer_load_dwordx4 v[152:155], v28, s[48:51], s68 offen offset:256 sc1
    buffer_load_dwordx4 v[156:159], v28, s[48:51], s68 offen offset:1280 sc1
    s_waitcnt vmcnt(6)
    v_add_u32 v29, v128, v134
    s_waitcnt vmcnt(4)
    v_add3_u32 v29, v136, v142, v29
    s_waitcnt vmcnt(2)
    v_add3_u32 v29, v144, v150, v29
    s_waitcnt vmcnt(0)
    v_add3_u32 v29, v152, v158, v29
    v_cmp_ne_u32 vcc, s79, v29
    s_cbranch_vccz L_ope_109
    s_sub_u32 s60, s60, 1
    s_cbranch_scc1 L_bail
    s_branch L_op_108
L_ux_68:
    s_setprio 3
    s_mov_b64 s[70:71], vcc
    s_mov_b64 exec, s[82:83]
    s_waitcnt vmcnt(12)
    s_branch L_gwc_151
L_gw_149:
    s_mov_b64 exec, s[82:83]
    buffer_load_dword v29, v9, s[48:51], s78 offen sc1
    s_waitcnt vmcnt(0)
L_gwc_151:
    v_cmp_ne_u32 s[82:83], s52, v29
    s_mov_b64 exec, -1
    s_cmp_eq_u64 s[82:83], 0
    s_cbranch_scc1 L_gwe_150
    s_sub_u32 s60, s60, 1
    s_cbranch_scc1 L_bail
    s_sleep 4
    s_branch L_gw_149
L_gwe_150:
    s_mov_b64 vcc, s[70:71]
    s_setprio 0
    s_branch L_ub_69
L_fx_34:
    s_setprio 3
    s_call_b64 s[64:65], L_fin
    s_mov_b32 s42, 4
    s_setprio 0
    s_branch L_fb_35
L_fx_36:
    s_setprio 3
    s_call_b64 s[64:65], L_fin
    s_mov_b32 s42, 8
    s_setprio 0
    s_branch L_fb_37
L_fx_38:
    s_setprio 3
    s_call_b64 s[64:65], L_fin
    s_mov_b32 s42, 12
    s_setprio 0
    s_branch L_fb_39
L_fx_40:
    s_setprio 3
    s_call_b64 s[64:65], L_fin
    s_mov_b32 s42, 16
    s_setprio 0
    s_branch L_fb_41
L_fx_42:
    s_setprio 3
    s_call_b64 s[64:65], L_fin
    s_mov_b32 s42, 20
    s_setprio 0
    s_branch L_fb_43
L_fx_44:
    s_setprio 3
    s_call_b64 s[64:65], L_fin
    s_mov_b32 s42, 24
    s_setprio 0
    s_branch L_fb_45
L_fx_46:
    s_setprio 3
    s_call_b64 s[64:65], L_fin
    s_mov_b32 s42, 28
    s_setprio 0
    s_branch L_fb_47
L_fx_70:
    s_setprio 3
    s_call_b64 s[64:65], L_fin
    s_mov_b32 s42, 68
    s_setprio 0
    s_branch L_fb_71
L_fx_72:
    s_setprio 3
    s_call_b64 s[64:65], L_fin
    s_mov_b32 s42, 72
    s_setprio 0
    s_branch L_fb_73
L_fx_74:
    s_setprio 3
    s_call_b64 s[64:65], L_fin
    s_mov_b32 s42, 76
    s_setprio 0
    s_branch L_fb_75
L_fx_87:
    s_setprio 3
    s_call_b64 s[64:65], L_fin
    s_mov_b32 s42, 84
    s_setprio 0
    s_branch L_fb_88
L_fx_92:
    s_setprio 3
    s_call_b64 s[64:65], L_fin
    s_mov_b32 s42, 88
    s_setprio 0
    s_branch L_fb_93
L_fx_94:
    s_setprio 3
    s_call_b64 s[64:65], L_fin
    s_mov_b32 s42, 92
    s_setprio 0
    s_branch L_fb_95
L_service:
    ds_read_b32 v176, v12
    s_waitcnt lgkmcnt(0)
    v_cmp_ne_u32 vcc, s29, v176
    s_cbranch_vccnz L_svc_ret
L_fin:
    s_waitcnt lgkmcnt(0)
    ds_read_b32 v208, v14 offset:0
    ds_read_b32 v209, v14 offset:2560
    ds_read_b32 v210, v14 offset:5120
    ds_read_b32 v211, v14 offset:7680
    ds_read_b128 v[176:179], v13 offset:0
    ds_read_b128 v[180:183], v13 offset:2560
    ds_read_b128 v[184:187], v13 offset:5120
    ds_read_b128 v[188:191], v13 offset:7680
    ds_read_b128 v[192:195], v13 offset:1024
    ds_read_b128 v[196:199], v13 offset:3584
    ds_read_b128 v[200:203], v13 offset:6144
    ds_read_b128 v[204:207], v13 offset:8704
    s_waitcnt lgkmcnt(8)
    v_pk_add_f32 v[208:209], v[208:209], v[210:211]
    v_add_f32 v208, v208, v209
    v_rcp_f32 v209, v208
    v_subrev_u32 v208, 0x21800000, v208
    v_cmp_lt_u32 vcc, 0x46000000, v208
    v_mul_f32 v210, v209, v31
    s_waitcnt lgkmcnt(4)
    v_pk_add_f32 v[176:177], v[176:177], v[180:181]
    v_pk_add_f32 v[184:185], v[184:185], v[188:189]
    v_pk_add_f32 v[178:179], v[178:179], v[182:183]
    v_pk_add_f32 v[186:187], v[186:187], v[190:191]
    v_pk_add_f32 v[176:177], v[176:177], v[184:185]
    v_pk_add_f32 v[178:179], v[178:179], v[186:187]
    v_pk_mul_f32 v[176:177], v[176:177], v[210:211] op_sel_hi:[1,0]
    v_pk_mul_f32 v[178:179], v[178:179], v[210:211] op_sel_hi:[1,0]
    v_cvt_pk_bf16_f32 v182, v176, v177
    v_cvt_pk_bf16_f32 v183, v178, v179
    v_mov_b32 v180, s52
    v_mov_b32 v186, s52
    s_waitcnt lgkmcnt(0)
    v_pk_add_f32 v[192:193], v[192:193], v[196:197]
    v_pk_add_f32 v[200:201], v[200:201], v[204:205]
    v_pk_add_f32 v[194:195], v[194:195], v[198:199]
    v_pk_add_f32 v[202:203], v[202:203], v[206:207]
    v_pk_add_f32 v[192:193], v[192:193], v[200:201]
    v_pk_add_f32 v[194:195], v[194:195], v[202:203]
    v_pk_mul_f32 v[192:193], v[192:193], v[210:211] op_sel_hi:[1,0]
    v_pk_mul_f32 v[194:195], v[194:195], v[210:211] op_sel_hi:[1,0]
    v_cvt_pk_bf16_f32 v184, v192, v193
    v_cvt_pk_bf16_f32 v185, v194, v195
    v_mov_b32 v208, 2
    s_cbranch_vccnz L_bad_152
    v_mov_b32 v208, 1
    buffer_store_dwordx4 v[180:183], v5, s[48:51], s30 offen sc1
    buffer_store_dwordx4 v[184:187], v5, s[48:51], s30 offen offset:1024 sc1
L_bad_152:
    ds_write_b32 v19, v208 offset:0
    v_add_u32 v13, s31, v13
    v_add_u32 v14, s31, v14
    v_add_u32 v12, s31, v12
    v_add_u32 v19, 16, v19
    s_add_u32 s30, s30, 4096
    s_add_u32 s62, s62, 4
    s_add_u32 s29, s29, 4
    s_cmp_ge_u32 s62, 7
    s_cselect_b32 s29, s52, s29
L_svc_ret:
    s_setpc_b64 s[64:65]
L_codeend:
.section .rodata,"a"
.p2align 6
.amdhsa_kernel gated_mix__grouped_kv_mqa__mixer_token_mlp__prompt_kernel
  .amdhsa_next_free_vgpr 256
  .amdhsa_next_free_sgpr 102
  .amdhsa_accum_offset 256
  .amdhsa_group_segment_fixed_size 0
  .amdhsa_kernarg_size 112
  .amdhsa_user_sgpr_count 2
  .amdhsa_user_sgpr_kernarg_segment_ptr 1
  .amdhsa_system_sgpr_workgroup_id_x 1
.end_amdhsa_kernel
```
